```python
import torch

def _softmax(x, axis=-1):
    return torch.softmax(x, dim=axis)
def _gelu(x):
    return torch.nn.functional.gelu(x, approximate="tanh")
def _silu(x):
    return torch.nn.functional.silu(x)
def _sigmoid(x):
    return torch.sigmoid(x)
def _layernorm(x, axis=-1, eps=1e-5):
    m = x.mean(dim=axis, keepdim=True)
    v = x.var(dim=axis, keepdim=True, unbiased=False)
    return (x - m) / torch.sqrt(v + eps)
def _scatter_add(tgt, idx, src, axis=0):
    return tgt.clone().index_add_(axis, idx, src)
def _segment_sum(src, seg, n):
    out = torch.zeros((n,) + src.shape[1:], dtype=src.dtype)
    return out.index_add_(0, seg, src)
def _pad(x, pw):
    flat = tuple(v for pair in reversed(pw) for v in pair)
    return torch.nn.functional.pad(x, flat)

kernel_name = 'sequential_preLN__softmax_full_mha__dense_activation_silu__prompt'

def setup_inputs():

    _w = (lambda a: (lambda t: t.to(torch.bfloat16) if t.is_floating_point() else t)(torch.as_tensor(a)))
    def _A_setup():
        B, S, D = 1, 2048, 640
        return {
            "x": _w((lambda *s: torch.randn(*s, dtype=torch.bfloat16) * 0.05)(B, S, D)),
            "wqkv": _w((lambda *s: torch.randn(*s, dtype=torch.bfloat16) * 0.05)(D, 3 * D)),
            "wo": _w((lambda *s: torch.randn(*s, dtype=torch.bfloat16) * 0.05)(D, D)),
        }
    _A_in = _A_setup()

    def _B_setup():
        B, S, D, F = 1, 2048, 640, 1536
        return {
            "x": _w((lambda *s: torch.randn(*s, dtype=torch.bfloat16) * 0.05)(B, S, D)),
            "w1": _w((lambda *s: torch.randn(*s, dtype=torch.bfloat16) * 3.2)(D, F) * (D ** -0.5)),
            "w2": _w((lambda *s: torch.randn(*s, dtype=torch.bfloat16) * 0.2)(F, D) * (F ** -0.5)),
        }
    _B_in = _B_setup()

    return {
        "A_x": _A_in["x"],
        "A_wqkv": _A_in["wqkv"],
        "A_wo": _A_in["wo"],
        "B_x": _B_in["x"],
        "B_w1": _B_in["w1"],
        "B_w2": _B_in["w2"],
    }

def reference(A_x, A_wqkv, A_wo, B_x, B_w1, B_w2):
    def _A_ref(x, wqkv, wo):
        B, S, D = x.shape
        H = 32; Dh = D // H
        qkv = (lambda x, *d: x.permute(*d))((x @ wqkv).reshape(B, S, 3, H, Dh), 2, 0, 3, 1, 4)
        q, k, v = qkv[0], qkv[1], qkv[2]
        scale = Dh ** -0.5
        scores = torch.einsum("bhqd,bhkd->bhqk", q, k) * scale
        p = _softmax(scores, axis=-1)
        o = torch.einsum("bhqk,bhkd->bhqd", p, v)
        return (lambda x, *d: x.permute(*d))(o, 0, 2, 1, 3).reshape(B, S, D) @ wo

    def _B_ref(x, w1, w2):
        h = torch.einsum("bsd,df->bsf", x, w1)
        h = _silu(h)
        out = torch.einsum("bsf,fd->bsd", h, w2)
        return out

    x = A_x
    h = x + _A_ref(_layernorm(x, axis=-1), A_wqkv, A_wo)
    h2 = h + _B_ref(_layernorm(h, axis=-1), B_w1, B_w2)
    return h2
```

```asm
; @launch grid=(256,1,1) block=(512,1,1) lds=163840
.amdgcn_target "amdgcn-amd-amdhsa--gfx950"
.text
all_code_begin:
.globl sequential_preLN__softmax_full_mha__dense_activation_silu__prompt_kernel
.p2align 8
.type sequential_preLN__softmax_full_mha__dense_activation_silu__prompt_kernel,@function
sequential_preLN__softmax_full_mha__dense_activation_silu__prompt_kernel:
    s_cmp_ge_u32 s2, 256
    s_cbranch_scc1 sequential_preLN__softmax_full_mha__dense_activation_silu__prompt_kernel_end
    s_load_dwordx4 s[4:7], s[0:1], 0
    s_load_dwordx2 s[8:9], s[0:1], 64
    s_and_b32 s30, s2, 7
    s_lshr_b32 s31, s2, 3
    s_lshr_b32 s24, s30, 2
    s_lshl_b32 s24, s24, 3
    s_and_b32 s32, s31, 7
    s_add_u32 s24, s24, s32
    s_and_b32 s25, s30, 3
    s_lshl_b32 s25, s25, 2
    s_lshr_b32 s32, s31, 3
    s_add_u32 s25, s25, s32
    s_cmp_ge_u32 s25, 15
    s_cbranch_scc1 sequential_preLN__softmax_full_mha__dense_activation_silu__prompt_kernel_idle
    v_lshrrev_b32 v116, 6, v0
    v_and_b32 v112, 63, v0
    s_mul_i32 s27, s25, 205
    s_lshr_b32 s27, s27, 10
    v_readfirstlane_b32 s28, v116
    s_mul_i32 s32, s27, 5
    s_sub_u32 s26, s25, s32
    v_and_b32 v113, 31, v112
    v_lshrrev_b32 v114, 5, v112
    s_and_b32 s29, s28, 3
    s_cmp_ge_u32 s28, 4
    s_cbranch_scc0 sequential_preLN__softmax_full_mha__dense_activation_silu__prompt_kernel_M
    v_lshrrev_b32 v116, 3, v112
    v_mul_u32_u24 v116, 1280, v116
    v_lshrrev_b32 v117, 4, v112
    v_and_b32 v118, 7, v112
    v_xor_b32 v118, v118, v117
    v_lshl_add_u32 v0, v118, 4, v116
    v_xor_b32 v1, 64, v0
    v_mul_u32_u24 v116, 3840, v117
    v_lshlrev_b32 v118, 2, v117
    v_and_b32 v119, 15, v112
    v_xor_b32 v118, v118, v119
    v_lshl_add_u32 v2, v118, 4, v116
    s_setprio 3
    s_mul_i32 s34, s29, 40960
    s_lshl_b32 s36, s29, 12
    s_mul_i32 s35, s29, 61440
    s_add_u32 s37, s36, 16384
    s_waitcnt lgkmcnt(0)
    s_mul_i32 s30, s24, 163840
    s_add_u32 s12, s4, s30
    s_addc_u32 s13, s5, 0
    s_and_b32 s13, s13, 0xffff
    s_mov_b32 s14, 163840
    s_mov_b32 s15, 0x20000
    s_lshl_b32 s30, s25, 8
    s_sub_u32 s31, 2457600, s30
    s_add_u32 s16, s6, s30
    s_addc_u32 s17, s7, 0
    s_and_b32 s17, s17, 0xffff
    s_mov_b32 s18, s31
    s_mov_b32 s19, 0x20000
    s_lshr_b32 s40, s25, 2
    s_lshl_b32 s40, s40, 2
    s_lshr_b32 s40, 29984, s40
    s_and_b32 s40, s40, 15
    s_lshr_b32 s30, s24, 3
    s_mul_i32 s30, s30, 5
    s_add_u32 s40, s40, s30
    s_cmp_ge_u32 s40, 10
    s_cselect_b32 s30, 10, 0
    s_sub_u32 s40, s40, s30
    s_lshl_b32 s41, s40, 7
    s_add_u32 s41, s41, s34
    s_mul_i32 s42, s40, 245760
    s_add_u32 s42, s42, s35
    s_add_u32 s40, s40, 1
    s_cmp_ge_u32 s40, 10
    s_cselect_b32 s40, 0, s40
    s_add_u32 m0, s36, 0
    s_add_u32 s30, s41, 0
    buffer_load_dwordx4 v0, s[12:15], s30 offen lds
    s_add_u32 m0, s37, 0
    s_add_u32 s30, s42, 0
    buffer_load_dwordx4 v2, s[16:19], s30 offen lds
    s_add_u32 m0, s36, 1024
    s_add_u32 s30, s41, 10240
    buffer_load_dwordx4 v1, s[12:15], s30 offen lds
    s_add_u32 m0, s37, 1024
    s_add_u32 s30, s42, 15360
    buffer_load_dwordx4 v2, s[16:19], s30 offen lds
    s_add_u32 m0, s36, 2048
    s_add_u32 s30, s41, 20480
    buffer_load_dwordx4 v0, s[12:15], s30 offen lds
    s_add_u32 m0, s37, 2048
    s_add_u32 s30, s42, 30720
    buffer_load_dwordx4 v2, s[16:19], s30 offen lds
    s_add_u32 m0, s36, 3072
    s_add_u32 s30, s41, 30720
    buffer_load_dwordx4 v1, s[12:15], s30 offen lds
    s_add_u32 m0, s37, 3072
    s_add_u32 s30, s42, 46080
    buffer_load_dwordx4 v2, s[16:19], s30 offen lds
    s_lshl_b32 s41, s40, 7
    s_add_u32 s41, s41, s34
    s_mul_i32 s42, s40, 245760
    s_add_u32 s42, s42, s35
    s_add_u32 s40, s40, 1
    s_cmp_ge_u32 s40, 10
    s_cselect_b32 s40, 0, s40
    s_add_u32 m0, s36, 32768
    s_add_u32 s30, s41, 0
    buffer_load_dwordx4 v0, s[12:15], s30 offen lds
    s_add_u32 m0, s37, 32768
    s_add_u32 s30, s42, 0
    buffer_load_dwordx4 v2, s[16:19], s30 offen lds
    s_add_u32 m0, s36, 33792
    s_add_u32 s30, s41, 10240
    buffer_load_dwordx4 v1, s[12:15], s30 offen lds
    s_add_u32 m0, s37, 33792
    s_add_u32 s30, s42, 15360
    buffer_load_dwordx4 v2, s[16:19], s30 offen lds
    s_add_u32 m0, s36, 34816
    s_add_u32 s30, s41, 20480
    buffer_load_dwordx4 v0, s[12:15], s30 offen lds
    s_add_u32 m0, s37, 34816
    s_add_u32 s30, s42, 30720
    buffer_load_dwordx4 v2, s[16:19], s30 offen lds
    s_add_u32 m0, s36, 35840
    s_add_u32 s30, s41, 30720
    buffer_load_dwordx4 v1, s[12:15], s30 offen lds
    s_add_u32 m0, s37, 35840
    s_add_u32 s30, s42, 46080
    buffer_load_dwordx4 v2, s[16:19], s30 offen lds
    s_lshr_b32 s33, s2, 3
    s_cmp_ge_u32 s33, 8
    s_cbranch_scc1 sequential_preLN__softmax_full_mha__dense_activation_silu__prompt_kernel_nocpf
    s_cmp_lg_u32 s28, 7
    s_cbranch_scc1 sequential_preLN__softmax_full_mha__dense_activation_silu__prompt_kernel_nocpf
    s_getpc_b64 s[44:45]
cpf140_pc:
    s_sub_u32 s44, s44, cpf140_pc-all_code_begin
    s_subb_u32 s45, s45, 0
    s_lshl_b32 s46, s33, 13
    v_lshl_add_u32 v128, v112, 7, s46
    v_min_u32 v128, all_code_end-all_code_begin-4, v128
    global_load_dword v129, v128, s[44:45]
sequential_preLN__softmax_full_mha__dense_activation_silu__prompt_kernel_nocpf:
    s_waitcnt vmcnt(8)
    s_barrier
    s_lshl_b32 s41, s40, 7
    s_add_u32 s41, s41, s34
    s_mul_i32 s42, s40, 245760
    s_add_u32 s42, s42, s35
    s_add_u32 s40, s40, 1
    s_cmp_ge_u32 s40, 10
    s_cselect_b32 s40, 0, s40
    s_add_u32 m0, s36, 65536
    s_add_u32 s30, s41, 0
    buffer_load_dwordx4 v0, s[12:15], s30 offen lds
    s_add_u32 m0, s37, 65536
    s_add_u32 s30, s42, 0
    buffer_load_dwordx4 v2, s[16:19], s30 offen lds
    s_add_u32 m0, s36, 66560
    s_add_u32 s30, s41, 10240
    buffer_load_dwordx4 v1, s[12:15], s30 offen lds
    s_add_u32 m0, s37, 66560
    s_add_u32 s30, s42, 15360
    buffer_load_dwordx4 v2, s[16:19], s30 offen lds
    s_add_u32 m0, s36, 67584
    s_add_u32 s30, s41, 20480
    buffer_load_dwordx4 v0, s[12:15], s30 offen lds
    s_add_u32 m0, s37, 67584
    s_add_u32 s30, s42, 30720
    buffer_load_dwordx4 v2, s[16:19], s30 offen lds
    s_add_u32 m0, s36, 68608
    s_add_u32 s30, s41, 30720
    buffer_load_dwordx4 v1, s[12:15], s30 offen lds
    s_add_u32 m0, s37, 68608
    s_add_u32 s30, s42, 46080
    buffer_load_dwordx4 v2, s[16:19], s30 offen lds
    s_lshl_b32 s41, s40, 7
    s_add_u32 s41, s41, s34
    s_mul_i32 s42, s40, 245760
    s_add_u32 s42, s42, s35
    s_add_u32 s40, s40, 1
    s_cmp_ge_u32 s40, 10
    s_cselect_b32 s40, 0, s40
    s_add_u32 m0, s36, 98304
    s_add_u32 s30, s41, 0
    buffer_load_dwordx4 v0, s[12:15], s30 offen lds
    s_add_u32 m0, s37, 98304
    s_add_u32 s30, s42, 0
    buffer_load_dwordx4 v2, s[16:19], s30 offen lds
    s_add_u32 m0, s36, 99328
    s_add_u32 s30, s41, 10240
    buffer_load_dwordx4 v1, s[12:15], s30 offen lds
    s_add_u32 m0, s37, 99328
    s_add_u32 s30, s42, 15360
    buffer_load_dwordx4 v2, s[16:19], s30 offen lds
    s_add_u32 m0, s36, 100352
    s_add_u32 s30, s41, 20480
    buffer_load_dwordx4 v0, s[12:15], s30 offen lds
    s_add_u32 m0, s37, 100352
    s_add_u32 s30, s42, 30720
    buffer_load_dwordx4 v2, s[16:19], s30 offen lds
    s_add_u32 m0, s36, 101376
    s_add_u32 s30, s41, 30720
    buffer_load_dwordx4 v1, s[12:15], s30 offen lds
    s_add_u32 m0, s37, 101376
    s_add_u32 s30, s42, 46080
    buffer_load_dwordx4 v2, s[16:19], s30 offen lds
    s_load_dwordx2 s[46:47], s[0:1], 56
    s_add_u32 s20, s8, 24305664
    s_addc_u32 s21, s9, 0
    s_and_b32 s21, s21, 0xffff
    s_mov_b32 s22, 16384
    s_mov_b32 s23, 0x20000
    s_lshl_b32 s48, s24, 2
    v_mov_b32 v8, s48
    v_lshlrev_b32 v9, 4, v112
    v_mov_b32 v10, 0
    s_lshl_b32 s48, s24, 10
    s_waitcnt lgkmcnt(0)
    v_cmp_eq_u32 vcc, 0, v112
    v_mov_b32 v11, 64
    s_nop 0
    v_cndmask_b32 v8, v11, v8, vcc
    s_waitcnt vmcnt(16)
    s_barrier
    s_lshl_b32 s41, s40, 7
    s_add_u32 s41, s41, s34
    s_mul_i32 s42, s40, 245760
    s_add_u32 s42, s42, s35
    s_add_u32 s40, s40, 1
    s_cmp_ge_u32 s40, 10
    s_cselect_b32 s40, 0, s40
    s_add_u32 m0, s36, 131072
    s_add_u32 s30, s41, 0
    buffer_load_dwordx4 v0, s[12:15], s30 offen lds
    s_add_u32 m0, s37, 131072
    s_add_u32 s30, s42, 0
    buffer_load_dwordx4 v2, s[16:19], s30 offen lds
    s_add_u32 m0, s36, 132096
    s_add_u32 s30, s41, 10240
    buffer_load_dwordx4 v1, s[12:15], s30 offen lds
    s_add_u32 m0, s37, 132096
    s_add_u32 s30, s42, 15360
    buffer_load_dwordx4 v2, s[16:19], s30 offen lds
    s_add_u32 m0, s36, 133120
    s_add_u32 s30, s41, 20480
    buffer_load_dwordx4 v0, s[12:15], s30 offen lds
    s_add_u32 m0, s37, 133120
    s_add_u32 s30, s42, 30720
    buffer_load_dwordx4 v2, s[16:19], s30 offen lds
    s_add_u32 m0, s36, 134144
    s_add_u32 s30, s41, 30720
    buffer_load_dwordx4 v1, s[12:15], s30 offen lds
    s_add_u32 m0, s37, 134144
    s_add_u32 s30, s42, 46080
    buffer_load_dwordx4 v2, s[16:19], s30 offen lds
    s_waitcnt vmcnt(16)
    s_barrier
    s_lshl_b32 s41, s40, 7
    s_add_u32 s41, s41, s34
    s_mul_i32 s42, s40, 245760
    s_add_u32 s42, s42, s35
    s_add_u32 s40, s40, 1
    s_cmp_ge_u32 s40, 10
    s_cselect_b32 s40, 0, s40
    s_add_u32 m0, s36, 0
    s_add_u32 s30, s41, 0
    buffer_load_dwordx4 v0, s[12:15], s30 offen lds
    s_add_u32 m0, s37, 0
    s_add_u32 s30, s42, 0
    buffer_load_dwordx4 v2, s[16:19], s30 offen lds
    s_add_u32 m0, s36, 1024
    s_add_u32 s30, s41, 10240
    buffer_load_dwordx4 v1, s[12:15], s30 offen lds
    s_add_u32 m0, s37, 1024
    s_add_u32 s30, s42, 15360
    buffer_load_dwordx4 v2, s[16:19], s30 offen lds
    s_add_u32 m0, s36, 2048
    s_add_u32 s30, s41, 20480
    buffer_load_dwordx4 v0, s[12:15], s30 offen lds
    s_add_u32 m0, s37, 2048
    s_add_u32 s30, s42, 30720
    buffer_load_dwordx4 v2, s[16:19], s30 offen lds
    s_add_u32 m0, s36, 3072
    s_add_u32 s30, s41, 30720
    buffer_load_dwordx4 v1, s[12:15], s30 offen lds
    s_add_u32 m0, s37, 3072
    s_add_u32 s30, s42, 46080
    buffer_load_dwordx4 v2, s[16:19], s30 offen lds
    s_waitcnt vmcnt(16)
    s_barrier
    s_lshl_b32 s41, s40, 7
    s_add_u32 s41, s41, s34
    s_mul_i32 s42, s40, 245760
    s_add_u32 s42, s42, s35
    s_add_u32 s40, s40, 1
    s_cmp_ge_u32 s40, 10
    s_cselect_b32 s40, 0, s40
    s_add_u32 m0, s36, 32768
    s_add_u32 s30, s41, 0
    buffer_load_dwordx4 v0, s[12:15], s30 offen lds
    s_add_u32 m0, s37, 32768
    s_add_u32 s30, s42, 0
    buffer_load_dwordx4 v2, s[16:19], s30 offen lds
    s_add_u32 m0, s36, 33792
    s_add_u32 s30, s41, 10240
    buffer_load_dwordx4 v1, s[12:15], s30 offen lds
    s_add_u32 m0, s37, 33792
    s_add_u32 s30, s42, 15360
    buffer_load_dwordx4 v2, s[16:19], s30 offen lds
    s_add_u32 m0, s36, 34816
    s_add_u32 s30, s41, 20480
    buffer_load_dwordx4 v0, s[12:15], s30 offen lds
    s_add_u32 m0, s37, 34816
    s_add_u32 s30, s42, 30720
    buffer_load_dwordx4 v2, s[16:19], s30 offen lds
    s_add_u32 m0, s36, 35840
    s_add_u32 s30, s41, 30720
    buffer_load_dwordx4 v1, s[12:15], s30 offen lds
    s_add_u32 m0, s37, 35840
    s_add_u32 s30, s42, 46080
    buffer_load_dwordx4 v2, s[16:19], s30 offen lds
    s_waitcnt vmcnt(16)
    s_barrier
    s_lshl_b32 s41, s40, 7
    s_add_u32 s41, s41, s34
    s_mul_i32 s42, s40, 245760
    s_add_u32 s42, s42, s35
    s_add_u32 s40, s40, 1
    s_cmp_ge_u32 s40, 10
    s_cselect_b32 s40, 0, s40
    s_add_u32 m0, s36, 65536
    s_add_u32 s30, s41, 0
    buffer_load_dwordx4 v0, s[12:15], s30 offen lds
    s_add_u32 m0, s37, 65536
    s_add_u32 s30, s42, 0
    buffer_load_dwordx4 v2, s[16:19], s30 offen lds
    s_add_u32 m0, s36, 66560
    s_add_u32 s30, s41, 10240
    buffer_load_dwordx4 v1, s[12:15], s30 offen lds
    s_add_u32 m0, s37, 66560
    s_add_u32 s30, s42, 15360
    buffer_load_dwordx4 v2, s[16:19], s30 offen lds
    s_add_u32 m0, s36, 67584
    s_add_u32 s30, s41, 20480
    buffer_load_dwordx4 v0, s[12:15], s30 offen lds
    s_add_u32 m0, s37, 67584
    s_add_u32 s30, s42, 30720
    buffer_load_dwordx4 v2, s[16:19], s30 offen lds
    s_add_u32 m0, s36, 68608
    s_add_u32 s30, s41, 30720
    buffer_load_dwordx4 v1, s[12:15], s30 offen lds
    s_add_u32 m0, s37, 68608
    s_add_u32 s30, s42, 46080
    buffer_load_dwordx4 v2, s[16:19], s30 offen lds
    s_waitcnt vmcnt(16)
    s_barrier
    s_lshl_b32 s41, s40, 7
    s_add_u32 s41, s41, s34
    s_mul_i32 s42, s40, 245760
    s_add_u32 s42, s42, s35
    s_add_u32 s40, s40, 1
    s_cmp_ge_u32 s40, 10
    s_cselect_b32 s40, 0, s40
    s_add_u32 m0, s36, 98304
    s_add_u32 s30, s41, 0
    buffer_load_dwordx4 v0, s[12:15], s30 offen lds
    s_add_u32 m0, s37, 98304
    s_add_u32 s30, s42, 0
    buffer_load_dwordx4 v2, s[16:19], s30 offen lds
    s_add_u32 m0, s36, 99328
    s_add_u32 s30, s41, 10240
    buffer_load_dwordx4 v1, s[12:15], s30 offen lds
    s_add_u32 m0, s37, 99328
    s_add_u32 s30, s42, 15360
    buffer_load_dwordx4 v2, s[16:19], s30 offen lds
    s_add_u32 m0, s36, 100352
    s_add_u32 s30, s41, 20480
    buffer_load_dwordx4 v0, s[12:15], s30 offen lds
    s_add_u32 m0, s37, 100352
    s_add_u32 s30, s42, 30720
    buffer_load_dwordx4 v2, s[16:19], s30 offen lds
    s_add_u32 m0, s36, 101376
    s_add_u32 s30, s41, 30720
    buffer_load_dwordx4 v1, s[12:15], s30 offen lds
    s_add_u32 m0, s37, 101376
    s_add_u32 s30, s42, 46080
    buffer_load_dwordx4 v2, s[16:19], s30 offen lds
    s_waitcnt vmcnt(16)
    s_barrier
    s_lshl_b32 s41, s40, 7
    s_add_u32 s41, s41, s34
    s_mul_i32 s42, s40, 245760
    s_add_u32 s42, s42, s35
    s_add_u32 s40, s40, 1
    s_cmp_ge_u32 s40, 10
    s_cselect_b32 s40, 0, s40
    s_add_u32 m0, s36, 131072
    s_add_u32 s30, s41, 0
    buffer_load_dwordx4 v0, s[12:15], s30 offen lds
    s_add_u32 m0, s37, 131072
    s_add_u32 s30, s42, 0
    buffer_load_dwordx4 v2, s[16:19], s30 offen lds
    s_add_u32 m0, s36, 132096
    s_add_u32 s30, s41, 10240
    buffer_load_dwordx4 v1, s[12:15], s30 offen lds
    s_add_u32 m0, s37, 132096
    s_add_u32 s30, s42, 15360
    buffer_load_dwordx4 v2, s[16:19], s30 offen lds
    s_add_u32 m0, s36, 133120
    s_add_u32 s30, s41, 20480
    buffer_load_dwordx4 v0, s[12:15], s30 offen lds
    s_add_u32 m0, s37, 133120
    s_add_u32 s30, s42, 30720
    buffer_load_dwordx4 v2, s[16:19], s30 offen lds
    s_add_u32 m0, s36, 134144
    s_add_u32 s30, s41, 30720
    buffer_load_dwordx4 v1, s[12:15], s30 offen lds
    s_add_u32 m0, s37, 134144
    s_add_u32 s30, s42, 46080
    buffer_load_dwordx4 v2, s[16:19], s30 offen lds
    s_waitcnt vmcnt(16)
    s_barrier
    s_cmp_lg_u32 s28, 4
    s_cbranch_scc1 sequential_preLN__softmax_full_mha__dense_activation_silu__prompt_kernel_d0a
    global_load_dword v10, v8, s[46:47]
sequential_preLN__softmax_full_mha__dense_activation_silu__prompt_kernel_d0a:
    s_waitcnt vmcnt(8)
    s_barrier
    s_cmp_lg_u32 s28, 4
    s_cbranch_scc1 sequential_preLN__softmax_full_mha__dense_activation_silu__prompt_kernel_d0b
    s_waitcnt vmcnt(0)
    s_mov_b32 s31, 262144
sequential_preLN__softmax_full_mha__dense_activation_silu__prompt_kernel_fp:
    v_cmp_eq_u32 vcc, 0, v10
    s_cbranch_vccz sequential_preLN__softmax_full_mha__dense_activation_silu__prompt_kernel_fp_d
    global_load_dword v10, v8, s[46:47] sc1
    s_waitcnt vmcnt(0)
    s_sub_u32 s31, s31, 1
    s_cmp_lg_u32 s31, 0
    s_cbranch_scc1 sequential_preLN__softmax_full_mha__dense_activation_silu__prompt_kernel_fp
sequential_preLN__softmax_full_mha__dense_activation_silu__prompt_kernel_fp_d:
    buffer_load_dwordx4 v[12:15], v9, s[20:23], s48 offen sc1
sequential_preLN__softmax_full_mha__dense_activation_silu__prompt_kernel_d0b:
    s_cmp_eq_u32 s28, 4
    s_cbranch_scc1 sequential_preLN__softmax_full_mha__dense_activation_silu__prompt_kernel_nw9
    s_waitcnt vmcnt(0)
sequential_preLN__softmax_full_mha__dense_activation_silu__prompt_kernel_nw9:
    s_barrier
    s_cmp_lg_u32 s28, 4
    s_cbranch_scc1 sequential_preLN__softmax_full_mha__dense_activation_silu__prompt_kernel_d0c
    s_waitcnt vmcnt(0)
    ds_write_b128 v9, v[12:15] offset:1024
    s_waitcnt lgkmcnt(0)
sequential_preLN__softmax_full_mha__dense_activation_silu__prompt_kernel_d0c:
    s_barrier
    s_branch sequential_preLN__softmax_full_mha__dense_activation_silu__prompt_kernel_p1d
sequential_preLN__softmax_full_mha__dense_activation_silu__prompt_kernel_M:
    s_waitcnt lgkmcnt(0)
    s_mov_b32 s20, s8
    s_and_b32 s21, s9, 0xffff
    s_mov_b32 s22, 7864320
    s_mov_b32 s23, 0x20000
    s_setprio 2
    v_lshlrev_b32 v116, 7, v113
    s_lshl_b32 s30, s29, 12
    v_add_u32 v116, s30, v116
    v_bfe_u32 v117, v113, 1, 3
    v_add_u32 v118, 0, v114
    v_xor_b32 v118, v118, v117
    v_lshl_add_u32 v88, v118, 4, v116
    v_add_u32 v118, 2, v114
    v_xor_b32 v118, v118, v117
    v_lshl_add_u32 v89, v118, 4, v116
    v_add_u32 v118, 4, v114
    v_xor_b32 v118, v118, v117
    v_lshl_add_u32 v90, v118, 4, v116
    v_add_u32 v118, 6, v114
    v_xor_b32 v118, v118, v117
    v_lshl_add_u32 v91, v118, 4, v116
    v_bfe_u32 v116, v112, 2, 2
    v_lshl_add_u32 v117, v114, 3, v116
    v_lshlrev_b32 v117, 8, v117
    v_bfe_u32 v118, v112, 4, 1
    v_lshlrev_b32 v118, 1, v118
    v_bfe_u32 v119, v112, 1, 1
    v_add_u32 v118, v118, v119
    v_lshl_add_u32 v117, v118, 4, v117
    v_and_b32 v119, 1, v112
    v_lshl_add_u32 v117, v119, 3, v117
    v_add_u32 v117, 16384, v117
    s_add_u32 s30, s29, 0
    s_and_b32 s30, s30, 3
    v_xor_b32 v118, s30, v116
    v_lshl_add_u32 v92, v118, 6, v117
    s_add_u32 s30, s29, 1
    s_and_b32 s30, s30, 3
    v_xor_b32 v118, s30, v116
    v_lshl_add_u32 v93, v118, 6, v117
    s_add_u32 s30, s29, 2
    s_and_b32 s30, s30, 3
    v_xor_b32 v118, s30, v116
    v_lshl_add_u32 v94, v118, 6, v117
    s_add_u32 s30, s29, 3
    s_and_b32 s30, s30, 3
    v_xor_b32 v118, s30, v116
    v_lshl_add_u32 v95, v118, 6, v117
    v_and_b32 v116, 15, v112
    v_bfe_u32 v117, v112, 4, 1
    v_cmp_eq_u32 vcc, v116, v117
    v_mov_b32 v118, 0x3f803f80
    s_nop 0
    v_cndmask_b32 v164, 0, v118, vcc
    v_mov_b32 v165, v164
    v_mov_b32 v166, v164
    v_mov_b32 v167, v164
    s_cmp_eq_u32 s27, 2
    s_cbranch_scc1 sequential_preLN__softmax_full_mha__dense_activation_silu__prompt_kernel_addr_v
    s_cmp_eq_u32 s27, 0
    s_mov_b32 s39, 0
    s_cselect_b32 s39, 5242880, s39
    s_lshl_b32 s30, s24, 2
    s_add_u32 s30, s30, s29
    s_mul_i32 s30, s30, 40960
    s_add_u32 s39, s39, s30
    s_lshl_b32 s30, s26, 13
    s_add_u32 s39, s39, s30
    v_lshlrev_b32 v96, 4, v112
    s_barrier
    ds_read_b128 v[80:83], v88 offset:0
    ds_read_b64_tr_b16 v[64:65], v92 offset:0
    ds_read_b64_tr_b16 v[66:67], v92 offset:1024
    ds_read_b64_tr_b16 v[68:69], v93 offset:0
    ds_read_b64_tr_b16 v[70:71], v93 offset:1024
    ds_read_b64_tr_b16 v[72:73], v94 offset:0
    ds_read_b64_tr_b16 v[74:75], v94 offset:1024
    ds_read_b64_tr_b16 v[76:77], v95 offset:0
    ds_read_b64_tr_b16 v[78:79], v95 offset:1024
    ds_read_b128 v[84:87], v89 offset:0
    s_waitcnt lgkmcnt(7)
    v_mfma_f32_32x32x16_bf16 v[0:15], v[64:67], v[80:83], 0
    v_mfma_f32_16x16x32_bf16 v[160:163], v[164:167], v[64:67], 0
    ds_read_b64_tr_b16 v[64:65], v92 offset:4096
    ds_read_b64_tr_b16 v[66:67], v92 offset:5120
    s_waitcnt lgkmcnt(7)
    v_mfma_f32_32x32x16_bf16 v[16:31], v[68:71], v[80:83], 0
    ds_read_b64_tr_b16 v[68:69], v93 offset:4096
    ds_read_b64_tr_b16 v[70:71], v93 offset:5120
    s_waitcnt lgkmcnt(7)
    v_mfma_f32_32x32x16_bf16 v[32:47], v[72:75], v[80:83], 0
    ds_read_b64_tr_b16 v[72:73], v94 offset:4096
    ds_read_b64_tr_b16 v[74:75], v94 offset:5120
    s_waitcnt lgkmcnt(7)
    v_mfma_f32_32x32x16_bf16 v[48:63], v[76:79], v[80:83], 0
    ds_read_b64_tr_b16 v[76:77], v95 offset:4096
    ds_read_b64_tr_b16 v[78:79], v95 offset:5120
    ds_read_b128 v[80:83], v90 offset:0
    s_waitcnt lgkmcnt(7)
    v_mfma_f32_32x32x16_bf16 v[0:15], v[64:67], v[84:87], v[0:15]
    v_mfma_f32_16x16x32_bf16 v[160:163], v[164:167], v[64:67], v[160:163]
    ds_read_b64_tr_b16 v[64:65], v92 offset:8192
    ds_read_b64_tr_b16 v[66:67], v92 offset:9216
    s_waitcnt lgkmcnt(7)
    v_mfma_f32_32x32x16_bf16 v[16:31], v[68:71], v[84:87], v[16:31]
    ds_read_b64_tr_b16 v[68:69], v93 offset:8192
    ds_read_b64_tr_b16 v[70:71], v93 offset:9216
    s_waitcnt lgkmcnt(7)
    v_mfma_f32_32x32x16_bf16 v[32:47], v[72:75], v[84:87], v[32:47]
    ds_read_b64_tr_b16 v[72:73], v94 offset:8192
    ds_read_b64_tr_b16 v[74:75], v94 offset:9216
    s_waitcnt lgkmcnt(7)
    v_mfma_f32_32x32x16_bf16 v[48:63], v[76:79], v[84:87], v[48:63]
    ds_read_b64_tr_b16 v[76:77], v95 offset:8192
    ds_read_b64_tr_b16 v[78:79], v95 offset:9216
    ds_read_b128 v[84:87], v91 offset:0
    s_waitcnt lgkmcnt(7)
    v_mfma_f32_32x32x16_bf16 v[0:15], v[64:67], v[80:83], v[0:15]
    v_mfma_f32_16x16x32_bf16 v[160:163], v[164:167], v[64:67], v[160:163]
    ds_read_b64_tr_b16 v[64:65], v92 offset:12288
    ds_read_b64_tr_b16 v[66:67], v92 offset:13312
    s_waitcnt lgkmcnt(7)
    v_mfma_f32_32x32x16_bf16 v[16:31], v[68:71], v[80:83], v[16:31]
    ds_read_b64_tr_b16 v[68:69], v93 offset:12288
    ds_read_b64_tr_b16 v[70:71], v93 offset:13312
    s_waitcnt lgkmcnt(7)
    v_mfma_f32_32x32x16_bf16 v[32:47], v[72:75], v[80:83], v[32:47]
    ds_read_b64_tr_b16 v[72:73], v94 offset:12288
    ds_read_b64_tr_b16 v[74:75], v94 offset:13312
    s_waitcnt lgkmcnt(7)
    v_mfma_f32_32x32x16_bf16 v[48:63], v[76:79], v[80:83], v[48:63]
    ds_read_b64_tr_b16 v[76:77], v95 offset:12288
    ds_read_b64_tr_b16 v[78:79], v95 offset:13312
    s_barrier
    ds_read_b128 v[80:83], v88 offset:32768
    s_waitcnt lgkmcnt(7)
    v_mfma_f32_32x32x16_bf16 v[0:15], v[64:67], v[84:87], v[0:15]
    v_mfma_f32_16x16x32_bf16 v[160:163], v[164:167], v[64:67], v[160:163]
    ds_read_b64_tr_b16 v[64:65], v92 offset:32768
    ds_read_b64_tr_b16 v[66:67], v92 offset:33792
    s_waitcnt lgkmcnt(7)
    v_mfma_f32_32x32x16_bf16 v[16:31], v[68:71], v[84:87], v[16:31]
    ds_read_b64_tr_b16 v[68:69], v93 offset:32768
    ds_read_b64_tr_b16 v[70:71], v93 offset:33792
    s_waitcnt lgkmcnt(7)
    v_mfma_f32_32x32x16_bf16 v[32:47], v[72:75], v[84:87], v[32:47]
    ds_read_b64_tr_b16 v[72:73], v94 offset:32768
    ds_read_b64_tr_b16 v[74:75], v94 offset:33792
    s_waitcnt lgkmcnt(7)
    v_mfma_f32_32x32x16_bf16 v[48:63], v[76:79], v[84:87], v[48:63]
    ds_read_b64_tr_b16 v[76:77], v95 offset:32768
    ds_read_b64_tr_b16 v[78:79], v95 offset:33792
    ds_read_b128 v[84:87], v89 offset:32768
    s_waitcnt lgkmcnt(7)
    v_mfma_f32_32x32x16_bf16 v[0:15], v[64:67], v[80:83], v[0:15]
    v_mfma_f32_16x16x32_bf16 v[160:163], v[164:167], v[64:67], v[160:163]
    ds_read_b64_tr_b16 v[64:65], v92 offset:36864
    ds_read_b64_tr_b16 v[66:67], v92 offset:37888
    s_waitcnt lgkmcnt(7)
    v_mfma_f32_32x32x16_bf16 v[16:31], v[68:71], v[80:83], v[16:31]
    ds_read_b64_tr_b16 v[68:69], v93 offset:36864
    ds_read_b64_tr_b16 v[70:71], v93 offset:37888
    s_waitcnt lgkmcnt(7)
    v_mfma_f32_32x32x16_bf16 v[32:47], v[72:75], v[80:83], v[32:47]
    ds_read_b64_tr_b16 v[72:73], v94 offset:36864
    ds_read_b64_tr_b16 v[74:75], v94 offset:37888
    s_waitcnt lgkmcnt(7)
    v_mfma_f32_32x32x16_bf16 v[48:63], v[76:79], v[80:83], v[48:63]
    ds_read_b64_tr_b16 v[76:77], v95 offset:36864
    ds_read_b64_tr_b16 v[78:79], v95 offset:37888
    ds_read_b128 v[80:83], v90 offset:32768
    s_waitcnt lgkmcnt(7)
    v_mfma_f32_32x32x16_bf16 v[0:15], v[64:67], v[84:87], v[0:15]
    v_mfma_f32_16x16x32_bf16 v[160:163], v[164:167], v[64:67], v[160:163]
    ds_read_b64_tr_b16 v[64:65], v92 offset:40960
    ds_read_b64_tr_b16 v[66:67], v92 offset:41984
    s_waitcnt lgkmcnt(7)
    v_mfma_f32_32x32x16_bf16 v[16:31], v[68:71], v[84:87], v[16:31]
    ds_read_b64_tr_b16 v[68:69], v93 offset:40960
    ds_read_b64_tr_b16 v[70:71], v93 offset:41984
    s_waitcnt lgkmcnt(7)
    v_mfma_f32_32x32x16_bf16 v[32:47], v[72:75], v[84:87], v[32:47]
    ds_read_b64_tr_b16 v[72:73], v94 offset:40960
    ds_read_b64_tr_b16 v[74:75], v94 offset:41984
    s_waitcnt lgkmcnt(7)
    v_mfma_f32_32x32x16_bf16 v[48:63], v[76:79], v[84:87], v[48:63]
    ds_read_b64_tr_b16 v[76:77], v95 offset:40960
    ds_read_b64_tr_b16 v[78:79], v95 offset:41984
    ds_read_b128 v[84:87], v91 offset:32768
    s_waitcnt lgkmcnt(7)
    v_mfma_f32_32x32x16_bf16 v[0:15], v[64:67], v[80:83], v[0:15]
    v_mfma_f32_16x16x32_bf16 v[160:163], v[164:167], v[64:67], v[160:163]
    ds_read_b64_tr_b16 v[64:65], v92 offset:45056
    ds_read_b64_tr_b16 v[66:67], v92 offset:46080
    s_waitcnt lgkmcnt(7)
    v_mfma_f32_32x32x16_bf16 v[16:31], v[68:71], v[80:83], v[16:31]
    ds_read_b64_tr_b16 v[68:69], v93 offset:45056
    ds_read_b64_tr_b16 v[70:71], v93 offset:46080
    s_waitcnt lgkmcnt(7)
    v_mfma_f32_32x32x16_bf16 v[32:47], v[72:75], v[80:83], v[32:47]
    ds_read_b64_tr_b16 v[72:73], v94 offset:45056
    ds_read_b64_tr_b16 v[74:75], v94 offset:46080
    s_waitcnt lgkmcnt(7)
    v_mfma_f32_32x32x16_bf16 v[48:63], v[76:79], v[80:83], v[48:63]
    ds_read_b64_tr_b16 v[76:77], v95 offset:45056
    ds_read_b64_tr_b16 v[78:79], v95 offset:46080
    s_barrier
    v_add_u32 v88, 65536, v88
    ds_read_b128 v[80:83], v88 offset:0
    s_waitcnt lgkmcnt(7)
    v_mfma_f32_32x32x16_bf16 v[0:15], v[64:67], v[84:87], v[0:15]
    v_mfma_f32_16x16x32_bf16 v[160:163], v[164:167], v[64:67], v[160:163]
    v_add_u32 v92, 65536, v92
    v_add_u32 v89, 65536, v89
    ds_read_b64_tr_b16 v[64:65], v92 offset:0
    ds_read_b64_tr_b16 v[66:67], v92 offset:1024
    s_waitcnt lgkmcnt(7)
    v_mfma_f32_32x32x16_bf16 v[16:31], v[68:71], v[84:87], v[16:31]
    v_add_u32 v93, 65536, v93
    v_add_u32 v90, 65536, v90
    ds_read_b64_tr_b16 v[68:69], v93 offset:0
    ds_read_b64_tr_b16 v[70:71], v93 offset:1024
    s_waitcnt lgkmcnt(7)
    v_mfma_f32_32x32x16_bf16 v[32:47], v[72:75], v[84:87], v[32:47]
    v_add_u32 v94, 65536, v94
    v_add_u32 v91, 65536, v91
    ds_read_b64_tr_b16 v[72:73], v94 offset:0
    ds_read_b64_tr_b16 v[74:75], v94 offset:1024
    s_waitcnt lgkmcnt(7)
    v_mfma_f32_32x32x16_bf16 v[48:63], v[76:79], v[84:87], v[48:63]
    v_add_u32 v95, 65536, v95
    ds_read_b64_tr_b16 v[76:77], v95 offset:0
    ds_read_b64_tr_b16 v[78:79], v95 offset:1024
    ds_read_b128 v[84:87], v89 offset:0
    s_waitcnt lgkmcnt(7)
    v_mfma_f32_32x32x16_bf16 v[0:15], v[64:67], v[80:83], v[0:15]
    v_mfma_f32_16x16x32_bf16 v[160:163], v[164:167], v[64:67], v[160:163]
    ds_read_b64_tr_b16 v[64:65], v92 offset:4096
    ds_read_b64_tr_b16 v[66:67], v92 offset:5120
    s_waitcnt lgkmcnt(7)
    v_mfma_f32_32x32x16_bf16 v[16:31], v[68:71], v[80:83], v[16:31]
    ds_read_b64_tr_b16 v[68:69], v93 offset:4096
    ds_read_b64_tr_b16 v[70:71], v93 offset:5120
    s_waitcnt lgkmcnt(7)
    v_mfma_f32_32x32x16_bf16 v[32:47], v[72:75], v[80:83], v[32:47]
    ds_read_b64_tr_b16 v[72:73], v94 offset:4096
    ds_read_b64_tr_b16 v[74:75], v94 offset:5120
    s_waitcnt lgkmcnt(7)
    v_mfma_f32_32x32x16_bf16 v[48:63], v[76:79], v[80:83], v[48:63]
    ds_read_b64_tr_b16 v[76:77], v95 offset:4096
    ds_read_b64_tr_b16 v[78:79], v95 offset:5120
    ds_read_b128 v[80:83], v90 offset:0
    s_waitcnt lgkmcnt(7)
    v_mfma_f32_32x32x16_bf16 v[0:15], v[64:67], v[84:87], v[0:15]
    v_mfma_f32_16x16x32_bf16 v[160:163], v[164:167], v[64:67], v[160:163]
    ds_read_b64_tr_b16 v[64:65], v92 offset:8192
    ds_read_b64_tr_b16 v[66:67], v92 offset:9216
    s_waitcnt lgkmcnt(7)
    v_mfma_f32_32x32x16_bf16 v[16:31], v[68:71], v[84:87], v[16:31]
    ds_read_b64_tr_b16 v[68:69], v93 offset:8192
    ds_read_b64_tr_b16 v[70:71], v93 offset:9216
    s_waitcnt lgkmcnt(7)
    v_mfma_f32_32x32x16_bf16 v[32:47], v[72:75], v[84:87], v[32:47]
    ds_read_b64_tr_b16 v[72:73], v94 offset:8192
    ds_read_b64_tr_b16 v[74:75], v94 offset:9216
    s_waitcnt lgkmcnt(7)
    v_mfma_f32_32x32x16_bf16 v[48:63], v[76:79], v[84:87], v[48:63]
    ds_read_b64_tr_b16 v[76:77], v95 offset:8192
    ds_read_b64_tr_b16 v[78:79], v95 offset:9216
    ds_read_b128 v[84:87], v91 offset:0
    s_waitcnt lgkmcnt(7)
    v_mfma_f32_32x32x16_bf16 v[0:15], v[64:67], v[80:83], v[0:15]
    v_mfma_f32_16x16x32_bf16 v[160:163], v[164:167], v[64:67], v[160:163]
    ds_read_b64_tr_b16 v[64:65], v92 offset:12288
    ds_read_b64_tr_b16 v[66:67], v92 offset:13312
    s_waitcnt lgkmcnt(7)
    v_mfma_f32_32x32x16_bf16 v[16:31], v[68:71], v[80:83], v[16:31]
    ds_read_b64_tr_b16 v[68:69], v93 offset:12288
    ds_read_b64_tr_b16 v[70:71], v93 offset:13312
    s_waitcnt lgkmcnt(7)
    v_mfma_f32_32x32x16_bf16 v[32:47], v[72:75], v[80:83], v[32:47]
    ds_read_b64_tr_b16 v[72:73], v94 offset:12288
    ds_read_b64_tr_b16 v[74:75], v94 offset:13312
    s_waitcnt lgkmcnt(7)
    v_mfma_f32_32x32x16_bf16 v[48:63], v[76:79], v[80:83], v[48:63]
    ds_read_b64_tr_b16 v[76:77], v95 offset:12288
    ds_read_b64_tr_b16 v[78:79], v95 offset:13312
    s_barrier
    ds_read_b128 v[80:83], v88 offset:32768
    s_waitcnt lgkmcnt(7)
    v_mfma_f32_32x32x16_bf16 v[0:15], v[64:67], v[84:87], v[0:15]
    v_mfma_f32_16x16x32_bf16 v[160:163], v[164:167], v[64:67], v[160:163]
    ds_read_b64_tr_b16 v[64:65], v92 offset:32768
    ds_read_b64_tr_b16 v[66:67], v92 offset:33792
    s_waitcnt lgkmcnt(7)
    v_mfma_f32_32x32x16_bf16 v[16:31], v[68:71], v[84:87], v[16:31]
    ds_read_b64_tr_b16 v[68:69], v93 offset:32768
    ds_read_b64_tr_b16 v[70:71], v93 offset:33792
    s_waitcnt lgkmcnt(7)
    v_mfma_f32_32x32x16_bf16 v[32:47], v[72:75], v[84:87], v[32:47]
    ds_read_b64_tr_b16 v[72:73], v94 offset:32768
    ds_read_b64_tr_b16 v[74:75], v94 offset:33792
    s_waitcnt lgkmcnt(7)
    v_mfma_f32_32x32x16_bf16 v[48:63], v[76:79], v[84:87], v[48:63]
    ds_read_b64_tr_b16 v[76:77], v95 offset:32768
    ds_read_b64_tr_b16 v[78:79], v95 offset:33792
    ds_read_b128 v[84:87], v89 offset:32768
    s_waitcnt lgkmcnt(7)
    v_mfma_f32_32x32x16_bf16 v[0:15], v[64:67], v[80:83], v[0:15]
    v_mfma_f32_16x16x32_bf16 v[160:163], v[164:167], v[64:67], v[160:163]
    ds_read_b64_tr_b16 v[64:65], v92 offset:36864
    ds_read_b64_tr_b16 v[66:67], v92 offset:37888
    s_waitcnt lgkmcnt(7)
    v_mfma_f32_32x32x16_bf16 v[16:31], v[68:71], v[80:83], v[16:31]
    ds_read_b64_tr_b16 v[68:69], v93 offset:36864
    ds_read_b64_tr_b16 v[70:71], v93 offset:37888
    s_waitcnt lgkmcnt(7)
    v_mfma_f32_32x32x16_bf16 v[32:47], v[72:75], v[80:83], v[32:47]
    ds_read_b64_tr_b16 v[72:73], v94 offset:36864
    ds_read_b64_tr_b16 v[74:75], v94 offset:37888
    s_waitcnt lgkmcnt(7)
    v_mfma_f32_32x32x16_bf16 v[48:63], v[76:79], v[80:83], v[48:63]
    ds_read_b64_tr_b16 v[76:77], v95 offset:36864
    ds_read_b64_tr_b16 v[78:79], v95 offset:37888
    ds_read_b128 v[80:83], v90 offset:32768
    s_waitcnt lgkmcnt(7)
    v_mfma_f32_32x32x16_bf16 v[0:15], v[64:67], v[84:87], v[0:15]
    v_mfma_f32_16x16x32_bf16 v[160:163], v[164:167], v[64:67], v[160:163]
    ds_read_b64_tr_b16 v[64:65], v92 offset:40960
    ds_read_b64_tr_b16 v[66:67], v92 offset:41984
    s_waitcnt lgkmcnt(7)
    v_mfma_f32_32x32x16_bf16 v[16:31], v[68:71], v[84:87], v[16:31]
    ds_read_b64_tr_b16 v[68:69], v93 offset:40960
    ds_read_b64_tr_b16 v[70:71], v93 offset:41984
    s_waitcnt lgkmcnt(7)
    v_mfma_f32_32x32x16_bf16 v[32:47], v[72:75], v[84:87], v[32:47]
    ds_read_b64_tr_b16 v[72:73], v94 offset:40960
    ds_read_b64_tr_b16 v[74:75], v94 offset:41984
    s_waitcnt lgkmcnt(7)
    v_mfma_f32_32x32x16_bf16 v[48:63], v[76:79], v[84:87], v[48:63]
    ds_read_b64_tr_b16 v[76:77], v95 offset:40960
    ds_read_b64_tr_b16 v[78:79], v95 offset:41984
    ds_read_b128 v[84:87], v91 offset:32768
    s_waitcnt lgkmcnt(7)
    v_mfma_f32_32x32x16_bf16 v[0:15], v[64:67], v[80:83], v[0:15]
    v_mfma_f32_16x16x32_bf16 v[160:163], v[164:167], v[64:67], v[160:163]
    ds_read_b64_tr_b16 v[64:65], v92 offset:45056
    ds_read_b64_tr_b16 v[66:67], v92 offset:46080
    s_waitcnt lgkmcnt(7)
    v_mfma_f32_32x32x16_bf16 v[16:31], v[68:71], v[80:83], v[16:31]
    ds_read_b64_tr_b16 v[68:69], v93 offset:45056
    ds_read_b64_tr_b16 v[70:71], v93 offset:46080
    s_waitcnt lgkmcnt(7)
    v_mfma_f32_32x32x16_bf16 v[32:47], v[72:75], v[80:83], v[32:47]
    ds_read_b64_tr_b16 v[72:73], v94 offset:45056
    ds_read_b64_tr_b16 v[74:75], v94 offset:46080
    s_waitcnt lgkmcnt(7)
    v_mfma_f32_32x32x16_bf16 v[48:63], v[76:79], v[80:83], v[48:63]
    ds_read_b64_tr_b16 v[76:77], v95 offset:45056
    ds_read_b64_tr_b16 v[78:79], v95 offset:46080
    s_barrier
    v_add_u32 v88, 65536, v88
    ds_read_b128 v[80:83], v88 offset:0
    s_waitcnt lgkmcnt(7)
    v_mfma_f32_32x32x16_bf16 v[0:15], v[64:67], v[84:87], v[0:15]
    v_mfma_f32_16x16x32_bf16 v[160:163], v[164:167], v[64:67], v[160:163]
    v_add_u32 v92, 65536, v92
    v_add_u32 v89, 65536, v89
    ds_read_b64_tr_b16 v[64:65], v92 offset:0
    ds_read_b64_tr_b16 v[66:67], v92 offset:1024
    s_waitcnt lgkmcnt(7)
    v_mfma_f32_32x32x16_bf16 v[16:31], v[68:71], v[84:87], v[16:31]
    v_add_u32 v93, 65536, v93
    v_add_u32 v90, 65536, v90
    ds_read_b64_tr_b16 v[68:69], v93 offset:0
    ds_read_b64_tr_b16 v[70:71], v93 offset:1024
    s_waitcnt lgkmcnt(7)
    v_mfma_f32_32x32x16_bf16 v[32:47], v[72:75], v[84:87], v[32:47]
    v_add_u32 v94, 65536, v94
    v_add_u32 v91, 65536, v91
    ds_read_b64_tr_b16 v[72:73], v94 offset:0
    ds_read_b64_tr_b16 v[74:75], v94 offset:1024
    s_waitcnt lgkmcnt(7)
    v_mfma_f32_32x32x16_bf16 v[48:63], v[76:79], v[84:87], v[48:63]
    v_add_u32 v95, 65536, v95
    ds_read_b64_tr_b16 v[76:77], v95 offset:0
    ds_read_b64_tr_b16 v[78:79], v95 offset:1024
    ds_read_b128 v[84:87], v89 offset:0
    s_waitcnt lgkmcnt(7)
    v_mfma_f32_32x32x16_bf16 v[0:15], v[64:67], v[80:83], v[0:15]
    v_mfma_f32_16x16x32_bf16 v[160:163], v[164:167], v[64:67], v[160:163]
    ds_read_b64_tr_b16 v[64:65], v92 offset:4096
    ds_read_b64_tr_b16 v[66:67], v92 offset:5120
    s_waitcnt lgkmcnt(7)
    v_mfma_f32_32x32x16_bf16 v[16:31], v[68:71], v[80:83], v[16:31]
    ds_read_b64_tr_b16 v[68:69], v93 offset:4096
    ds_read_b64_tr_b16 v[70:71], v93 offset:5120
    s_waitcnt lgkmcnt(7)
    v_mfma_f32_32x32x16_bf16 v[32:47], v[72:75], v[80:83], v[32:47]
    ds_read_b64_tr_b16 v[72:73], v94 offset:4096
    ds_read_b64_tr_b16 v[74:75], v94 offset:5120
    s_waitcnt lgkmcnt(7)
    v_mfma_f32_32x32x16_bf16 v[48:63], v[76:79], v[80:83], v[48:63]
    ds_read_b64_tr_b16 v[76:77], v95 offset:4096
    ds_read_b64_tr_b16 v[78:79], v95 offset:5120
    ds_read_b128 v[80:83], v90 offset:0
    s_waitcnt lgkmcnt(7)
    v_mfma_f32_32x32x16_bf16 v[0:15], v[64:67], v[84:87], v[0:15]
    v_mfma_f32_16x16x32_bf16 v[160:163], v[164:167], v[64:67], v[160:163]
    ds_read_b64_tr_b16 v[64:65], v92 offset:8192
    ds_read_b64_tr_b16 v[66:67], v92 offset:9216
    s_waitcnt lgkmcnt(7)
    v_mfma_f32_32x32x16_bf16 v[16:31], v[68:71], v[84:87], v[16:31]
    ds_read_b64_tr_b16 v[68:69], v93 offset:8192
    ds_read_b64_tr_b16 v[70:71], v93 offset:9216
    s_waitcnt lgkmcnt(7)
    v_mfma_f32_32x32x16_bf16 v[32:47], v[72:75], v[84:87], v[32:47]
    ds_read_b64_tr_b16 v[72:73], v94 offset:8192
    ds_read_b64_tr_b16 v[74:75], v94 offset:9216
    s_waitcnt lgkmcnt(7)
    v_mfma_f32_32x32x16_bf16 v[48:63], v[76:79], v[84:87], v[48:63]
    ds_read_b64_tr_b16 v[76:77], v95 offset:8192
    ds_read_b64_tr_b16 v[78:79], v95 offset:9216
    ds_read_b128 v[84:87], v91 offset:0
    s_waitcnt lgkmcnt(7)
    v_mfma_f32_32x32x16_bf16 v[0:15], v[64:67], v[80:83], v[0:15]
    v_mfma_f32_16x16x32_bf16 v[160:163], v[164:167], v[64:67], v[160:163]
    ds_read_b64_tr_b16 v[64:65], v92 offset:12288
    ds_read_b64_tr_b16 v[66:67], v92 offset:13312
    s_waitcnt lgkmcnt(7)
    v_mfma_f32_32x32x16_bf16 v[16:31], v[68:71], v[80:83], v[16:31]
    ds_read_b64_tr_b16 v[68:69], v93 offset:12288
    ds_read_b64_tr_b16 v[70:71], v93 offset:13312
    s_waitcnt lgkmcnt(7)
    v_mfma_f32_32x32x16_bf16 v[32:47], v[72:75], v[80:83], v[32:47]
    ds_read_b64_tr_b16 v[72:73], v94 offset:12288
    ds_read_b64_tr_b16 v[74:75], v94 offset:13312
    s_waitcnt lgkmcnt(7)
    v_mfma_f32_32x32x16_bf16 v[48:63], v[76:79], v[80:83], v[48:63]
    ds_read_b64_tr_b16 v[76:77], v95 offset:12288
    ds_read_b64_tr_b16 v[78:79], v95 offset:13312
    s_barrier
    v_add_u32 v88, 4294836224, v88
    ds_read_b128 v[80:83], v88 offset:0
    s_waitcnt lgkmcnt(7)
    v_mfma_f32_32x32x16_bf16 v[0:15], v[64:67], v[84:87], v[0:15]
    v_mfma_f32_16x16x32_bf16 v[160:163], v[164:167], v[64:67], v[160:163]
    v_add_u32 v92, 4294836224, v92
    v_add_u32 v89, 4294836224, v89
    ds_read_b64_tr_b16 v[64:65], v92 offset:0
    ds_read_b64_tr_b16 v[66:67], v92 offset:1024
    s_waitcnt lgkmcnt(7)
    v_mfma_f32_32x32x16_bf16 v[16:31], v[68:71], v[84:87], v[16:31]
    v_add_u32 v93, 4294836224, v93
    v_add_u32 v90, 4294836224, v90
    ds_read_b64_tr_b16 v[68:69], v93 offset:0
    ds_read_b64_tr_b16 v[70:71], v93 offset:1024
    s_waitcnt lgkmcnt(7)
    v_mfma_f32_32x32x16_bf16 v[32:47], v[72:75], v[84:87], v[32:47]
    v_add_u32 v94, 4294836224, v94
    v_add_u32 v91, 4294836224, v91
    ds_read_b64_tr_b16 v[72:73], v94 offset:0
    ds_read_b64_tr_b16 v[74:75], v94 offset:1024
    s_waitcnt lgkmcnt(7)
    v_mfma_f32_32x32x16_bf16 v[48:63], v[76:79], v[84:87], v[48:63]
    v_add_u32 v95, 4294836224, v95
    ds_read_b64_tr_b16 v[76:77], v95 offset:0
    ds_read_b64_tr_b16 v[78:79], v95 offset:1024
    ds_read_b128 v[84:87], v89 offset:0
    s_waitcnt lgkmcnt(7)
    v_mfma_f32_32x32x16_bf16 v[0:15], v[64:67], v[80:83], v[0:15]
    v_mfma_f32_16x16x32_bf16 v[160:163], v[164:167], v[64:67], v[160:163]
    ds_read_b64_tr_b16 v[64:65], v92 offset:4096
    ds_read_b64_tr_b16 v[66:67], v92 offset:5120
    s_waitcnt lgkmcnt(7)
    v_mfma_f32_32x32x16_bf16 v[16:31], v[68:71], v[80:83], v[16:31]
    ds_read_b64_tr_b16 v[68:69], v93 offset:4096
    ds_read_b64_tr_b16 v[70:71], v93 offset:5120
    s_waitcnt lgkmcnt(7)
    v_mfma_f32_32x32x16_bf16 v[32:47], v[72:75], v[80:83], v[32:47]
    ds_read_b64_tr_b16 v[72:73], v94 offset:4096
    ds_read_b64_tr_b16 v[74:75], v94 offset:5120
    s_waitcnt lgkmcnt(7)
    v_mfma_f32_32x32x16_bf16 v[48:63], v[76:79], v[80:83], v[48:63]
    ds_read_b64_tr_b16 v[76:77], v95 offset:4096
    ds_read_b64_tr_b16 v[78:79], v95 offset:5120
    ds_read_b128 v[80:83], v90 offset:0
    s_waitcnt lgkmcnt(7)
    v_mfma_f32_32x32x16_bf16 v[0:15], v[64:67], v[84:87], v[0:15]
    v_mfma_f32_16x16x32_bf16 v[160:163], v[164:167], v[64:67], v[160:163]
    ds_read_b64_tr_b16 v[64:65], v92 offset:8192
    ds_read_b64_tr_b16 v[66:67], v92 offset:9216
    s_waitcnt lgkmcnt(7)
    v_mfma_f32_32x32x16_bf16 v[16:31], v[68:71], v[84:87], v[16:31]
    ds_read_b64_tr_b16 v[68:69], v93 offset:8192
    ds_read_b64_tr_b16 v[70:71], v93 offset:9216
    s_waitcnt lgkmcnt(7)
    v_mfma_f32_32x32x16_bf16 v[32:47], v[72:75], v[84:87], v[32:47]
    ds_read_b64_tr_b16 v[72:73], v94 offset:8192
    ds_read_b64_tr_b16 v[74:75], v94 offset:9216
    s_waitcnt lgkmcnt(7)
    v_mfma_f32_32x32x16_bf16 v[48:63], v[76:79], v[84:87], v[48:63]
    ds_read_b64_tr_b16 v[76:77], v95 offset:8192
    ds_read_b64_tr_b16 v[78:79], v95 offset:9216
    ds_read_b128 v[84:87], v91 offset:0
    s_waitcnt lgkmcnt(7)
    v_mfma_f32_32x32x16_bf16 v[0:15], v[64:67], v[80:83], v[0:15]
    v_mfma_f32_16x16x32_bf16 v[160:163], v[164:167], v[64:67], v[160:163]
    ds_read_b64_tr_b16 v[64:65], v92 offset:12288
    ds_read_b64_tr_b16 v[66:67], v92 offset:13312
    s_waitcnt lgkmcnt(7)
    v_mfma_f32_32x32x16_bf16 v[16:31], v[68:71], v[80:83], v[16:31]
    ds_read_b64_tr_b16 v[68:69], v93 offset:12288
    ds_read_b64_tr_b16 v[70:71], v93 offset:13312
    s_waitcnt lgkmcnt(7)
    v_mfma_f32_32x32x16_bf16 v[32:47], v[72:75], v[80:83], v[32:47]
    ds_read_b64_tr_b16 v[72:73], v94 offset:12288
    ds_read_b64_tr_b16 v[74:75], v94 offset:13312
    s_waitcnt lgkmcnt(7)
    v_mfma_f32_32x32x16_bf16 v[48:63], v[76:79], v[80:83], v[48:63]
    ds_read_b64_tr_b16 v[76:77], v95 offset:12288
    ds_read_b64_tr_b16 v[78:79], v95 offset:13312
    s_barrier
    ds_read_b128 v[80:83], v88 offset:32768
    s_waitcnt lgkmcnt(7)
    v_mfma_f32_32x32x16_bf16 v[0:15], v[64:67], v[84:87], v[0:15]
    v_mfma_f32_16x16x32_bf16 v[160:163], v[164:167], v[64:67], v[160:163]
    ds_read_b64_tr_b16 v[64:65], v92 offset:32768
    ds_read_b64_tr_b16 v[66:67], v92 offset:33792
    s_waitcnt lgkmcnt(7)
    v_mfma_f32_32x32x16_bf16 v[16:31], v[68:71], v[84:87], v[16:31]
    ds_read_b64_tr_b16 v[68:69], v93 offset:32768
    ds_read_b64_tr_b16 v[70:71], v93 offset:33792
    s_waitcnt lgkmcnt(7)
    v_mfma_f32_32x32x16_bf16 v[32:47], v[72:75], v[84:87], v[32:47]
    ds_read_b64_tr_b16 v[72:73], v94 offset:32768
    ds_read_b64_tr_b16 v[74:75], v94 offset:33792
    s_waitcnt lgkmcnt(7)
    v_mfma_f32_32x32x16_bf16 v[48:63], v[76:79], v[84:87], v[48:63]
    ds_read_b64_tr_b16 v[76:77], v95 offset:32768
    ds_read_b64_tr_b16 v[78:79], v95 offset:33792
    ds_read_b128 v[84:87], v89 offset:32768
    s_waitcnt lgkmcnt(7)
    v_mfma_f32_32x32x16_bf16 v[0:15], v[64:67], v[80:83], v[0:15]
    v_mfma_f32_16x16x32_bf16 v[160:163], v[164:167], v[64:67], v[160:163]
    ds_read_b64_tr_b16 v[64:65], v92 offset:36864
    ds_read_b64_tr_b16 v[66:67], v92 offset:37888
    s_waitcnt lgkmcnt(7)
    v_mfma_f32_32x32x16_bf16 v[16:31], v[68:71], v[80:83], v[16:31]
    ds_read_b64_tr_b16 v[68:69], v93 offset:36864
    ds_read_b64_tr_b16 v[70:71], v93 offset:37888
    s_waitcnt lgkmcnt(7)
    v_mfma_f32_32x32x16_bf16 v[32:47], v[72:75], v[80:83], v[32:47]
    ds_read_b64_tr_b16 v[72:73], v94 offset:36864
    ds_read_b64_tr_b16 v[74:75], v94 offset:37888
    s_waitcnt lgkmcnt(7)
    v_mfma_f32_32x32x16_bf16 v[48:63], v[76:79], v[80:83], v[48:63]
    ds_read_b64_tr_b16 v[76:77], v95 offset:36864
    ds_read_b64_tr_b16 v[78:79], v95 offset:37888
    ds_read_b128 v[80:83], v90 offset:32768
    s_waitcnt lgkmcnt(7)
    v_mfma_f32_32x32x16_bf16 v[0:15], v[64:67], v[84:87], v[0:15]
    v_mfma_f32_16x16x32_bf16 v[160:163], v[164:167], v[64:67], v[160:163]
    ds_read_b64_tr_b16 v[64:65], v92 offset:40960
    ds_read_b64_tr_b16 v[66:67], v92 offset:41984
    s_waitcnt lgkmcnt(7)
    v_mfma_f32_32x32x16_bf16 v[16:31], v[68:71], v[84:87], v[16:31]
    ds_read_b64_tr_b16 v[68:69], v93 offset:40960
    ds_read_b64_tr_b16 v[70:71], v93 offset:41984
    s_waitcnt lgkmcnt(7)
    v_mfma_f32_32x32x16_bf16 v[32:47], v[72:75], v[84:87], v[32:47]
    ds_read_b64_tr_b16 v[72:73], v94 offset:40960
    ds_read_b64_tr_b16 v[74:75], v94 offset:41984
    s_waitcnt lgkmcnt(7)
    v_mfma_f32_32x32x16_bf16 v[48:63], v[76:79], v[84:87], v[48:63]
    ds_read_b64_tr_b16 v[76:77], v95 offset:40960
    ds_read_b64_tr_b16 v[78:79], v95 offset:41984
    ds_read_b128 v[84:87], v91 offset:32768
    s_waitcnt lgkmcnt(7)
    v_mfma_f32_32x32x16_bf16 v[0:15], v[64:67], v[80:83], v[0:15]
    v_mfma_f32_16x16x32_bf16 v[160:163], v[164:167], v[64:67], v[160:163]
    ds_read_b64_tr_b16 v[64:65], v92 offset:45056
    ds_read_b64_tr_b16 v[66:67], v92 offset:46080
    s_waitcnt lgkmcnt(7)
    v_mfma_f32_32x32x16_bf16 v[16:31], v[68:71], v[80:83], v[16:31]
    ds_read_b64_tr_b16 v[68:69], v93 offset:45056
    ds_read_b64_tr_b16 v[70:71], v93 offset:46080
    s_waitcnt lgkmcnt(7)
    v_mfma_f32_32x32x16_bf16 v[32:47], v[72:75], v[80:83], v[32:47]
    ds_read_b64_tr_b16 v[72:73], v94 offset:45056
    ds_read_b64_tr_b16 v[74:75], v94 offset:46080
    s_waitcnt lgkmcnt(7)
    v_mfma_f32_32x32x16_bf16 v[48:63], v[76:79], v[80:83], v[48:63]
    ds_read_b64_tr_b16 v[76:77], v95 offset:45056
    ds_read_b64_tr_b16 v[78:79], v95 offset:46080
    s_barrier
    v_add_u32 v88, 65536, v88
    ds_read_b128 v[80:83], v88 offset:0
    s_waitcnt lgkmcnt(7)
    v_mfma_f32_32x32x16_bf16 v[0:15], v[64:67], v[84:87], v[0:15]
    v_mfma_f32_16x16x32_bf16 v[160:163], v[164:167], v[64:67], v[160:163]
    v_add_u32 v92, 65536, v92
    v_add_u32 v89, 65536, v89
    ds_read_b64_tr_b16 v[64:65], v92 offset:0
    ds_read_b64_tr_b16 v[66:67], v92 offset:1024
    s_waitcnt lgkmcnt(7)
    v_mfma_f32_32x32x16_bf16 v[16:31], v[68:71], v[84:87], v[16:31]
    v_add_u32 v93, 65536, v93
    v_add_u32 v90, 65536, v90
    ds_read_b64_tr_b16 v[68:69], v93 offset:0
    ds_read_b64_tr_b16 v[70:71], v93 offset:1024
    s_waitcnt lgkmcnt(7)
    v_mfma_f32_32x32x16_bf16 v[32:47], v[72:75], v[84:87], v[32:47]
    v_add_u32 v94, 65536, v94
    v_add_u32 v91, 65536, v91
    ds_read_b64_tr_b16 v[72:73], v94 offset:0
    ds_read_b64_tr_b16 v[74:75], v94 offset:1024
    s_waitcnt lgkmcnt(7)
    v_mfma_f32_32x32x16_bf16 v[48:63], v[76:79], v[84:87], v[48:63]
    v_add_u32 v95, 65536, v95
    ds_read_b64_tr_b16 v[76:77], v95 offset:0
    ds_read_b64_tr_b16 v[78:79], v95 offset:1024
    ds_read_b128 v[84:87], v89 offset:0
    s_waitcnt lgkmcnt(7)
    v_mfma_f32_32x32x16_bf16 v[0:15], v[64:67], v[80:83], v[0:15]
    v_mfma_f32_16x16x32_bf16 v[160:163], v[164:167], v[64:67], v[160:163]
    ds_read_b64_tr_b16 v[64:65], v92 offset:4096
    ds_read_b64_tr_b16 v[66:67], v92 offset:5120
    s_waitcnt lgkmcnt(7)
    v_mfma_f32_32x32x16_bf16 v[16:31], v[68:71], v[80:83], v[16:31]
    ds_read_b64_tr_b16 v[68:69], v93 offset:4096
    ds_read_b64_tr_b16 v[70:71], v93 offset:5120
    s_waitcnt lgkmcnt(7)
    v_mfma_f32_32x32x16_bf16 v[32:47], v[72:75], v[80:83], v[32:47]
    ds_read_b64_tr_b16 v[72:73], v94 offset:4096
    ds_read_b64_tr_b16 v[74:75], v94 offset:5120
    s_waitcnt lgkmcnt(7)
    v_mfma_f32_32x32x16_bf16 v[48:63], v[76:79], v[80:83], v[48:63]
    ds_read_b64_tr_b16 v[76:77], v95 offset:4096
    ds_read_b64_tr_b16 v[78:79], v95 offset:5120
    ds_read_b128 v[80:83], v90 offset:0
    s_waitcnt lgkmcnt(7)
    v_mfma_f32_32x32x16_bf16 v[0:15], v[64:67], v[84:87], v[0:15]
    v_mfma_f32_16x16x32_bf16 v[160:163], v[164:167], v[64:67], v[160:163]
    ds_read_b64_tr_b16 v[64:65], v92 offset:8192
    ds_read_b64_tr_b16 v[66:67], v92 offset:9216
    s_waitcnt lgkmcnt(7)
    v_mfma_f32_32x32x16_bf16 v[16:31], v[68:71], v[84:87], v[16:31]
    ds_read_b64_tr_b16 v[68:69], v93 offset:8192
    ds_read_b64_tr_b16 v[70:71], v93 offset:9216
    s_waitcnt lgkmcnt(7)
    v_mfma_f32_32x32x16_bf16 v[32:47], v[72:75], v[84:87], v[32:47]
    ds_read_b64_tr_b16 v[72:73], v94 offset:8192
    ds_read_b64_tr_b16 v[74:75], v94 offset:9216
    s_waitcnt lgkmcnt(7)
    v_mfma_f32_32x32x16_bf16 v[48:63], v[76:79], v[84:87], v[48:63]
    ds_read_b64_tr_b16 v[76:77], v95 offset:8192
    ds_read_b64_tr_b16 v[78:79], v95 offset:9216
    ds_read_b128 v[84:87], v91 offset:0
    s_waitcnt lgkmcnt(7)
    v_mfma_f32_32x32x16_bf16 v[0:15], v[64:67], v[80:83], v[0:15]
    v_mfma_f32_16x16x32_bf16 v[160:163], v[164:167], v[64:67], v[160:163]
    ds_read_b64_tr_b16 v[64:65], v92 offset:12288
    ds_read_b64_tr_b16 v[66:67], v92 offset:13312
    s_waitcnt lgkmcnt(7)
    v_mfma_f32_32x32x16_bf16 v[16:31], v[68:71], v[80:83], v[16:31]
    ds_read_b64_tr_b16 v[68:69], v93 offset:12288
    ds_read_b64_tr_b16 v[70:71], v93 offset:13312
    s_waitcnt lgkmcnt(7)
    v_mfma_f32_32x32x16_bf16 v[32:47], v[72:75], v[80:83], v[32:47]
    ds_read_b64_tr_b16 v[72:73], v94 offset:12288
    ds_read_b64_tr_b16 v[74:75], v94 offset:13312
    s_waitcnt lgkmcnt(7)
    v_mfma_f32_32x32x16_bf16 v[48:63], v[76:79], v[80:83], v[48:63]
    ds_read_b64_tr_b16 v[76:77], v95 offset:12288
    ds_read_b64_tr_b16 v[78:79], v95 offset:13312
    s_barrier
    ds_read_b128 v[80:83], v88 offset:32768
    s_waitcnt lgkmcnt(7)
    v_mfma_f32_32x32x16_bf16 v[0:15], v[64:67], v[84:87], v[0:15]
    v_mfma_f32_16x16x32_bf16 v[160:163], v[164:167], v[64:67], v[160:163]
    ds_read_b64_tr_b16 v[64:65], v92 offset:32768
    ds_read_b64_tr_b16 v[66:67], v92 offset:33792
    s_waitcnt lgkmcnt(7)
    v_mfma_f32_32x32x16_bf16 v[16:31], v[68:71], v[84:87], v[16:31]
    ds_read_b64_tr_b16 v[68:69], v93 offset:32768
    ds_read_b64_tr_b16 v[70:71], v93 offset:33792
    s_waitcnt lgkmcnt(7)
    v_mfma_f32_32x32x16_bf16 v[32:47], v[72:75], v[84:87], v[32:47]
    ds_read_b64_tr_b16 v[72:73], v94 offset:32768
    ds_read_b64_tr_b16 v[74:75], v94 offset:33792
    s_waitcnt lgkmcnt(7)
    v_mfma_f32_32x32x16_bf16 v[48:63], v[76:79], v[84:87], v[48:63]
    ds_read_b64_tr_b16 v[76:77], v95 offset:32768
    ds_read_b64_tr_b16 v[78:79], v95 offset:33792
    ds_read_b128 v[84:87], v89 offset:32768
    s_waitcnt lgkmcnt(7)
    v_mfma_f32_32x32x16_bf16 v[0:15], v[64:67], v[80:83], v[0:15]
    v_mfma_f32_16x16x32_bf16 v[160:163], v[164:167], v[64:67], v[160:163]
    ds_read_b64_tr_b16 v[64:65], v92 offset:36864
    ds_read_b64_tr_b16 v[66:67], v92 offset:37888
    s_waitcnt lgkmcnt(7)
    v_mfma_f32_32x32x16_bf16 v[16:31], v[68:71], v[80:83], v[16:31]
    ds_read_b64_tr_b16 v[68:69], v93 offset:36864
    ds_read_b64_tr_b16 v[70:71], v93 offset:37888
    s_waitcnt lgkmcnt(7)
    v_mfma_f32_32x32x16_bf16 v[32:47], v[72:75], v[80:83], v[32:47]
    ds_read_b64_tr_b16 v[72:73], v94 offset:36864
    ds_read_b64_tr_b16 v[74:75], v94 offset:37888
    s_waitcnt lgkmcnt(7)
    v_mfma_f32_32x32x16_bf16 v[48:63], v[76:79], v[80:83], v[48:63]
    ds_read_b64_tr_b16 v[76:77], v95 offset:36864
    ds_read_b64_tr_b16 v[78:79], v95 offset:37888
    ds_read_b128 v[80:83], v90 offset:32768
    s_waitcnt lgkmcnt(7)
    v_mfma_f32_32x32x16_bf16 v[0:15], v[64:67], v[84:87], v[0:15]
    v_mfma_f32_16x16x32_bf16 v[160:163], v[164:167], v[64:67], v[160:163]
    ds_read_b64_tr_b16 v[64:65], v92 offset:40960
    ds_read_b64_tr_b16 v[66:67], v92 offset:41984
    s_waitcnt lgkmcnt(7)
    v_mfma_f32_32x32x16_bf16 v[16:31], v[68:71], v[84:87], v[16:31]
    ds_read_b64_tr_b16 v[68:69], v93 offset:40960
    ds_read_b64_tr_b16 v[70:71], v93 offset:41984
    s_waitcnt lgkmcnt(7)
    v_mfma_f32_32x32x16_bf16 v[32:47], v[72:75], v[84:87], v[32:47]
    ds_read_b64_tr_b16 v[72:73], v94 offset:40960
    ds_read_b64_tr_b16 v[74:75], v94 offset:41984
    s_waitcnt lgkmcnt(7)
    v_mfma_f32_32x32x16_bf16 v[48:63], v[76:79], v[84:87], v[48:63]
    ds_read_b64_tr_b16 v[76:77], v95 offset:40960
    ds_read_b64_tr_b16 v[78:79], v95 offset:41984
    ds_read_b128 v[84:87], v91 offset:32768
    s_waitcnt lgkmcnt(7)
    v_mfma_f32_32x32x16_bf16 v[0:15], v[64:67], v[80:83], v[0:15]
    v_mfma_f32_16x16x32_bf16 v[160:163], v[164:167], v[64:67], v[160:163]
    ds_read_b64_tr_b16 v[64:65], v92 offset:45056
    ds_read_b64_tr_b16 v[66:67], v92 offset:46080
    s_waitcnt lgkmcnt(7)
    v_mfma_f32_32x32x16_bf16 v[16:31], v[68:71], v[80:83], v[16:31]
    ds_read_b64_tr_b16 v[68:69], v93 offset:45056
    ds_read_b64_tr_b16 v[70:71], v93 offset:46080
    s_waitcnt lgkmcnt(7)
    v_mfma_f32_32x32x16_bf16 v[32:47], v[72:75], v[80:83], v[32:47]
    ds_read_b64_tr_b16 v[72:73], v94 offset:45056
    ds_read_b64_tr_b16 v[74:75], v94 offset:46080
    s_waitcnt lgkmcnt(7)
    v_mfma_f32_32x32x16_bf16 v[48:63], v[76:79], v[80:83], v[48:63]
    ds_read_b64_tr_b16 v[76:77], v95 offset:45056
    ds_read_b64_tr_b16 v[78:79], v95 offset:46080
    s_barrier
    v_add_u32 v88, 65536, v88
    ds_read_b128 v[80:83], v88 offset:0
    s_waitcnt lgkmcnt(7)
    v_mfma_f32_32x32x16_bf16 v[0:15], v[64:67], v[84:87], v[0:15]
    v_mfma_f32_16x16x32_bf16 v[160:163], v[164:167], v[64:67], v[160:163]
    v_add_u32 v92, 65536, v92
    v_add_u32 v89, 65536, v89
    ds_read_b64_tr_b16 v[64:65], v92 offset:0
    ds_read_b64_tr_b16 v[66:67], v92 offset:1024
    s_waitcnt lgkmcnt(7)
    v_mfma_f32_32x32x16_bf16 v[16:31], v[68:71], v[84:87], v[16:31]
    v_add_u32 v93, 65536, v93
    v_add_u32 v90, 65536, v90
    ds_read_b64_tr_b16 v[68:69], v93 offset:0
    ds_read_b64_tr_b16 v[70:71], v93 offset:1024
    s_waitcnt lgkmcnt(7)
    v_mfma_f32_32x32x16_bf16 v[32:47], v[72:75], v[84:87], v[32:47]
    v_add_u32 v94, 65536, v94
    v_add_u32 v91, 65536, v91
    ds_read_b64_tr_b16 v[72:73], v94 offset:0
    ds_read_b64_tr_b16 v[74:75], v94 offset:1024
    s_waitcnt lgkmcnt(7)
    v_mfma_f32_32x32x16_bf16 v[48:63], v[76:79], v[84:87], v[48:63]
    v_add_u32 v95, 65536, v95
    ds_read_b64_tr_b16 v[76:77], v95 offset:0
    ds_read_b64_tr_b16 v[78:79], v95 offset:1024
    ds_read_b128 v[84:87], v89 offset:0
    s_waitcnt lgkmcnt(7)
    v_mfma_f32_32x32x16_bf16 v[0:15], v[64:67], v[80:83], v[0:15]
    v_mfma_f32_16x16x32_bf16 v[160:163], v[164:167], v[64:67], v[160:163]
    ds_read_b64_tr_b16 v[64:65], v92 offset:4096
    ds_read_b64_tr_b16 v[66:67], v92 offset:5120
    s_waitcnt lgkmcnt(7)
    v_mfma_f32_32x32x16_bf16 v[16:31], v[68:71], v[80:83], v[16:31]
    ds_read_b64_tr_b16 v[68:69], v93 offset:4096
    ds_read_b64_tr_b16 v[70:71], v93 offset:5120
    s_waitcnt lgkmcnt(7)
    v_mfma_f32_32x32x16_bf16 v[32:47], v[72:75], v[80:83], v[32:47]
    ds_read_b64_tr_b16 v[72:73], v94 offset:4096
    ds_read_b64_tr_b16 v[74:75], v94 offset:5120
    s_waitcnt lgkmcnt(7)
    v_mfma_f32_32x32x16_bf16 v[48:63], v[76:79], v[80:83], v[48:63]
    ds_read_b64_tr_b16 v[76:77], v95 offset:4096
    ds_read_b64_tr_b16 v[78:79], v95 offset:5120
    ds_read_b128 v[80:83], v90 offset:0
    s_waitcnt lgkmcnt(7)
    v_mfma_f32_32x32x16_bf16 v[0:15], v[64:67], v[84:87], v[0:15]
    v_mfma_f32_16x16x32_bf16 v[160:163], v[164:167], v[64:67], v[160:163]
    ds_read_b64_tr_b16 v[64:65], v92 offset:8192
    ds_read_b64_tr_b16 v[66:67], v92 offset:9216
    s_waitcnt lgkmcnt(7)
    v_mfma_f32_32x32x16_bf16 v[16:31], v[68:71], v[84:87], v[16:31]
    ds_read_b64_tr_b16 v[68:69], v93 offset:8192
    ds_read_b64_tr_b16 v[70:71], v93 offset:9216
    s_waitcnt lgkmcnt(7)
    v_mfma_f32_32x32x16_bf16 v[32:47], v[72:75], v[84:87], v[32:47]
    ds_read_b64_tr_b16 v[72:73], v94 offset:8192
    ds_read_b64_tr_b16 v[74:75], v94 offset:9216
    s_waitcnt lgkmcnt(7)
    v_mfma_f32_32x32x16_bf16 v[48:63], v[76:79], v[84:87], v[48:63]
    ds_read_b64_tr_b16 v[76:77], v95 offset:8192
    ds_read_b64_tr_b16 v[78:79], v95 offset:9216
    ds_read_b128 v[84:87], v91 offset:0
    s_waitcnt lgkmcnt(7)
    v_mfma_f32_32x32x16_bf16 v[0:15], v[64:67], v[80:83], v[0:15]
    v_mfma_f32_16x16x32_bf16 v[160:163], v[164:167], v[64:67], v[160:163]
    ds_read_b64_tr_b16 v[64:65], v92 offset:12288
    ds_read_b64_tr_b16 v[66:67], v92 offset:13312
    s_waitcnt lgkmcnt(7)
    v_mfma_f32_32x32x16_bf16 v[16:31], v[68:71], v[80:83], v[16:31]
    ds_read_b64_tr_b16 v[68:69], v93 offset:12288
    ds_read_b64_tr_b16 v[70:71], v93 offset:13312
    s_waitcnt lgkmcnt(7)
    v_mfma_f32_32x32x16_bf16 v[32:47], v[72:75], v[80:83], v[32:47]
    ds_read_b64_tr_b16 v[72:73], v94 offset:12288
    ds_read_b64_tr_b16 v[74:75], v94 offset:13312
    s_waitcnt lgkmcnt(7)
    v_mfma_f32_32x32x16_bf16 v[48:63], v[76:79], v[80:83], v[48:63]
    ds_read_b64_tr_b16 v[76:77], v95 offset:12288
    ds_read_b64_tr_b16 v[78:79], v95 offset:13312
    s_waitcnt lgkmcnt(6)
    v_mfma_f32_32x32x16_bf16 v[0:15], v[64:67], v[84:87], v[0:15]
    v_mfma_f32_16x16x32_bf16 v[160:163], v[164:167], v[64:67], v[160:163]
    s_waitcnt lgkmcnt(4)
    v_mfma_f32_32x32x16_bf16 v[16:31], v[68:71], v[84:87], v[16:31]
    s_waitcnt lgkmcnt(2)
    v_mfma_f32_32x32x16_bf16 v[32:47], v[72:75], v[84:87], v[32:47]
    s_waitcnt lgkmcnt(0)
    v_mfma_f32_32x32x16_bf16 v[48:63], v[76:79], v[84:87], v[48:63]
    s_lshl_b32 s30, s29, 7
    v_lshl_add_u32 v116, v112, 2, s30
    s_nop 7
    s_mov_b64 exec, 0xffff
    ds_write_b32 v116, v160 offset:0
    ds_write_b32 v116, v161 offset:64
    s_mov_b64 exec, -1
    s_waitcnt lgkmcnt(0)
    s_barrier
    s_lshl_b32 s30, s29, 8
    v_lshl_add_u32 v116, v113, 3, s30
    ds_read_b64 v[126:127], v116 offset:1024
    v_lshlrev_b32 v116, 4, v114
    s_add_u32 s30, s29, 0
    s_and_b32 s30, s30, 3
    s_lshl_b32 s30, s30, 7
    v_add_u32 v117, s30, v116
    ds_read_b128 v[132:135], v117 offset:0
    ds_read_b128 v[136:139], v117 offset:32
    ds_read_b128 v[140:143], v117 offset:64
    ds_read_b128 v[144:147], v117 offset:96
    s_add_u32 s30, s29, 1
    s_and_b32 s30, s30, 3
    s_lshl_b32 s30, s30, 7
    v_add_u32 v117, s30, v116
    ds_read_b128 v[148:151], v117 offset:0
    ds_read_b128 v[152:155], v117 offset:32
    ds_read_b128 v[156:159], v117 offset:64
    ds_read_b128 v[160:163], v117 offset:96
    s_add_u32 s30, s29, 2
    s_and_b32 s30, s30, 3
    s_lshl_b32 s30, s30, 7
    v_add_u32 v117, s30, v116
    v_mov_b32 v118, v117
    s_add_u32 s30, s29, 3
    s_and_b32 s30, s30, 3
    s_lshl_b32 s30, s30, 7
    v_add_u32 v117, s30, v116
    v_mov_b32 v119, v117
    s_cmp_eq_u32 s27, 0
    s_cselect_b32 s30, 0x3ea52b5c, 1.0
    s_waitcnt lgkmcnt(8)
    v_mul_f32 v128, s30, v127
    s_waitcnt lgkmcnt(7)
    v_pk_fma_f32 v[0:1], v[126:127], v[132:133], v[0:1] op_sel_hi:[0,1,1] neg_lo:[1,0,0] neg_hi:[1,0,0]
    v_pk_fma_f32 v[2:3], v[126:127], v[134:135], v[2:3] op_sel_hi:[0,1,1] neg_lo:[1,0,0] neg_hi:[1,0,0]
    v_pk_mul_f32 v[0:1], v[128:129], v[0:1] op_sel_hi:[0,1]
    v_pk_mul_f32 v[2:3], v[128:129], v[2:3] op_sel_hi:[0,1]
    v_cvt_pk_bf16_f32 v100, v0, v1
    v_cvt_pk_bf16_f32 v101, v2, v3
    s_waitcnt lgkmcnt(6)
    v_pk_fma_f32 v[4:5], v[126:127], v[136:137], v[4:5] op_sel_hi:[0,1,1] neg_lo:[1,0,0] neg_hi:[1,0,0]
    v_pk_fma_f32 v[6:7], v[126:127], v[138:139], v[6:7] op_sel_hi:[0,1,1] neg_lo:[1,0,0] neg_hi:[1,0,0]
    v_pk_mul_f32 v[4:5], v[128:129], v[4:5] op_sel_hi:[0,1]
    v_pk_mul_f32 v[6:7], v[128:129], v[6:7] op_sel_hi:[0,1]
    v_cvt_pk_bf16_f32 v102, v4, v5
    v_cvt_pk_bf16_f32 v103, v6, v7
    s_add_u32 s30, s29, 0
    s_and_b32 s30, s30, 3
    s_lshl_b32 s30, s30, 11
    v_permlane32_swap_b32 v100, v102
    s_add_u32 s30, s30, s39
    v_permlane32_swap_b32 v101, v103
    buffer_store_dwordx4 v[100:103], v96, s[20:23], s30 offen sc1
    s_waitcnt lgkmcnt(5)
    v_pk_fma_f32 v[8:9], v[126:127], v[140:141], v[8:9] op_sel_hi:[0,1,1] neg_lo:[1,0,0] neg_hi:[1,0,0]
    v_pk_fma_f32 v[10:11], v[126:127], v[142:143], v[10:11] op_sel_hi:[0,1,1] neg_lo:[1,0,0] neg_hi:[1,0,0]
    v_pk_mul_f32 v[8:9], v[128:129], v[8:9] op_sel_hi:[0,1]
    v_pk_mul_f32 v[10:11], v[128:129], v[10:11] op_sel_hi:[0,1]
    v_cvt_pk_bf16_f32 v104, v8, v9
    v_cvt_pk_bf16_f32 v105, v10, v11
    s_waitcnt lgkmcnt(4)
    v_pk_fma_f32 v[12:13], v[126:127], v[144:145], v[12:13] op_sel_hi:[0,1,1] neg_lo:[1,0,0] neg_hi:[1,0,0]
    v_pk_fma_f32 v[14:15], v[126:127], v[146:147], v[14:15] op_sel_hi:[0,1,1] neg_lo:[1,0,0] neg_hi:[1,0,0]
    v_pk_mul_f32 v[12:13], v[128:129], v[12:13] op_sel_hi:[0,1]
    v_pk_mul_f32 v[14:15], v[128:129], v[14:15] op_sel_hi:[0,1]
    v_cvt_pk_bf16_f32 v106, v12, v13
    v_cvt_pk_bf16_f32 v107, v14, v15
    s_add_u32 s30, s29, 0
    s_and_b32 s30, s30, 3
    s_lshl_b32 s30, s30, 11
    v_permlane32_swap_b32 v104, v106
    s_add_u32 s30, s30, s39
    v_permlane32_swap_b32 v105, v107
    s_add_u32 s30, s30, 1024
    buffer_store_dwordx4 v[104:107], v96, s[20:23], s30 offen sc1
    ds_read_b128 v[132:135], v118 offset:0
    ds_read_b128 v[136:139], v118 offset:32
    ds_read_b128 v[140:143], v118 offset:64
    ds_read_b128 v[144:147], v118 offset:96
    s_waitcnt lgkmcnt(3)
    v_pk_fma_f32 v[16:17], v[126:127], v[148:149], v[16:17] op_sel_hi:[0,1,1] neg_lo:[1,0,0] neg_hi:[1,0,0]
    v_pk_fma_f32 v[18:19], v[126:127], v[150:151], v[18:19] op_sel_hi:[0,1,1] neg_lo:[1,0,0] neg_hi:[1,0,0]
    v_pk_mul_f32 v[16:17], v[128:129], v[16:17] op_sel_hi:[0,1]
    v_pk_mul_f32 v[18:19], v[128:129], v[18:19] op_sel_hi:[0,1]
    v_cvt_pk_bf16_f32 v100, v16, v17
    v_cvt_pk_bf16_f32 v101, v18, v19
    s_waitcnt lgkmcnt(2)
    v_pk_fma_f32 v[20:21], v[126:127], v[152:153], v[20:21] op_sel_hi:[0,1,1] neg_lo:[1,0,0] neg_hi:[1,0,0]
    v_pk_fma_f32 v[22:23], v[126:127], v[154:155], v[22:23] op_sel_hi:[0,1,1] neg_lo:[1,0,0] neg_hi:[1,0,0]
    v_pk_mul_f32 v[20:21], v[128:129], v[20:21] op_sel_hi:[0,1]
    v_pk_mul_f32 v[22:23], v[128:129], v[22:23] op_sel_hi:[0,1]
    v_cvt_pk_bf16_f32 v102, v20, v21
    v_cvt_pk_bf16_f32 v103, v22, v23
    s_add_u32 s30, s29, 1
    s_and_b32 s30, s30, 3
    s_lshl_b32 s30, s30, 11
    v_permlane32_swap_b32 v100, v102
    s_add_u32 s30, s30, s39
    v_permlane32_swap_b32 v101, v103
    buffer_store_dwordx4 v[100:103], v96, s[20:23], s30 offen sc1
    s_waitcnt lgkmcnt(1)
    v_pk_fma_f32 v[24:25], v[126:127], v[156:157], v[24:25] op_sel_hi:[0,1,1] neg_lo:[1,0,0] neg_hi:[1,0,0]
    v_pk_fma_f32 v[26:27], v[126:127], v[158:159], v[26:27] op_sel_hi:[0,1,1] neg_lo:[1,0,0] neg_hi:[1,0,0]
    v_pk_mul_f32 v[24:25], v[128:129], v[24:25] op_sel_hi:[0,1]
    v_pk_mul_f32 v[26:27], v[128:129], v[26:27] op_sel_hi:[0,1]
    v_cvt_pk_bf16_f32 v104, v24, v25
    v_cvt_pk_bf16_f32 v105, v26, v27
    s_waitcnt lgkmcnt(0)
    v_pk_fma_f32 v[28:29], v[126:127], v[160:161], v[28:29] op_sel_hi:[0,1,1] neg_lo:[1,0,0] neg_hi:[1,0,0]
    v_pk_fma_f32 v[30:31], v[126:127], v[162:163], v[30:31] op_sel_hi:[0,1,1] neg_lo:[1,0,0] neg_hi:[1,0,0]
    v_pk_mul_f32 v[28:29], v[128:129], v[28:29] op_sel_hi:[0,1]
    v_pk_mul_f32 v[30:31], v[128:129], v[30:31] op_sel_hi:[0,1]
    v_cvt_pk_bf16_f32 v106, v28, v29
    v_cvt_pk_bf16_f32 v107, v30, v31
    s_add_u32 s30, s29, 1
    s_and_b32 s30, s30, 3
    s_lshl_b32 s30, s30, 11
    v_permlane32_swap_b32 v104, v106
    s_add_u32 s30, s30, s39
    v_permlane32_swap_b32 v105, v107
    s_add_u32 s30, s30, 1024
    buffer_store_dwordx4 v[104:107], v96, s[20:23], s30 offen sc1
    ds_read_b128 v[148:151], v119 offset:0
    ds_read_b128 v[152:155], v119 offset:32
    ds_read_b128 v[156:159], v119 offset:64
    ds_read_b128 v[160:163], v119 offset:96
    s_waitcnt lgkmcnt(4)
    v_pk_fma_f32 v[32:33], v[126:127], v[132:133], v[32:33] op_sel_hi:[0,1,1] neg_lo:[1,0,0] neg_hi:[1,0,0]
    v_pk_fma_f32 v[34:35], v[126:127], v[134:135], v[34:35] op_sel_hi:[0,1,1] neg_lo:[1,0,0] neg_hi:[1,0,0]
    v_pk_mul_f32 v[32:33], v[128:129], v[32:33] op_sel_hi:[0,1]
    v_pk_mul_f32 v[34:35], v[128:129], v[34:35] op_sel_hi:[0,1]
    v_cvt_pk_bf16_f32 v100, v32, v33
    v_cvt_pk_bf16_f32 v101, v34, v35
    v_pk_fma_f32 v[36:37], v[126:127], v[136:137], v[36:37] op_sel_hi:[0,1,1] neg_lo:[1,0,0] neg_hi:[1,0,0]
    v_pk_fma_f32 v[38:39], v[126:127], v[138:139], v[38:39] op_sel_hi:[0,1,1] neg_lo:[1,0,0] neg_hi:[1,0,0]
    v_pk_mul_f32 v[36:37], v[128:129], v[36:37] op_sel_hi:[0,1]
    v_pk_mul_f32 v[38:39], v[128:129], v[38:39] op_sel_hi:[0,1]
    v_cvt_pk_bf16_f32 v102, v36, v37
    v_cvt_pk_bf16_f32 v103, v38, v39
    s_add_u32 s30, s29, 2
    s_and_b32 s30, s30, 3
    s_lshl_b32 s30, s30, 11
    v_permlane32_swap_b32 v100, v102
    s_add_u32 s30, s30, s39
    v_permlane32_swap_b32 v101, v103
    buffer_store_dwordx4 v[100:103], v96, s[20:23], s30 offen sc1
    v_pk_fma_f32 v[40:41], v[126:127], v[140:141], v[40:41] op_sel_hi:[0,1,1] neg_lo:[1,0,0] neg_hi:[1,0,0]
    v_pk_fma_f32 v[42:43], v[126:127], v[142:143], v[42:43] op_sel_hi:[0,1,1] neg_lo:[1,0,0] neg_hi:[1,0,0]
    v_pk_mul_f32 v[40:41], v[128:129], v[40:41] op_sel_hi:[0,1]
    v_pk_mul_f32 v[42:43], v[128:129], v[42:43] op_sel_hi:[0,1]
    v_cvt_pk_bf16_f32 v104, v40, v41
    v_cvt_pk_bf16_f32 v105, v42, v43
    v_pk_fma_f32 v[44:45], v[126:127], v[144:145], v[44:45] op_sel_hi:[0,1,1] neg_lo:[1,0,0] neg_hi:[1,0,0]
    v_pk_fma_f32 v[46:47], v[126:127], v[146:147], v[46:47] op_sel_hi:[0,1,1] neg_lo:[1,0,0] neg_hi:[1,0,0]
    v_pk_mul_f32 v[44:45], v[128:129], v[44:45] op_sel_hi:[0,1]
    v_pk_mul_f32 v[46:47], v[128:129], v[46:47] op_sel_hi:[0,1]
    v_cvt_pk_bf16_f32 v106, v44, v45
    v_cvt_pk_bf16_f32 v107, v46, v47
    s_add_u32 s30, s29, 2
    s_and_b32 s30, s30, 3
    s_lshl_b32 s30, s30, 11
    v_permlane32_swap_b32 v104, v106
    s_add_u32 s30, s30, s39
    v_permlane32_swap_b32 v105, v107
    s_add_u32 s30, s30, 1024
    buffer_store_dwordx4 v[104:107], v96, s[20:23], s30 offen sc1
    s_waitcnt lgkmcnt(0)
    v_pk_fma_f32 v[48:49], v[126:127], v[148:149], v[48:49] op_sel_hi:[0,1,1] neg_lo:[1,0,0] neg_hi:[1,0,0]
    v_pk_fma_f32 v[50:51], v[126:127], v[150:151], v[50:51] op_sel_hi:[0,1,1] neg_lo:[1,0,0] neg_hi:[1,0,0]
    v_pk_mul_f32 v[48:49], v[128:129], v[48:49] op_sel_hi:[0,1]
    v_pk_mul_f32 v[50:51], v[128:129], v[50:51] op_sel_hi:[0,1]
    v_cvt_pk_bf16_f32 v100, v48, v49
    v_cvt_pk_bf16_f32 v101, v50, v51
    v_pk_fma_f32 v[52:53], v[126:127], v[152:153], v[52:53] op_sel_hi:[0,1,1] neg_lo:[1,0,0] neg_hi:[1,0,0]
    v_pk_fma_f32 v[54:55], v[126:127], v[154:155], v[54:55] op_sel_hi:[0,1,1] neg_lo:[1,0,0] neg_hi:[1,0,0]
    v_pk_mul_f32 v[52:53], v[128:129], v[52:53] op_sel_hi:[0,1]
    v_pk_mul_f32 v[54:55], v[128:129], v[54:55] op_sel_hi:[0,1]
    v_cvt_pk_bf16_f32 v102, v52, v53
    v_cvt_pk_bf16_f32 v103, v54, v55
    s_add_u32 s30, s29, 3
    s_and_b32 s30, s30, 3
    s_lshl_b32 s30, s30, 11
    v_permlane32_swap_b32 v100, v102
    s_add_u32 s30, s30, s39
    v_permlane32_swap_b32 v101, v103
    buffer_store_dwordx4 v[100:103], v96, s[20:23], s30 offen sc1
    v_pk_fma_f32 v[56:57], v[126:127], v[156:157], v[56:57] op_sel_hi:[0,1,1] neg_lo:[1,0,0] neg_hi:[1,0,0]
    v_pk_fma_f32 v[58:59], v[126:127], v[158:159], v[58:59] op_sel_hi:[0,1,1] neg_lo:[1,0,0] neg_hi:[1,0,0]
    v_pk_mul_f32 v[56:57], v[128:129], v[56:57] op_sel_hi:[0,1]
    v_pk_mul_f32 v[58:59], v[128:129], v[58:59] op_sel_hi:[0,1]
    v_cvt_pk_bf16_f32 v104, v56, v57
    v_cvt_pk_bf16_f32 v105, v58, v59
    v_pk_fma_f32 v[60:61], v[126:127], v[160:161], v[60:61] op_sel_hi:[0,1,1] neg_lo:[1,0,0] neg_hi:[1,0,0]
    v_pk_fma_f32 v[62:63], v[126:127], v[162:163], v[62:63] op_sel_hi:[0,1,1] neg_lo:[1,0,0] neg_hi:[1,0,0]
    v_pk_mul_f32 v[60:61], v[128:129], v[60:61] op_sel_hi:[0,1]
    v_pk_mul_f32 v[62:63], v[128:129], v[62:63] op_sel_hi:[0,1]
    v_cvt_pk_bf16_f32 v106, v60, v61
    v_cvt_pk_bf16_f32 v107, v62, v63
    s_add_u32 s30, s29, 3
    s_and_b32 s30, s30, 3
    s_lshl_b32 s30, s30, 11
    v_permlane32_swap_b32 v104, v106
    s_add_u32 s30, s30, s39
    v_permlane32_swap_b32 v105, v107
    s_add_u32 s30, s30, 1024
    buffer_store_dwordx4 v[104:107], v96, s[20:23], s30 offen sc1
    s_branch sequential_preLN__softmax_full_mha__dense_activation_silu__prompt_kernel_p1m
sequential_preLN__softmax_full_mha__dense_activation_silu__prompt_kernel_addr_v:
    s_lshl_b32 s30, s24, 2
    s_add_u32 s30, s30, s29
    s_mul_i32 s30, s30, 1280
    s_add_u32 s39, s30, 2621440
    s_mov_b32 s32, 81920
    s_add_u32 s30, s29, 0
    s_and_b32 s30, s30, 3
    s_lshl_b32 s30, s30, 5
    s_lshl_b32 s31, s26, 7
    s_add_u32 s30, s30, s31
    v_add_u32 v116, s30, v113
    v_mul_u32_u24 v117, 3277, v116
    v_lshrrev_b32 v117, 16, v117
    v_mul_u32_u24 v118, 20, v117
    v_sub_u32 v118, v116, v118
    v_mul_lo_u32 v117, v117, s32
    v_lshl_add_u32 v117, v118, 4, v117
    v_mul_u32_u24 v118, 320, v114
    v_add_u32 v96, v117, v118
    s_add_u32 s30, s29, 1
    s_and_b32 s30, s30, 3
    s_lshl_b32 s30, s30, 5
    s_lshl_b32 s31, s26, 7
    s_add_u32 s30, s30, s31
    v_add_u32 v116, s30, v113
    v_mul_u32_u24 v117, 3277, v116
    v_lshrrev_b32 v117, 16, v117
    v_mul_u32_u24 v118, 20, v117
    v_sub_u32 v118, v116, v118
    v_mul_lo_u32 v117, v117, s32
    v_lshl_add_u32 v117, v118, 4, v117
    v_mul_u32_u24 v118, 320, v114
    v_add_u32 v97, v117, v118
    s_add_u32 s30, s29, 2
    s_and_b32 s30, s30, 3
    s_lshl_b32 s30, s30, 5
    s_lshl_b32 s31, s26, 7
    s_add_u32 s30, s30, s31
    v_add_u32 v116, s30, v113
    v_mul_u32_u24 v117, 3277, v116
    v_lshrrev_b32 v117, 16, v117
    v_mul_u32_u24 v118, 20, v117
    v_sub_u32 v118, v116, v118
    v_mul_lo_u32 v117, v117, s32
    v_lshl_add_u32 v117, v118, 4, v117
    v_mul_u32_u24 v118, 320, v114
    v_add_u32 v98, v117, v118
    s_add_u32 s30, s29, 3
    s_and_b32 s30, s30, 3
    s_lshl_b32 s30, s30, 5
    s_lshl_b32 s31, s26, 7
    s_add_u32 s30, s30, s31
    v_add_u32 v116, s30, v113
    v_mul_u32_u24 v117, 3277, v116
    v_lshrrev_b32 v117, 16, v117
    v_mul_u32_u24 v118, 20, v117
    v_sub_u32 v118, v116, v118
    v_mul_lo_u32 v117, v117, s32
    v_lshl_add_u32 v117, v118, 4, v117
    v_mul_u32_u24 v118, 320, v114
    v_add_u32 v99, v117, v118
    s_barrier
    ds_read_b128 v[80:83], v88 offset:0
    ds_read_b64_tr_b16 v[64:65], v92 offset:0
    ds_read_b64_tr_b16 v[66:67], v92 offset:1024
    ds_read_b64_tr_b16 v[68:69], v93 offset:0
    ds_read_b64_tr_b16 v[70:71], v93 offset:1024
    ds_read_b64_tr_b16 v[72:73], v94 offset:0
    ds_read_b64_tr_b16 v[74:75], v94 offset:1024
    ds_read_b64_tr_b16 v[76:77], v95 offset:0
    ds_read_b64_tr_b16 v[78:79], v95 offset:1024
    ds_read_b128 v[84:87], v89 offset:0
    s_waitcnt lgkmcnt(7)
    v_mfma_f32_32x32x16_bf16 v[0:15], v[80:83], v[64:67], 0
    v_mfma_f32_16x16x32_bf16 v[160:163], v[164:167], v[64:67], 0
    ds_read_b64_tr_b16 v[64:65], v92 offset:4096
    ds_read_b64_tr_b16 v[66:67], v92 offset:5120
    s_waitcnt lgkmcnt(7)
    v_mfma_f32_32x32x16_bf16 v[16:31], v[80:83], v[68:71], 0
    ds_read_b64_tr_b16 v[68:69], v93 offset:4096
    ds_read_b64_tr_b16 v[70:71], v93 offset:5120
    s_waitcnt lgkmcnt(7)
    v_mfma_f32_32x32x16_bf16 v[32:47], v[80:83], v[72:75], 0
    ds_read_b64_tr_b16 v[72:73], v94 offset:4096
    ds_read_b64_tr_b16 v[74:75], v94 offset:5120
    s_waitcnt lgkmcnt(7)
    v_mfma_f32_32x32x16_bf16 v[48:63], v[80:83], v[76:79], 0
    ds_read_b64_tr_b16 v[76:77], v95 offset:4096
    ds_read_b64_tr_b16 v[78:79], v95 offset:5120
    ds_read_b128 v[80:83], v90 offset:0
    s_waitcnt lgkmcnt(7)
    v_mfma_f32_32x32x16_bf16 v[0:15], v[84:87], v[64:67], v[0:15]
    v_mfma_f32_16x16x32_bf16 v[160:163], v[164:167], v[64:67], v[160:163]
    ds_read_b64_tr_b16 v[64:65], v92 offset:8192
    ds_read_b64_tr_b16 v[66:67], v92 offset:9216
    s_waitcnt lgkmcnt(7)
    v_mfma_f32_32x32x16_bf16 v[16:31], v[84:87], v[68:71], v[16:31]
    ds_read_b64_tr_b16 v[68:69], v93 offset:8192
    ds_read_b64_tr_b16 v[70:71], v93 offset:9216
    s_waitcnt lgkmcnt(7)
    v_mfma_f32_32x32x16_bf16 v[32:47], v[84:87], v[72:75], v[32:47]
    ds_read_b64_tr_b16 v[72:73], v94 offset:8192
    ds_read_b64_tr_b16 v[74:75], v94 offset:9216
    s_waitcnt lgkmcnt(7)
    v_mfma_f32_32x32x16_bf16 v[48:63], v[84:87], v[76:79], v[48:63]
    ds_read_b64_tr_b16 v[76:77], v95 offset:8192
    ds_read_b64_tr_b16 v[78:79], v95 offset:9216
    ds_read_b128 v[84:87], v91 offset:0
    s_waitcnt lgkmcnt(7)
    v_mfma_f32_32x32x16_bf16 v[0:15], v[80:83], v[64:67], v[0:15]
    v_mfma_f32_16x16x32_bf16 v[160:163], v[164:167], v[64:67], v[160:163]
    ds_read_b64_tr_b16 v[64:65], v92 offset:12288
    ds_read_b64_tr_b16 v[66:67], v92 offset:13312
    s_waitcnt lgkmcnt(7)
    v_mfma_f32_32x32x16_bf16 v[16:31], v[80:83], v[68:71], v[16:31]
    ds_read_b64_tr_b16 v[68:69], v93 offset:12288
    ds_read_b64_tr_b16 v[70:71], v93 offset:13312
    s_waitcnt lgkmcnt(7)
    v_mfma_f32_32x32x16_bf16 v[32:47], v[80:83], v[72:75], v[32:47]
    ds_read_b64_tr_b16 v[72:73], v94 offset:12288
    ds_read_b64_tr_b16 v[74:75], v94 offset:13312
    s_waitcnt lgkmcnt(7)
    v_mfma_f32_32x32x16_bf16 v[48:63], v[80:83], v[76:79], v[48:63]
    ds_read_b64_tr_b16 v[76:77], v95 offset:12288
    ds_read_b64_tr_b16 v[78:79], v95 offset:13312
    s_barrier
    ds_read_b128 v[80:83], v88 offset:32768
    s_waitcnt lgkmcnt(7)
    v_mfma_f32_32x32x16_bf16 v[0:15], v[84:87], v[64:67], v[0:15]
    v_mfma_f32_16x16x32_bf16 v[160:163], v[164:167], v[64:67], v[160:163]
    ds_read_b64_tr_b16 v[64:65], v92 offset:32768
    ds_read_b64_tr_b16 v[66:67], v92 offset:33792
    s_waitcnt lgkmcnt(7)
    v_mfma_f32_32x32x16_bf16 v[16:31], v[84:87], v[68:71], v[16:31]
    ds_read_b64_tr_b16 v[68:69], v93 offset:32768
    ds_read_b64_tr_b16 v[70:71], v93 offset:33792
    s_waitcnt lgkmcnt(7)
    v_mfma_f32_32x32x16_bf16 v[32:47], v[84:87], v[72:75], v[32:47]
    ds_read_b64_tr_b16 v[72:73], v94 offset:32768
    ds_read_b64_tr_b16 v[74:75], v94 offset:33792
    s_waitcnt lgkmcnt(7)
    v_mfma_f32_32x32x16_bf16 v[48:63], v[84:87], v[76:79], v[48:63]
    ds_read_b64_tr_b16 v[76:77], v95 offset:32768
    ds_read_b64_tr_b16 v[78:79], v95 offset:33792
    ds_read_b128 v[84:87], v89 offset:32768
    s_waitcnt lgkmcnt(7)
    v_mfma_f32_32x32x16_bf16 v[0:15], v[80:83], v[64:67], v[0:15]
    v_mfma_f32_16x16x32_bf16 v[160:163], v[164:167], v[64:67], v[160:163]
    ds_read_b64_tr_b16 v[64:65], v92 offset:36864
    ds_read_b64_tr_b16 v[66:67], v92 offset:37888
    s_waitcnt lgkmcnt(7)
    v_mfma_f32_32x32x16_bf16 v[16:31], v[80:83], v[68:71], v[16:31]
    ds_read_b64_tr_b16 v[68:69], v93 offset:36864
    ds_read_b64_tr_b16 v[70:71], v93 offset:37888
    s_waitcnt lgkmcnt(7)
    v_mfma_f32_32x32x16_bf16 v[32:47], v[80:83], v[72:75], v[32:47]
    ds_read_b64_tr_b16 v[72:73], v94 offset:36864
    ds_read_b64_tr_b16 v[74:75], v94 offset:37888
    s_waitcnt lgkmcnt(7)
    v_mfma_f32_32x32x16_bf16 v[48:63], v[80:83], v[76:79], v[48:63]
    ds_read_b64_tr_b16 v[76:77], v95 offset:36864
    ds_read_b64_tr_b16 v[78:79], v95 offset:37888
    ds_read_b128 v[80:83], v90 offset:32768
    s_waitcnt lgkmcnt(7)
    v_mfma_f32_32x32x16_bf16 v[0:15], v[84:87], v[64:67], v[0:15]
    v_mfma_f32_16x16x32_bf16 v[160:163], v[164:167], v[64:67], v[160:163]
    ds_read_b64_tr_b16 v[64:65], v92 offset:40960
    ds_read_b64_tr_b16 v[66:67], v92 offset:41984
    s_waitcnt lgkmcnt(7)
    v_mfma_f32_32x32x16_bf16 v[16:31], v[84:87], v[68:71], v[16:31]
    ds_read_b64_tr_b16 v[68:69], v93 offset:40960
    ds_read_b64_tr_b16 v[70:71], v93 offset:41984
    s_waitcnt lgkmcnt(7)
    v_mfma_f32_32x32x16_bf16 v[32:47], v[84:87], v[72:75], v[32:47]
    ds_read_b64_tr_b16 v[72:73], v94 offset:40960
    ds_read_b64_tr_b16 v[74:75], v94 offset:41984
    s_waitcnt lgkmcnt(7)
    v_mfma_f32_32x32x16_bf16 v[48:63], v[84:87], v[76:79], v[48:63]
    ds_read_b64_tr_b16 v[76:77], v95 offset:40960
    ds_read_b64_tr_b16 v[78:79], v95 offset:41984
    ds_read_b128 v[84:87], v91 offset:32768
    s_waitcnt lgkmcnt(7)
    v_mfma_f32_32x32x16_bf16 v[0:15], v[80:83], v[64:67], v[0:15]
    v_mfma_f32_16x16x32_bf16 v[160:163], v[164:167], v[64:67], v[160:163]
    ds_read_b64_tr_b16 v[64:65], v92 offset:45056
    ds_read_b64_tr_b16 v[66:67], v92 offset:46080
    s_waitcnt lgkmcnt(7)
    v_mfma_f32_32x32x16_bf16 v[16:31], v[80:83], v[68:71], v[16:31]
    ds_read_b64_tr_b16 v[68:69], v93 offset:45056
    ds_read_b64_tr_b16 v[70:71], v93 offset:46080
    s_waitcnt lgkmcnt(7)
    v_mfma_f32_32x32x16_bf16 v[32:47], v[80:83], v[72:75], v[32:47]
    ds_read_b64_tr_b16 v[72:73], v94 offset:45056
    ds_read_b64_tr_b16 v[74:75], v94 offset:46080
    s_waitcnt lgkmcnt(7)
    v_mfma_f32_32x32x16_bf16 v[48:63], v[80:83], v[76:79], v[48:63]
    ds_read_b64_tr_b16 v[76:77], v95 offset:45056
    ds_read_b64_tr_b16 v[78:79], v95 offset:46080
    s_barrier
    v_add_u32 v88, 65536, v88
    ds_read_b128 v[80:83], v88 offset:0
    s_waitcnt lgkmcnt(7)
    v_mfma_f32_32x32x16_bf16 v[0:15], v[84:87], v[64:67], v[0:15]
    v_mfma_f32_16x16x32_bf16 v[160:163], v[164:167], v[64:67], v[160:163]
    v_add_u32 v92, 65536, v92
    v_add_u32 v89, 65536, v89
    ds_read_b64_tr_b16 v[64:65], v92 offset:0
    ds_read_b64_tr_b16 v[66:67], v92 offset:1024
    s_waitcnt lgkmcnt(7)
    v_mfma_f32_32x32x16_bf16 v[16:31], v[84:87], v[68:71], v[16:31]
    v_add_u32 v93, 65536, v93
    v_add_u32 v90, 65536, v90
    ds_read_b64_tr_b16 v[68:69], v93 offset:0
    ds_read_b64_tr_b16 v[70:71], v93 offset:1024
    s_waitcnt lgkmcnt(7)
    v_mfma_f32_32x32x16_bf16 v[32:47], v[84:87], v[72:75], v[32:47]
    v_add_u32 v94, 65536, v94
    v_add_u32 v91, 65536, v91
    ds_read_b64_tr_b16 v[72:73], v94 offset:0
    ds_read_b64_tr_b16 v[74:75], v94 offset:1024
    s_waitcnt lgkmcnt(7)
    v_mfma_f32_32x32x16_bf16 v[48:63], v[84:87], v[76:79], v[48:63]
    v_add_u32 v95, 65536, v95
    ds_read_b64_tr_b16 v[76:77], v95 offset:0
    ds_read_b64_tr_b16 v[78:79], v95 offset:1024
    ds_read_b128 v[84:87], v89 offset:0
    s_waitcnt lgkmcnt(7)
    v_mfma_f32_32x32x16_bf16 v[0:15], v[80:83], v[64:67], v[0:15]
    v_mfma_f32_16x16x32_bf16 v[160:163], v[164:167], v[64:67], v[160:163]
    ds_read_b64_tr_b16 v[64:65], v92 offset:4096
    ds_read_b64_tr_b16 v[66:67], v92 offset:5120
    s_waitcnt lgkmcnt(7)
    v_mfma_f32_32x32x16_bf16 v[16:31], v[80:83], v[68:71], v[16:31]
    ds_read_b64_tr_b16 v[68:69], v93 offset:4096
    ds_read_b64_tr_b16 v[70:71], v93 offset:5120
    s_waitcnt lgkmcnt(7)
    v_mfma_f32_32x32x16_bf16 v[32:47], v[80:83], v[72:75], v[32:47]
    ds_read_b64_tr_b16 v[72:73], v94 offset:4096
    ds_read_b64_tr_b16 v[74:75], v94 offset:5120
    s_waitcnt lgkmcnt(7)
    v_mfma_f32_32x32x16_bf16 v[48:63], v[80:83], v[76:79], v[48:63]
    ds_read_b64_tr_b16 v[76:77], v95 offset:4096
    ds_read_b64_tr_b16 v[78:79], v95 offset:5120
    ds_read_b128 v[80:83], v90 offset:0
    s_waitcnt lgkmcnt(7)
    v_mfma_f32_32x32x16_bf16 v[0:15], v[84:87], v[64:67], v[0:15]
    v_mfma_f32_16x16x32_bf16 v[160:163], v[164:167], v[64:67], v[160:163]
    ds_read_b64_tr_b16 v[64:65], v92 offset:8192
    ds_read_b64_tr_b16 v[66:67], v92 offset:9216
    s_waitcnt lgkmcnt(7)
    v_mfma_f32_32x32x16_bf16 v[16:31], v[84:87], v[68:71], v[16:31]
    ds_read_b64_tr_b16 v[68:69], v93 offset:8192
    ds_read_b64_tr_b16 v[70:71], v93 offset:9216
    s_waitcnt lgkmcnt(7)
    v_mfma_f32_32x32x16_bf16 v[32:47], v[84:87], v[72:75], v[32:47]
    ds_read_b64_tr_b16 v[72:73], v94 offset:8192
    ds_read_b64_tr_b16 v[74:75], v94 offset:9216
    s_waitcnt lgkmcnt(7)
    v_mfma_f32_32x32x16_bf16 v[48:63], v[84:87], v[76:79], v[48:63]
    ds_read_b64_tr_b16 v[76:77], v95 offset:8192
    ds_read_b64_tr_b16 v[78:79], v95 offset:9216
    ds_read_b128 v[84:87], v91 offset:0
    s_waitcnt lgkmcnt(7)
    v_mfma_f32_32x32x16_bf16 v[0:15], v[80:83], v[64:67], v[0:15]
    v_mfma_f32_16x16x32_bf16 v[160:163], v[164:167], v[64:67], v[160:163]
    ds_read_b64_tr_b16 v[64:65], v92 offset:12288
    ds_read_b64_tr_b16 v[66:67], v92 offset:13312
    s_waitcnt lgkmcnt(7)
    v_mfma_f32_32x32x16_bf16 v[16:31], v[80:83], v[68:71], v[16:31]
    ds_read_b64_tr_b16 v[68:69], v93 offset:12288
    ds_read_b64_tr_b16 v[70:71], v93 offset:13312
    s_waitcnt lgkmcnt(7)
    v_mfma_f32_32x32x16_bf16 v[32:47], v[80:83], v[72:75], v[32:47]
    ds_read_b64_tr_b16 v[72:73], v94 offset:12288
    ds_read_b64_tr_b16 v[74:75], v94 offset:13312
    s_waitcnt lgkmcnt(7)
    v_mfma_f32_32x32x16_bf16 v[48:63], v[80:83], v[76:79], v[48:63]
    ds_read_b64_tr_b16 v[76:77], v95 offset:12288
    ds_read_b64_tr_b16 v[78:79], v95 offset:13312
    s_barrier
    ds_read_b128 v[80:83], v88 offset:32768
    s_waitcnt lgkmcnt(7)
    v_mfma_f32_32x32x16_bf16 v[0:15], v[84:87], v[64:67], v[0:15]
    v_mfma_f32_16x16x32_bf16 v[160:163], v[164:167], v[64:67], v[160:163]
    ds_read_b64_tr_b16 v[64:65], v92 offset:32768
    ds_read_b64_tr_b16 v[66:67], v92 offset:33792
    s_waitcnt lgkmcnt(7)
    v_mfma_f32_32x32x16_bf16 v[16:31], v[84:87], v[68:71], v[16:31]
    ds_read_b64_tr_b16 v[68:69], v93 offset:32768
    ds_read_b64_tr_b16 v[70:71], v93 offset:33792
    s_waitcnt lgkmcnt(7)
    v_mfma_f32_32x32x16_bf16 v[32:47], v[84:87], v[72:75], v[32:47]
    ds_read_b64_tr_b16 v[72:73], v94 offset:32768
    ds_read_b64_tr_b16 v[74:75], v94 offset:33792
    s_waitcnt lgkmcnt(7)
    v_mfma_f32_32x32x16_bf16 v[48:63], v[84:87], v[76:79], v[48:63]
    ds_read_b64_tr_b16 v[76:77], v95 offset:32768
    ds_read_b64_tr_b16 v[78:79], v95 offset:33792
    ds_read_b128 v[84:87], v89 offset:32768
    s_waitcnt lgkmcnt(7)
    v_mfma_f32_32x32x16_bf16 v[0:15], v[80:83], v[64:67], v[0:15]
    v_mfma_f32_16x16x32_bf16 v[160:163], v[164:167], v[64:67], v[160:163]
    ds_read_b64_tr_b16 v[64:65], v92 offset:36864
    ds_read_b64_tr_b16 v[66:67], v92 offset:37888
    s_waitcnt lgkmcnt(7)
    v_mfma_f32_32x32x16_bf16 v[16:31], v[80:83], v[68:71], v[16:31]
    ds_read_b64_tr_b16 v[68:69], v93 offset:36864
    ds_read_b64_tr_b16 v[70:71], v93 offset:37888
    s_waitcnt lgkmcnt(7)
    v_mfma_f32_32x32x16_bf16 v[32:47], v[80:83], v[72:75], v[32:47]
    ds_read_b64_tr_b16 v[72:73], v94 offset:36864
    ds_read_b64_tr_b16 v[74:75], v94 offset:37888
    s_waitcnt lgkmcnt(7)
    v_mfma_f32_32x32x16_bf16 v[48:63], v[80:83], v[76:79], v[48:63]
    ds_read_b64_tr_b16 v[76:77], v95 offset:36864
    ds_read_b64_tr_b16 v[78:79], v95 offset:37888
    ds_read_b128 v[80:83], v90 offset:32768
    s_waitcnt lgkmcnt(7)
    v_mfma_f32_32x32x16_bf16 v[0:15], v[84:87], v[64:67], v[0:15]
    v_mfma_f32_16x16x32_bf16 v[160:163], v[164:167], v[64:67], v[160:163]
    ds_read_b64_tr_b16 v[64:65], v92 offset:40960
    ds_read_b64_tr_b16 v[66:67], v92 offset:41984
    s_waitcnt lgkmcnt(7)
    v_mfma_f32_32x32x16_bf16 v[16:31], v[84:87], v[68:71], v[16:31]
    ds_read_b64_tr_b16 v[68:69], v93 offset:40960
    ds_read_b64_tr_b16 v[70:71], v93 offset:41984
    s_waitcnt lgkmcnt(7)
    v_mfma_f32_32x32x16_bf16 v[32:47], v[84:87], v[72:75], v[32:47]
    ds_read_b64_tr_b16 v[72:73], v94 offset:40960
    ds_read_b64_tr_b16 v[74:75], v94 offset:41984
    s_waitcnt lgkmcnt(7)
    v_mfma_f32_32x32x16_bf16 v[48:63], v[84:87], v[76:79], v[48:63]
    ds_read_b64_tr_b16 v[76:77], v95 offset:40960
    ds_read_b64_tr_b16 v[78:79], v95 offset:41984
    ds_read_b128 v[84:87], v91 offset:32768
    s_waitcnt lgkmcnt(7)
    v_mfma_f32_32x32x16_bf16 v[0:15], v[80:83], v[64:67], v[0:15]
    v_mfma_f32_16x16x32_bf16 v[160:163], v[164:167], v[64:67], v[160:163]
    ds_read_b64_tr_b16 v[64:65], v92 offset:45056
    ds_read_b64_tr_b16 v[66:67], v92 offset:46080
    s_waitcnt lgkmcnt(7)
    v_mfma_f32_32x32x16_bf16 v[16:31], v[80:83], v[68:71], v[16:31]
    ds_read_b64_tr_b16 v[68:69], v93 offset:45056
    ds_read_b64_tr_b16 v[70:71], v93 offset:46080
    s_waitcnt lgkmcnt(7)
    v_mfma_f32_32x32x16_bf16 v[32:47], v[80:83], v[72:75], v[32:47]
    ds_read_b64_tr_b16 v[72:73], v94 offset:45056
    ds_read_b64_tr_b16 v[74:75], v94 offset:46080
    s_waitcnt lgkmcnt(7)
    v_mfma_f32_32x32x16_bf16 v[48:63], v[80:83], v[76:79], v[48:63]
    ds_read_b64_tr_b16 v[76:77], v95 offset:45056
    ds_read_b64_tr_b16 v[78:79], v95 offset:46080
    s_barrier
    v_add_u32 v88, 65536, v88
    ds_read_b128 v[80:83], v88 offset:0
    s_waitcnt lgkmcnt(7)
    v_mfma_f32_32x32x16_bf16 v[0:15], v[84:87], v[64:67], v[0:15]
    v_mfma_f32_16x16x32_bf16 v[160:163], v[164:167], v[64:67], v[160:163]
    v_add_u32 v92, 65536, v92
    v_add_u32 v89, 65536, v89
    ds_read_b64_tr_b16 v[64:65], v92 offset:0
    ds_read_b64_tr_b16 v[66:67], v92 offset:1024
    s_waitcnt lgkmcnt(7)
    v_mfma_f32_32x32x16_bf16 v[16:31], v[84:87], v[68:71], v[16:31]
    v_add_u32 v93, 65536, v93
    v_add_u32 v90, 65536, v90
    ds_read_b64_tr_b16 v[68:69], v93 offset:0
    ds_read_b64_tr_b16 v[70:71], v93 offset:1024
    s_waitcnt lgkmcnt(7)
    v_mfma_f32_32x32x16_bf16 v[32:47], v[84:87], v[72:75], v[32:47]
    v_add_u32 v94, 65536, v94
    v_add_u32 v91, 65536, v91
    ds_read_b64_tr_b16 v[72:73], v94 offset:0
    ds_read_b64_tr_b16 v[74:75], v94 offset:1024
    s_waitcnt lgkmcnt(7)
    v_mfma_f32_32x32x16_bf16 v[48:63], v[84:87], v[76:79], v[48:63]
    v_add_u32 v95, 65536, v95
    ds_read_b64_tr_b16 v[76:77], v95 offset:0
    ds_read_b64_tr_b16 v[78:79], v95 offset:1024
    ds_read_b128 v[84:87], v89 offset:0
    s_waitcnt lgkmcnt(7)
    v_mfma_f32_32x32x16_bf16 v[0:15], v[80:83], v[64:67], v[0:15]
    v_mfma_f32_16x16x32_bf16 v[160:163], v[164:167], v[64:67], v[160:163]
    ds_read_b64_tr_b16 v[64:65], v92 offset:4096
    ds_read_b64_tr_b16 v[66:67], v92 offset:5120
    s_waitcnt lgkmcnt(7)
    v_mfma_f32_32x32x16_bf16 v[16:31], v[80:83], v[68:71], v[16:31]
    ds_read_b64_tr_b16 v[68:69], v93 offset:4096
    ds_read_b64_tr_b16 v[70:71], v93 offset:5120
    s_waitcnt lgkmcnt(7)
    v_mfma_f32_32x32x16_bf16 v[32:47], v[80:83], v[72:75], v[32:47]
    ds_read_b64_tr_b16 v[72:73], v94 offset:4096
    ds_read_b64_tr_b16 v[74:75], v94 offset:5120
    s_waitcnt lgkmcnt(7)
    v_mfma_f32_32x32x16_bf16 v[48:63], v[80:83], v[76:79], v[48:63]
    ds_read_b64_tr_b16 v[76:77], v95 offset:4096
    ds_read_b64_tr_b16 v[78:79], v95 offset:5120
    ds_read_b128 v[80:83], v90 offset:0
    s_waitcnt lgkmcnt(7)
    v_mfma_f32_32x32x16_bf16 v[0:15], v[84:87], v[64:67], v[0:15]
    v_mfma_f32_16x16x32_bf16 v[160:163], v[164:167], v[64:67], v[160:163]
    ds_read_b64_tr_b16 v[64:65], v92 offset:8192
    ds_read_b64_tr_b16 v[66:67], v92 offset:9216
    s_waitcnt lgkmcnt(7)
    v_mfma_f32_32x32x16_bf16 v[16:31], v[84:87], v[68:71], v[16:31]
    ds_read_b64_tr_b16 v[68:69], v93 offset:8192
    ds_read_b64_tr_b16 v[70:71], v93 offset:9216
    s_waitcnt lgkmcnt(7)
    v_mfma_f32_32x32x16_bf16 v[32:47], v[84:87], v[72:75], v[32:47]
    ds_read_b64_tr_b16 v[72:73], v94 offset:8192
    ds_read_b64_tr_b16 v[74:75], v94 offset:9216
    s_waitcnt lgkmcnt(7)
    v_mfma_f32_32x32x16_bf16 v[48:63], v[84:87], v[76:79], v[48:63]
    ds_read_b64_tr_b16 v[76:77], v95 offset:8192
    ds_read_b64_tr_b16 v[78:79], v95 offset:9216
    ds_read_b128 v[84:87], v91 offset:0
    s_waitcnt lgkmcnt(7)
    v_mfma_f32_32x32x16_bf16 v[0:15], v[80:83], v[64:67], v[0:15]
    v_mfma_f32_16x16x32_bf16 v[160:163], v[164:167], v[64:67], v[160:163]
    ds_read_b64_tr_b16 v[64:65], v92 offset:12288
    ds_read_b64_tr_b16 v[66:67], v92 offset:13312
    s_waitcnt lgkmcnt(7)
    v_mfma_f32_32x32x16_bf16 v[16:31], v[80:83], v[68:71], v[16:31]
    ds_read_b64_tr_b16 v[68:69], v93 offset:12288
    ds_read_b64_tr_b16 v[70:71], v93 offset:13312
    s_waitcnt lgkmcnt(7)
    v_mfma_f32_32x32x16_bf16 v[32:47], v[80:83], v[72:75], v[32:47]
    ds_read_b64_tr_b16 v[72:73], v94 offset:12288
    ds_read_b64_tr_b16 v[74:75], v94 offset:13312
    s_waitcnt lgkmcnt(7)
    v_mfma_f32_32x32x16_bf16 v[48:63], v[80:83], v[76:79], v[48:63]
    ds_read_b64_tr_b16 v[76:77], v95 offset:12288
    ds_read_b64_tr_b16 v[78:79], v95 offset:13312
    s_barrier
    v_add_u32 v88, 4294836224, v88
    ds_read_b128 v[80:83], v88 offset:0
    s_waitcnt lgkmcnt(7)
    v_mfma_f32_32x32x16_bf16 v[0:15], v[84:87], v[64:67], v[0:15]
    v_mfma_f32_16x16x32_bf16 v[160:163], v[164:167], v[64:67], v[160:163]
    v_add_u32 v92, 4294836224, v92
    v_add_u32 v89, 4294836224, v89
    ds_read_b64_tr_b16 v[64:65], v92 offset:0
    ds_read_b64_tr_b16 v[66:67], v92 offset:1024
    s_waitcnt lgkmcnt(7)
    v_mfma_f32_32x32x16_bf16 v[16:31], v[84:87], v[68:71], v[16:31]
    v_add_u32 v93, 4294836224, v93
    v_add_u32 v90, 4294836224, v90
    ds_read_b64_tr_b16 v[68:69], v93 offset:0
    ds_read_b64_tr_b16 v[70:71], v93 offset:1024
    s_waitcnt lgkmcnt(7)
    v_mfma_f32_32x32x16_bf16 v[32:47], v[84:87], v[72:75], v[32:47]
    v_add_u32 v94, 4294836224, v94
    v_add_u32 v91, 4294836224, v91
    ds_read_b64_tr_b16 v[72:73], v94 offset:0
    ds_read_b64_tr_b16 v[74:75], v94 offset:1024
    s_waitcnt lgkmcnt(7)
    v_mfma_f32_32x32x16_bf16 v[48:63], v[84:87], v[76:79], v[48:63]
    v_add_u32 v95, 4294836224, v95
    ds_read_b64_tr_b16 v[76:77], v95 offset:0
    ds_read_b64_tr_b16 v[78:79], v95 offset:1024
    ds_read_b128 v[84:87], v89 offset:0
    s_waitcnt lgkmcnt(7)
    v_mfma_f32_32x32x16_bf16 v[0:15], v[80:83], v[64:67], v[0:15]
    v_mfma_f32_16x16x32_bf16 v[160:163], v[164:167], v[64:67], v[160:163]
    ds_read_b64_tr_b16 v[64:65], v92 offset:4096
    ds_read_b64_tr_b16 v[66:67], v92 offset:5120
    s_waitcnt lgkmcnt(7)
    v_mfma_f32_32x32x16_bf16 v[16:31], v[80:83], v[68:71], v[16:31]
    ds_read_b64_tr_b16 v[68:69], v93 offset:4096
    ds_read_b64_tr_b16 v[70:71], v93 offset:5120
    s_waitcnt lgkmcnt(7)
    v_mfma_f32_32x32x16_bf16 v[32:47], v[80:83], v[72:75], v[32:47]
    ds_read_b64_tr_b16 v[72:73], v94 offset:4096
    ds_read_b64_tr_b16 v[74:75], v94 offset:5120
    s_waitcnt lgkmcnt(7)
    v_mfma_f32_32x32x16_bf16 v[48:63], v[80:83], v[76:79], v[48:63]
    ds_read_b64_tr_b16 v[76:77], v95 offset:4096
    ds_read_b64_tr_b16 v[78:79], v95 offset:5120
    ds_read_b128 v[80:83], v90 offset:0
    s_waitcnt lgkmcnt(7)
    v_mfma_f32_32x32x16_bf16 v[0:15], v[84:87], v[64:67], v[0:15]
    v_mfma_f32_16x16x32_bf16 v[160:163], v[164:167], v[64:67], v[160:163]
    ds_read_b64_tr_b16 v[64:65], v92 offset:8192
    ds_read_b64_tr_b16 v[66:67], v92 offset:9216
    s_waitcnt lgkmcnt(7)
    v_mfma_f32_32x32x16_bf16 v[16:31], v[84:87], v[68:71], v[16:31]
    ds_read_b64_tr_b16 v[68:69], v93 offset:8192
    ds_read_b64_tr_b16 v[70:71], v93 offset:9216
    s_waitcnt lgkmcnt(7)
    v_mfma_f32_32x32x16_bf16 v[32:47], v[84:87], v[72:75], v[32:47]
    ds_read_b64_tr_b16 v[72:73], v94 offset:8192
    ds_read_b64_tr_b16 v[74:75], v94 offset:9216
    s_waitcnt lgkmcnt(7)
    v_mfma_f32_32x32x16_bf16 v[48:63], v[84:87], v[76:79], v[48:63]
    ds_read_b64_tr_b16 v[76:77], v95 offset:8192
    ds_read_b64_tr_b16 v[78:79], v95 offset:9216
    ds_read_b128 v[84:87], v91 offset:0
    s_waitcnt lgkmcnt(7)
    v_mfma_f32_32x32x16_bf16 v[0:15], v[80:83], v[64:67], v[0:15]
    v_mfma_f32_16x16x32_bf16 v[160:163], v[164:167], v[64:67], v[160:163]
    ds_read_b64_tr_b16 v[64:65], v92 offset:12288
    ds_read_b64_tr_b16 v[66:67], v92 offset:13312
    s_waitcnt lgkmcnt(7)
    v_mfma_f32_32x32x16_bf16 v[16:31], v[80:83], v[68:71], v[16:31]
    ds_read_b64_tr_b16 v[68:69], v93 offset:12288
    ds_read_b64_tr_b16 v[70:71], v93 offset:13312
    s_waitcnt lgkmcnt(7)
    v_mfma_f32_32x32x16_bf16 v[32:47], v[80:83], v[72:75], v[32:47]
    ds_read_b64_tr_b16 v[72:73], v94 offset:12288
    ds_read_b64_tr_b16 v[74:75], v94 offset:13312
    s_waitcnt lgkmcnt(7)
    v_mfma_f32_32x32x16_bf16 v[48:63], v[80:83], v[76:79], v[48:63]
    ds_read_b64_tr_b16 v[76:77], v95 offset:12288
    ds_read_b64_tr_b16 v[78:79], v95 offset:13312
    s_barrier
    ds_read_b128 v[80:83], v88 offset:32768
    s_waitcnt lgkmcnt(7)
    v_mfma_f32_32x32x16_bf16 v[0:15], v[84:87], v[64:67], v[0:15]
    v_mfma_f32_16x16x32_bf16 v[160:163], v[164:167], v[64:67], v[160:163]
    ds_read_b64_tr_b16 v[64:65], v92 offset:32768
    ds_read_b64_tr_b16 v[66:67], v92 offset:33792
    s_waitcnt lgkmcnt(7)
    v_mfma_f32_32x32x16_bf16 v[16:31], v[84:87], v[68:71], v[16:31]
    ds_read_b64_tr_b16 v[68:69], v93 offset:32768
    ds_read_b64_tr_b16 v[70:71], v93 offset:33792
    s_waitcnt lgkmcnt(7)
    v_mfma_f32_32x32x16_bf16 v[32:47], v[84:87], v[72:75], v[32:47]
    ds_read_b64_tr_b16 v[72:73], v94 offset:32768
    ds_read_b64_tr_b16 v[74:75], v94 offset:33792
    s_waitcnt lgkmcnt(7)
    v_mfma_f32_32x32x16_bf16 v[48:63], v[84:87], v[76:79], v[48:63]
    ds_read_b64_tr_b16 v[76:77], v95 offset:32768
    ds_read_b64_tr_b16 v[78:79], v95 offset:33792
    ds_read_b128 v[84:87], v89 offset:32768
    s_waitcnt lgkmcnt(7)
    v_mfma_f32_32x32x16_bf16 v[0:15], v[80:83], v[64:67], v[0:15]
    v_mfma_f32_16x16x32_bf16 v[160:163], v[164:167], v[64:67], v[160:163]
    ds_read_b64_tr_b16 v[64:65], v92 offset:36864
    ds_read_b64_tr_b16 v[66:67], v92 offset:37888
    s_waitcnt lgkmcnt(7)
    v_mfma_f32_32x32x16_bf16 v[16:31], v[80:83], v[68:71], v[16:31]
    ds_read_b64_tr_b16 v[68:69], v93 offset:36864
    ds_read_b64_tr_b16 v[70:71], v93 offset:37888
    s_waitcnt lgkmcnt(7)
    v_mfma_f32_32x32x16_bf16 v[32:47], v[80:83], v[72:75], v[32:47]
    ds_read_b64_tr_b16 v[72:73], v94 offset:36864
    ds_read_b64_tr_b16 v[74:75], v94 offset:37888
    s_waitcnt lgkmcnt(7)
    v_mfma_f32_32x32x16_bf16 v[48:63], v[80:83], v[76:79], v[48:63]
    ds_read_b64_tr_b16 v[76:77], v95 offset:36864
    ds_read_b64_tr_b16 v[78:79], v95 offset:37888
    ds_read_b128 v[80:83], v90 offset:32768
    s_waitcnt lgkmcnt(7)
    v_mfma_f32_32x32x16_bf16 v[0:15], v[84:87], v[64:67], v[0:15]
    v_mfma_f32_16x16x32_bf16 v[160:163], v[164:167], v[64:67], v[160:163]
    ds_read_b64_tr_b16 v[64:65], v92 offset:40960
    ds_read_b64_tr_b16 v[66:67], v92 offset:41984
    s_waitcnt lgkmcnt(7)
    v_mfma_f32_32x32x16_bf16 v[16:31], v[84:87], v[68:71], v[16:31]
    ds_read_b64_tr_b16 v[68:69], v93 offset:40960
    ds_read_b64_tr_b16 v[70:71], v93 offset:41984
    s_waitcnt lgkmcnt(7)
    v_mfma_f32_32x32x16_bf16 v[32:47], v[84:87], v[72:75], v[32:47]
    ds_read_b64_tr_b16 v[72:73], v94 offset:40960
    ds_read_b64_tr_b16 v[74:75], v94 offset:41984
    s_waitcnt lgkmcnt(7)
    v_mfma_f32_32x32x16_bf16 v[48:63], v[84:87], v[76:79], v[48:63]
    ds_read_b64_tr_b16 v[76:77], v95 offset:40960
    ds_read_b64_tr_b16 v[78:79], v95 offset:41984
    ds_read_b128 v[84:87], v91 offset:32768
    s_waitcnt lgkmcnt(7)
    v_mfma_f32_32x32x16_bf16 v[0:15], v[80:83], v[64:67], v[0:15]
    v_mfma_f32_16x16x32_bf16 v[160:163], v[164:167], v[64:67], v[160:163]
    ds_read_b64_tr_b16 v[64:65], v92 offset:45056
    ds_read_b64_tr_b16 v[66:67], v92 offset:46080
    s_waitcnt lgkmcnt(7)
    v_mfma_f32_32x32x16_bf16 v[16:31], v[80:83], v[68:71], v[16:31]
    ds_read_b64_tr_b16 v[68:69], v93 offset:45056
    ds_read_b64_tr_b16 v[70:71], v93 offset:46080
    s_waitcnt lgkmcnt(7)
    v_mfma_f32_32x32x16_bf16 v[32:47], v[80:83], v[72:75], v[32:47]
    ds_read_b64_tr_b16 v[72:73], v94 offset:45056
    ds_read_b64_tr_b16 v[74:75], v94 offset:46080
    s_waitcnt lgkmcnt(7)
    v_mfma_f32_32x32x16_bf16 v[48:63], v[80:83], v[76:79], v[48:63]
    ds_read_b64_tr_b16 v[76:77], v95 offset:45056
    ds_read_b64_tr_b16 v[78:79], v95 offset:46080
    s_barrier
    v_add_u32 v88, 65536, v88
    ds_read_b128 v[80:83], v88 offset:0
    s_waitcnt lgkmcnt(7)
    v_mfma_f32_32x32x16_bf16 v[0:15], v[84:87], v[64:67], v[0:15]
    v_mfma_f32_16x16x32_bf16 v[160:163], v[164:167], v[64:67], v[160:163]
    v_add_u32 v92, 65536, v92
    v_add_u32 v89, 65536, v89
    ds_read_b64_tr_b16 v[64:65], v92 offset:0
    ds_read_b64_tr_b16 v[66:67], v92 offset:1024
    s_waitcnt lgkmcnt(7)
    v_mfma_f32_32x32x16_bf16 v[16:31], v[84:87], v[68:71], v[16:31]
    v_add_u32 v93, 65536, v93
    v_add_u32 v90, 65536, v90
    ds_read_b64_tr_b16 v[68:69], v93 offset:0
    ds_read_b64_tr_b16 v[70:71], v93 offset:1024
    s_waitcnt lgkmcnt(7)
    v_mfma_f32_32x32x16_bf16 v[32:47], v[84:87], v[72:75], v[32:47]
    v_add_u32 v94, 65536, v94
    v_add_u32 v91, 65536, v91
    ds_read_b64_tr_b16 v[72:73], v94 offset:0
    ds_read_b64_tr_b16 v[74:75], v94 offset:1024
    s_waitcnt lgkmcnt(7)
    v_mfma_f32_32x32x16_bf16 v[48:63], v[84:87], v[76:79], v[48:63]
    v_add_u32 v95, 65536, v95
    ds_read_b64_tr_b16 v[76:77], v95 offset:0
    ds_read_b64_tr_b16 v[78:79], v95 offset:1024
    ds_read_b128 v[84:87], v89 offset:0
    s_waitcnt lgkmcnt(7)
    v_mfma_f32_32x32x16_bf16 v[0:15], v[80:83], v[64:67], v[0:15]
    v_mfma_f32_16x16x32_bf16 v[160:163], v[164:167], v[64:67], v[160:163]
    ds_read_b64_tr_b16 v[64:65], v92 offset:4096
    ds_read_b64_tr_b16 v[66:67], v92 offset:5120
    s_waitcnt lgkmcnt(7)
    v_mfma_f32_32x32x16_bf16 v[16:31], v[80:83], v[68:71], v[16:31]
    ds_read_b64_tr_b16 v[68:69], v93 offset:4096
    ds_read_b64_tr_b16 v[70:71], v93 offset:5120
    s_waitcnt lgkmcnt(7)
    v_mfma_f32_32x32x16_bf16 v[32:47], v[80:83], v[72:75], v[32:47]
    ds_read_b64_tr_b16 v[72:73], v94 offset:4096
    ds_read_b64_tr_b16 v[74:75], v94 offset:5120
    s_waitcnt lgkmcnt(7)
    v_mfma_f32_32x32x16_bf16 v[48:63], v[80:83], v[76:79], v[48:63]
    ds_read_b64_tr_b16 v[76:77], v95 offset:4096
    ds_read_b64_tr_b16 v[78:79], v95 offset:5120
    ds_read_b128 v[80:83], v90 offset:0
    s_waitcnt lgkmcnt(7)
    v_mfma_f32_32x32x16_bf16 v[0:15], v[84:87], v[64:67], v[0:15]
    v_mfma_f32_16x16x32_bf16 v[160:163], v[164:167], v[64:67], v[160:163]
    ds_read_b64_tr_b16 v[64:65], v92 offset:8192
    ds_read_b64_tr_b16 v[66:67], v92 offset:9216
    s_waitcnt lgkmcnt(7)
    v_mfma_f32_32x32x16_bf16 v[16:31], v[84:87], v[68:71], v[16:31]
    ds_read_b64_tr_b16 v[68:69], v93 offset:8192
    ds_read_b64_tr_b16 v[70:71], v93 offset:9216
    s_waitcnt lgkmcnt(7)
    v_mfma_f32_32x32x16_bf16 v[32:47], v[84:87], v[72:75], v[32:47]
    ds_read_b64_tr_b16 v[72:73], v94 offset:8192
    ds_read_b64_tr_b16 v[74:75], v94 offset:9216
    s_waitcnt lgkmcnt(7)
    v_mfma_f32_32x32x16_bf16 v[48:63], v[84:87], v[76:79], v[48:63]
    ds_read_b64_tr_b16 v[76:77], v95 offset:8192
    ds_read_b64_tr_b16 v[78:79], v95 offset:9216
    ds_read_b128 v[84:87], v91 offset:0
    s_waitcnt lgkmcnt(7)
    v_mfma_f32_32x32x16_bf16 v[0:15], v[80:83], v[64:67], v[0:15]
    v_mfma_f32_16x16x32_bf16 v[160:163], v[164:167], v[64:67], v[160:163]
    ds_read_b64_tr_b16 v[64:65], v92 offset:12288
    ds_read_b64_tr_b16 v[66:67], v92 offset:13312
    s_waitcnt lgkmcnt(7)
    v_mfma_f32_32x32x16_bf16 v[16:31], v[80:83], v[68:71], v[16:31]
    ds_read_b64_tr_b16 v[68:69], v93 offset:12288
    ds_read_b64_tr_b16 v[70:71], v93 offset:13312
    s_waitcnt lgkmcnt(7)
    v_mfma_f32_32x32x16_bf16 v[32:47], v[80:83], v[72:75], v[32:47]
    ds_read_b64_tr_b16 v[72:73], v94 offset:12288
    ds_read_b64_tr_b16 v[74:75], v94 offset:13312
    s_waitcnt lgkmcnt(7)
    v_mfma_f32_32x32x16_bf16 v[48:63], v[80:83], v[76:79], v[48:63]
    ds_read_b64_tr_b16 v[76:77], v95 offset:12288
    ds_read_b64_tr_b16 v[78:79], v95 offset:13312
    s_barrier
    ds_read_b128 v[80:83], v88 offset:32768
    s_waitcnt lgkmcnt(7)
    v_mfma_f32_32x32x16_bf16 v[0:15], v[84:87], v[64:67], v[0:15]
    v_mfma_f32_16x16x32_bf16 v[160:163], v[164:167], v[64:67], v[160:163]
    ds_read_b64_tr_b16 v[64:65], v92 offset:32768
    ds_read_b64_tr_b16 v[66:67], v92 offset:33792
    s_waitcnt lgkmcnt(7)
    v_mfma_f32_32x32x16_bf16 v[16:31], v[84:87], v[68:71], v[16:31]
    ds_read_b64_tr_b16 v[68:69], v93 offset:32768
    ds_read_b64_tr_b16 v[70:71], v93 offset:33792
    s_waitcnt lgkmcnt(7)
    v_mfma_f32_32x32x16_bf16 v[32:47], v[84:87], v[72:75], v[32:47]
    ds_read_b64_tr_b16 v[72:73], v94 offset:32768
    ds_read_b64_tr_b16 v[74:75], v94 offset:33792
    s_waitcnt lgkmcnt(7)
    v_mfma_f32_32x32x16_bf16 v[48:63], v[84:87], v[76:79], v[48:63]
    ds_read_b64_tr_b16 v[76:77], v95 offset:32768
    ds_read_b64_tr_b16 v[78:79], v95 offset:33792
    ds_read_b128 v[84:87], v89 offset:32768
    s_waitcnt lgkmcnt(7)
    v_mfma_f32_32x32x16_bf16 v[0:15], v[80:83], v[64:67], v[0:15]
    v_mfma_f32_16x16x32_bf16 v[160:163], v[164:167], v[64:67], v[160:163]
    ds_read_b64_tr_b16 v[64:65], v92 offset:36864
    ds_read_b64_tr_b16 v[66:67], v92 offset:37888
    s_waitcnt lgkmcnt(7)
    v_mfma_f32_32x32x16_bf16 v[16:31], v[80:83], v[68:71], v[16:31]
    ds_read_b64_tr_b16 v[68:69], v93 offset:36864
    ds_read_b64_tr_b16 v[70:71], v93 offset:37888
    s_waitcnt lgkmcnt(7)
    v_mfma_f32_32x32x16_bf16 v[32:47], v[80:83], v[72:75], v[32:47]
    ds_read_b64_tr_b16 v[72:73], v94 offset:36864
    ds_read_b64_tr_b16 v[74:75], v94 offset:37888
    s_waitcnt lgkmcnt(7)
    v_mfma_f32_32x32x16_bf16 v[48:63], v[80:83], v[76:79], v[48:63]
    ds_read_b64_tr_b16 v[76:77], v95 offset:36864
    ds_read_b64_tr_b16 v[78:79], v95 offset:37888
    ds_read_b128 v[80:83], v90 offset:32768
    s_waitcnt lgkmcnt(7)
    v_mfma_f32_32x32x16_bf16 v[0:15], v[84:87], v[64:67], v[0:15]
    v_mfma_f32_16x16x32_bf16 v[160:163], v[164:167], v[64:67], v[160:163]
    ds_read_b64_tr_b16 v[64:65], v92 offset:40960
    ds_read_b64_tr_b16 v[66:67], v92 offset:41984
    s_waitcnt lgkmcnt(7)
    v_mfma_f32_32x32x16_bf16 v[16:31], v[84:87], v[68:71], v[16:31]
    ds_read_b64_tr_b16 v[68:69], v93 offset:40960
    ds_read_b64_tr_b16 v[70:71], v93 offset:41984
    s_waitcnt lgkmcnt(7)
    v_mfma_f32_32x32x16_bf16 v[32:47], v[84:87], v[72:75], v[32:47]
    ds_read_b64_tr_b16 v[72:73], v94 offset:40960
    ds_read_b64_tr_b16 v[74:75], v94 offset:41984
    s_waitcnt lgkmcnt(7)
    v_mfma_f32_32x32x16_bf16 v[48:63], v[84:87], v[76:79], v[48:63]
    ds_read_b64_tr_b16 v[76:77], v95 offset:40960
    ds_read_b64_tr_b16 v[78:79], v95 offset:41984
    ds_read_b128 v[84:87], v91 offset:32768
    s_waitcnt lgkmcnt(7)
    v_mfma_f32_32x32x16_bf16 v[0:15], v[80:83], v[64:67], v[0:15]
    v_mfma_f32_16x16x32_bf16 v[160:163], v[164:167], v[64:67], v[160:163]
    ds_read_b64_tr_b16 v[64:65], v92 offset:45056
    ds_read_b64_tr_b16 v[66:67], v92 offset:46080
    s_waitcnt lgkmcnt(7)
    v_mfma_f32_32x32x16_bf16 v[16:31], v[80:83], v[68:71], v[16:31]
    ds_read_b64_tr_b16 v[68:69], v93 offset:45056
    ds_read_b64_tr_b16 v[70:71], v93 offset:46080
    s_waitcnt lgkmcnt(7)
    v_mfma_f32_32x32x16_bf16 v[32:47], v[80:83], v[72:75], v[32:47]
    ds_read_b64_tr_b16 v[72:73], v94 offset:45056
    ds_read_b64_tr_b16 v[74:75], v94 offset:46080
    s_waitcnt lgkmcnt(7)
    v_mfma_f32_32x32x16_bf16 v[48:63], v[80:83], v[76:79], v[48:63]
    ds_read_b64_tr_b16 v[76:77], v95 offset:45056
    ds_read_b64_tr_b16 v[78:79], v95 offset:46080
    s_barrier
    v_add_u32 v88, 65536, v88
    ds_read_b128 v[80:83], v88 offset:0
    s_waitcnt lgkmcnt(7)
    v_mfma_f32_32x32x16_bf16 v[0:15], v[84:87], v[64:67], v[0:15]
    v_mfma_f32_16x16x32_bf16 v[160:163], v[164:167], v[64:67], v[160:163]
    v_add_u32 v92, 65536, v92
    v_add_u32 v89, 65536, v89
    ds_read_b64_tr_b16 v[64:65], v92 offset:0
    ds_read_b64_tr_b16 v[66:67], v92 offset:1024
    s_waitcnt lgkmcnt(7)
    v_mfma_f32_32x32x16_bf16 v[16:31], v[84:87], v[68:71], v[16:31]
    v_add_u32 v93, 65536, v93
    v_add_u32 v90, 65536, v90
    ds_read_b64_tr_b16 v[68:69], v93 offset:0
    ds_read_b64_tr_b16 v[70:71], v93 offset:1024
    s_waitcnt lgkmcnt(7)
    v_mfma_f32_32x32x16_bf16 v[32:47], v[84:87], v[72:75], v[32:47]
    v_add_u32 v94, 65536, v94
    v_add_u32 v91, 65536, v91
    ds_read_b64_tr_b16 v[72:73], v94 offset:0
    ds_read_b64_tr_b16 v[74:75], v94 offset:1024
    s_waitcnt lgkmcnt(7)
    v_mfma_f32_32x32x16_bf16 v[48:63], v[84:87], v[76:79], v[48:63]
    v_add_u32 v95, 65536, v95
    ds_read_b64_tr_b16 v[76:77], v95 offset:0
    ds_read_b64_tr_b16 v[78:79], v95 offset:1024
    ds_read_b128 v[84:87], v89 offset:0
    s_waitcnt lgkmcnt(7)
    v_mfma_f32_32x32x16_bf16 v[0:15], v[80:83], v[64:67], v[0:15]
    v_mfma_f32_16x16x32_bf16 v[160:163], v[164:167], v[64:67], v[160:163]
    ds_read_b64_tr_b16 v[64:65], v92 offset:4096
    ds_read_b64_tr_b16 v[66:67], v92 offset:5120
    s_waitcnt lgkmcnt(7)
    v_mfma_f32_32x32x16_bf16 v[16:31], v[80:83], v[68:71], v[16:31]
    ds_read_b64_tr_b16 v[68:69], v93 offset:4096
    ds_read_b64_tr_b16 v[70:71], v93 offset:5120
    s_waitcnt lgkmcnt(7)
    v_mfma_f32_32x32x16_bf16 v[32:47], v[80:83], v[72:75], v[32:47]
    ds_read_b64_tr_b16 v[72:73], v94 offset:4096
    ds_read_b64_tr_b16 v[74:75], v94 offset:5120
    s_waitcnt lgkmcnt(7)
    v_mfma_f32_32x32x16_bf16 v[48:63], v[80:83], v[76:79], v[48:63]
    ds_read_b64_tr_b16 v[76:77], v95 offset:4096
    ds_read_b64_tr_b16 v[78:79], v95 offset:5120
    ds_read_b128 v[80:83], v90 offset:0
    s_waitcnt lgkmcnt(7)
    v_mfma_f32_32x32x16_bf16 v[0:15], v[84:87], v[64:67], v[0:15]
    v_mfma_f32_16x16x32_bf16 v[160:163], v[164:167], v[64:67], v[160:163]
    ds_read_b64_tr_b16 v[64:65], v92 offset:8192
    ds_read_b64_tr_b16 v[66:67], v92 offset:9216
    s_waitcnt lgkmcnt(7)
    v_mfma_f32_32x32x16_bf16 v[16:31], v[84:87], v[68:71], v[16:31]
    ds_read_b64_tr_b16 v[68:69], v93 offset:8192
    ds_read_b64_tr_b16 v[70:71], v93 offset:9216
    s_waitcnt lgkmcnt(7)
    v_mfma_f32_32x32x16_bf16 v[32:47], v[84:87], v[72:75], v[32:47]
    ds_read_b64_tr_b16 v[72:73], v94 offset:8192
    ds_read_b64_tr_b16 v[74:75], v94 offset:9216
    s_waitcnt lgkmcnt(7)
    v_mfma_f32_32x32x16_bf16 v[48:63], v[84:87], v[76:79], v[48:63]
    ds_read_b64_tr_b16 v[76:77], v95 offset:8192
    ds_read_b64_tr_b16 v[78:79], v95 offset:9216
    ds_read_b128 v[84:87], v91 offset:0
    s_waitcnt lgkmcnt(7)
    v_mfma_f32_32x32x16_bf16 v[0:15], v[80:83], v[64:67], v[0:15]
    v_mfma_f32_16x16x32_bf16 v[160:163], v[164:167], v[64:67], v[160:163]
    ds_read_b64_tr_b16 v[64:65], v92 offset:12288
    ds_read_b64_tr_b16 v[66:67], v92 offset:13312
    s_waitcnt lgkmcnt(7)
    v_mfma_f32_32x32x16_bf16 v[16:31], v[80:83], v[68:71], v[16:31]
    ds_read_b64_tr_b16 v[68:69], v93 offset:12288
    ds_read_b64_tr_b16 v[70:71], v93 offset:13312
    s_waitcnt lgkmcnt(7)
    v_mfma_f32_32x32x16_bf16 v[32:47], v[80:83], v[72:75], v[32:47]
    ds_read_b64_tr_b16 v[72:73], v94 offset:12288
    ds_read_b64_tr_b16 v[74:75], v94 offset:13312
    s_waitcnt lgkmcnt(7)
    v_mfma_f32_32x32x16_bf16 v[48:63], v[80:83], v[76:79], v[48:63]
    ds_read_b64_tr_b16 v[76:77], v95 offset:12288
    ds_read_b64_tr_b16 v[78:79], v95 offset:13312
    s_waitcnt lgkmcnt(6)
    v_mfma_f32_32x32x16_bf16 v[0:15], v[84:87], v[64:67], v[0:15]
    v_mfma_f32_16x16x32_bf16 v[160:163], v[164:167], v[64:67], v[160:163]
    s_waitcnt lgkmcnt(4)
    v_mfma_f32_32x32x16_bf16 v[16:31], v[84:87], v[68:71], v[16:31]
    s_waitcnt lgkmcnt(2)
    v_mfma_f32_32x32x16_bf16 v[32:47], v[84:87], v[72:75], v[32:47]
    s_waitcnt lgkmcnt(0)
    v_mfma_f32_32x32x16_bf16 v[48:63], v[84:87], v[76:79], v[48:63]
    s_lshl_b32 s30, s29, 7
    v_lshl_add_u32 v116, v112, 2, s30
    s_nop 7
    s_mov_b64 exec, 0xffff
    ds_write_b32 v116, v160 offset:0
    ds_write_b32 v116, v161 offset:64
    s_mov_b64 exec, -1
    s_waitcnt lgkmcnt(0)
    s_barrier
    s_lshl_b32 s30, s29, 8
    v_lshl_add_u32 v117, v114, 5, s30
    ds_read_b128 v[132:135], v117 offset:1024
    ds_read_b128 v[136:139], v117 offset:1040
    ds_read_b128 v[140:143], v117 offset:1088
    ds_read_b128 v[144:147], v117 offset:1104
    ds_read_b128 v[148:151], v117 offset:1152
    ds_read_b128 v[152:155], v117 offset:1168
    ds_read_b128 v[156:159], v117 offset:1216
    ds_read_b128 v[160:163], v117 offset:1232
    s_add_u32 s30, s29, 0
    s_and_b32 s30, s30, 3
    s_lshl_b32 s30, s30, 7
    v_lshl_add_u32 v118, v113, 2, s30
    ds_read_b32 v124, v118 offset:0
    s_add_u32 s30, s29, 1
    s_and_b32 s30, s30, 3
    s_lshl_b32 s30, s30, 7
    v_lshl_add_u32 v118, v113, 2, s30
    ds_read_b32 v125, v118 offset:0
    s_add_u32 s30, s29, 2
    s_and_b32 s30, s30, 3
    s_lshl_b32 s30, s30, 7
    v_lshl_add_u32 v118, v113, 2, s30
    ds_read_b32 v126, v118 offset:0
    s_add_u32 s30, s29, 3
    s_and_b32 s30, s30, 3
    s_lshl_b32 s30, s30, 7
    v_lshl_add_u32 v118, v113, 2, s30
    ds_read_b32 v127, v118 offset:0
    s_waitcnt lgkmcnt(4)
    v_mul_f32 v132, v132, v133
    v_mul_f32 v134, v134, v135
    v_mul_f32 v136, v136, v137
    v_mul_f32 v138, v138, v139
    v_mul_f32 v140, v140, v141
    v_mul_f32 v142, v142, v143
    v_mul_f32 v144, v144, v145
    v_mul_f32 v146, v146, v147
    v_mul_f32 v148, v148, v149
    v_mul_f32 v150, v150, v151
    v_mul_f32 v152, v152, v153
    v_mul_f32 v154, v154, v155
    v_mul_f32 v156, v156, v157
    v_mul_f32 v158, v158, v159
    v_mul_f32 v160, v160, v161
    v_mul_f32 v162, v162, v163
    s_waitcnt lgkmcnt(0)
    v_mul_f32 v0, v133, v0
    v_mul_f32 v1, v135, v1
    v_mul_f32 v2, v137, v2
    v_mul_f32 v3, v139, v3
    v_mul_f32 v4, v141, v4
    v_mul_f32 v5, v143, v5
    v_mul_f32 v6, v145, v6
    v_mul_f32 v7, v147, v7
    v_fma_f32 v0, -v132, v124, v0
    v_fma_f32 v1, -v134, v124, v1
    v_fma_f32 v2, -v136, v124, v2
    v_fma_f32 v3, -v138, v124, v3
    v_fma_f32 v4, -v140, v124, v4
    v_fma_f32 v5, -v142, v124, v5
    v_fma_f32 v6, -v144, v124, v6
    v_fma_f32 v7, -v146, v124, v7
    v_cvt_pk_bf16_f32 v116, v0, v1
    v_cvt_pk_bf16_f32 v117, v2, v3
    v_cvt_pk_bf16_f32 v118, v4, v5
    v_cvt_pk_bf16_f32 v119, v6, v7
    s_add_u32 s30, s39, 0
    buffer_store_dwordx4 v[116:119], v96, s[20:23], s30 offen sc1
    v_mul_f32 v8, v149, v8
    v_mul_f32 v9, v151, v9
    v_mul_f32 v10, v153, v10
    v_mul_f32 v11, v155, v11
    v_mul_f32 v12, v157, v12
    v_mul_f32 v13, v159, v13
    v_mul_f32 v14, v161, v14
    v_mul_f32 v15, v163, v15
    v_fma_f32 v8, -v148, v124, v8
    v_fma_f32 v9, -v150, v124, v9
    v_fma_f32 v10, -v152, v124, v10
    v_fma_f32 v11, -v154, v124, v11
    v_fma_f32 v12, -v156, v124, v12
    v_fma_f32 v13, -v158, v124, v13
    v_fma_f32 v14, -v160, v124, v14
    v_fma_f32 v15, -v162, v124, v15
    v_cvt_pk_bf16_f32 v120, v8, v9
    v_cvt_pk_bf16_f32 v121, v10, v11
    v_cvt_pk_bf16_f32 v122, v12, v13
    v_cvt_pk_bf16_f32 v123, v14, v15
    s_add_u32 s30, s39, 640
    buffer_store_dwordx4 v[120:123], v96, s[20:23], s30 offen sc1
    v_mul_f32 v16, v133, v16
    v_mul_f32 v17, v135, v17
    v_mul_f32 v18, v137, v18
    v_mul_f32 v19, v139, v19
    v_mul_f32 v20, v141, v20
    v_mul_f32 v21, v143, v21
    v_mul_f32 v22, v145, v22
    v_mul_f32 v23, v147, v23
    v_fma_f32 v16, -v132, v125, v16
    v_fma_f32 v17, -v134, v125, v17
    v_fma_f32 v18, -v136, v125, v18
    v_fma_f32 v19, -v138, v125, v19
    v_fma_f32 v20, -v140, v125, v20
    v_fma_f32 v21, -v142, v125, v21
    v_fma_f32 v22, -v144, v125, v22
    v_fma_f32 v23, -v146, v125, v23
    v_cvt_pk_bf16_f32 v116, v16, v17
    v_cvt_pk_bf16_f32 v117, v18, v19
    v_cvt_pk_bf16_f32 v118, v20, v21
    v_cvt_pk_bf16_f32 v119, v22, v23
    s_add_u32 s30, s39, 0
    buffer_store_dwordx4 v[116:119], v97, s[20:23], s30 offen sc1
    v_mul_f32 v24, v149, v24
    v_mul_f32 v25, v151, v25
    v_mul_f32 v26, v153, v26
    v_mul_f32 v27, v155, v27
    v_mul_f32 v28, v157, v28
    v_mul_f32 v29, v159, v29
    v_mul_f32 v30, v161, v30
    v_mul_f32 v31, v163, v31
    v_fma_f32 v24, -v148, v125, v24
    v_fma_f32 v25, -v150, v125, v25
    v_fma_f32 v26, -v152, v125, v26
    v_fma_f32 v27, -v154, v125, v27
    v_fma_f32 v28, -v156, v125, v28
    v_fma_f32 v29, -v158, v125, v29
    v_fma_f32 v30, -v160, v125, v30
    v_fma_f32 v31, -v162, v125, v31
    v_cvt_pk_bf16_f32 v120, v24, v25
    v_cvt_pk_bf16_f32 v121, v26, v27
    v_cvt_pk_bf16_f32 v122, v28, v29
    v_cvt_pk_bf16_f32 v123, v30, v31
    s_add_u32 s30, s39, 640
    buffer_store_dwordx4 v[120:123], v97, s[20:23], s30 offen sc1
    v_mul_f32 v32, v133, v32
    v_mul_f32 v33, v135, v33
    v_mul_f32 v34, v137, v34
    v_mul_f32 v35, v139, v35
    v_mul_f32 v36, v141, v36
    v_mul_f32 v37, v143, v37
    v_mul_f32 v38, v145, v38
    v_mul_f32 v39, v147, v39
    v_fma_f32 v32, -v132, v126, v32
    v_fma_f32 v33, -v134, v126, v33
    v_fma_f32 v34, -v136, v126, v34
    v_fma_f32 v35, -v138, v126, v35
    v_fma_f32 v36, -v140, v126, v36
    v_fma_f32 v37, -v142, v126, v37
    v_fma_f32 v38, -v144, v126, v38
    v_fma_f32 v39, -v146, v126, v39
    v_cvt_pk_bf16_f32 v116, v32, v33
    v_cvt_pk_bf16_f32 v117, v34, v35
    v_cvt_pk_bf16_f32 v118, v36, v37
    v_cvt_pk_bf16_f32 v119, v38, v39
    s_add_u32 s30, s39, 0
    buffer_store_dwordx4 v[116:119], v98, s[20:23], s30 offen sc1
    v_mul_f32 v40, v149, v40
    v_mul_f32 v41, v151, v41
    v_mul_f32 v42, v153, v42
    v_mul_f32 v43, v155, v43
    v_mul_f32 v44, v157, v44
    v_mul_f32 v45, v159, v45
    v_mul_f32 v46, v161, v46
    v_mul_f32 v47, v163, v47
    v_fma_f32 v40, -v148, v126, v40
    v_fma_f32 v41, -v150, v126, v41
    v_fma_f32 v42, -v152, v126, v42
    v_fma_f32 v43, -v154, v126, v43
    v_fma_f32 v44, -v156, v126, v44
    v_fma_f32 v45, -v158, v126, v45
    v_fma_f32 v46, -v160, v126, v46
    v_fma_f32 v47, -v162, v126, v47
    v_cvt_pk_bf16_f32 v120, v40, v41
    v_cvt_pk_bf16_f32 v121, v42, v43
    v_cvt_pk_bf16_f32 v122, v44, v45
    v_cvt_pk_bf16_f32 v123, v46, v47
    s_add_u32 s30, s39, 640
    buffer_store_dwordx4 v[120:123], v98, s[20:23], s30 offen sc1
    v_mul_f32 v48, v133, v48
    v_mul_f32 v49, v135, v49
    v_mul_f32 v50, v137, v50
    v_mul_f32 v51, v139, v51
    v_mul_f32 v52, v141, v52
    v_mul_f32 v53, v143, v53
    v_mul_f32 v54, v145, v54
    v_mul_f32 v55, v147, v55
    v_fma_f32 v48, -v132, v127, v48
    v_fma_f32 v49, -v134, v127, v49
    v_fma_f32 v50, -v136, v127, v50
    v_fma_f32 v51, -v138, v127, v51
    v_fma_f32 v52, -v140, v127, v52
    v_fma_f32 v53, -v142, v127, v53
    v_fma_f32 v54, -v144, v127, v54
    v_fma_f32 v55, -v146, v127, v55
    v_cvt_pk_bf16_f32 v116, v48, v49
    v_cvt_pk_bf16_f32 v117, v50, v51
    v_cvt_pk_bf16_f32 v118, v52, v53
    v_cvt_pk_bf16_f32 v119, v54, v55
    s_add_u32 s30, s39, 0
    buffer_store_dwordx4 v[116:119], v99, s[20:23], s30 offen sc1
    v_mul_f32 v56, v149, v56
    v_mul_f32 v57, v151, v57
    v_mul_f32 v58, v153, v58
    v_mul_f32 v59, v155, v59
    v_mul_f32 v60, v157, v60
    v_mul_f32 v61, v159, v61
    v_mul_f32 v62, v161, v62
    v_mul_f32 v63, v163, v63
    v_fma_f32 v56, -v148, v127, v56
    v_fma_f32 v57, -v150, v127, v57
    v_fma_f32 v58, -v152, v127, v58
    v_fma_f32 v59, -v154, v127, v59
    v_fma_f32 v60, -v156, v127, v60
    v_fma_f32 v61, -v158, v127, v61
    v_fma_f32 v62, -v160, v127, v62
    v_fma_f32 v63, -v162, v127, v63
    v_cvt_pk_bf16_f32 v120, v56, v57
    v_cvt_pk_bf16_f32 v121, v58, v59
    v_cvt_pk_bf16_f32 v122, v60, v61
    v_cvt_pk_bf16_f32 v123, v62, v63
    s_add_u32 s30, s39, 640
    buffer_store_dwordx4 v[120:123], v99, s[20:23], s30 offen sc1
sequential_preLN__softmax_full_mha__dense_activation_silu__prompt_kernel_p1m:
    s_waitcnt vmcnt(0)
sequential_preLN__softmax_full_mha__dense_activation_silu__prompt_kernel_p1d:
    s_barrier
    s_cmp_lg_u32 s28, 0
    s_cbranch_scc1 sequential_preLN__softmax_full_mha__dense_activation_silu__prompt_kernel_p1x
    s_lshl_b32 s30, s25, 8
    s_add_u32 s30, s30, 24295424
    s_mov_b64 exec, 1
    v_mov_b32 v116, s30
    v_mov_b32 v117, 1
    global_atomic_add v116, v117, s[8:9] sc1
    s_mov_b64 exec, -1
sequential_preLN__softmax_full_mha__dense_activation_silu__prompt_kernel_p1x:
    s_lshl_b32 s30, s28, 6
    v_add_u32 v0, s30, v112
    s_branch sequential_preLN__softmax_full_mha__dense_activation_silu__prompt_kernel_p2
sequential_preLN__softmax_full_mha__dense_activation_silu__prompt_kernel_end:
    s_endpgm
sequential_preLN__softmax_full_mha__dense_activation_silu__prompt_kernel_idle:
    v_lshrrev_b32 v116, 6, v0
    v_and_b32 v1, 63, v0
    s_nop 0
    v_readfirstlane_b32 s28, v116
    s_waitcnt lgkmcnt(0)
    s_cmp_lg_u32 s2, 195
    s_cbranch_scc1 sequential_preLN__softmax_full_mha__dense_activation_silu__prompt_kernel_st
    s_add_u32 s20, s8, 24281088
    s_addc_u32 s21, s9, 0
    s_and_b32 s21, s21, 0xffff
    s_mov_b32 s22, 24576
    s_mov_b32 s23, 0x20000
    v_lshlrev_b32 v2, 4, v0
    v_mov_b32 v4, 0
    v_mov_b32 v5, 0
    v_mov_b32 v6, 0
    v_mov_b32 v7, 0
    buffer_store_dwordx4 v[4:7], v2, s[20:23], 0 offen sc1
    v_add_u32 v2, 8192, v2
    buffer_store_dwordx4 v[4:7], v2, s[20:23], 0 offen sc1
    v_add_u32 v2, 8192, v2
    buffer_store_dwordx4 v[4:7], v2, s[20:23], 0 offen sc1
    v_add_u32 v2, 8192, v2
sequential_preLN__softmax_full_mha__dense_activation_silu__prompt_kernel_st:
    s_mul_i32 s30, s24, 163840
    s_add_u32 s12, s4, s30
    s_addc_u32 s13, s5, 0
    s_and_b32 s13, s13, 0xffff
    s_mov_b32 s14, 163840
    s_mov_b32 s15, 0x20000
    v_lshrrev_b32 v2, 3, v1
    v_mul_u32_u24 v3, 1280, v2
    v_and_b32 v8, 7, v1
    v_lshl_add_u32 v3, v8, 4, v3
    s_mul_i32 s30, s28, 20480
    s_mov_b32 s38, 0xffff0000
    s_add_u32 s31, s30, 0
    buffer_load_dwordx4 v[16:19], v3, s[12:15], s31 offen
    s_add_u32 s31, s30, 128
    buffer_load_dwordx4 v[20:23], v3, s[12:15], s31 offen
    s_add_u32 s31, s30, 256
    buffer_load_dwordx4 v[24:27], v3, s[12:15], s31 offen
    s_add_u32 s31, s30, 384
    buffer_load_dwordx4 v[28:31], v3, s[12:15], s31 offen
    s_add_u32 s31, s30, 512
    buffer_load_dwordx4 v[32:35], v3, s[12:15], s31 offen
    s_add_u32 s31, s30, 640
    buffer_load_dwordx4 v[36:39], v3, s[12:15], s31 offen
    s_add_u32 s31, s30, 768
    buffer_load_dwordx4 v[40:43], v3, s[12:15], s31 offen
    s_add_u32 s31, s30, 896
    buffer_load_dwordx4 v[44:47], v3, s[12:15], s31 offen
    s_add_u32 s31, s30, 1024
    buffer_load_dwordx4 v[48:51], v3, s[12:15], s31 offen
    s_add_u32 s31, s30, 1152
    buffer_load_dwordx4 v[52:55], v3, s[12:15], s31 offen
    s_add_u32 s31, s30, 10240
    buffer_load_dwordx4 v[56:59], v3, s[12:15], s31 offen
    s_add_u32 s31, s30, 10368
    buffer_load_dwordx4 v[60:63], v3, s[12:15], s31 offen
    s_add_u32 s31, s30, 10496
    buffer_load_dwordx4 v[64:67], v3, s[12:15], s31 offen
    s_add_u32 s31, s30, 10624
    buffer_load_dwordx4 v[68:71], v3, s[12:15], s31 offen
    s_add_u32 s31, s30, 10752
    buffer_load_dwordx4 v[72:75], v3, s[12:15], s31 offen
    s_add_u32 s31, s30, 10880
    buffer_load_dwordx4 v[76:79], v3, s[12:15], s31 offen
    s_add_u32 s31, s30, 11008
    buffer_load_dwordx4 v[80:83], v3, s[12:15], s31 offen
    s_add_u32 s31, s30, 11136
    buffer_load_dwordx4 v[84:87], v3, s[12:15], s31 offen
    s_add_u32 s31, s30, 11264
    buffer_load_dwordx4 v[88:91], v3, s[12:15], s31 offen
    s_add_u32 s31, s30, 11392
    buffer_load_dwordx4 v[92:95], v3, s[12:15], s31 offen
    s_add_u32 s20, s8, 24305664
    s_addc_u32 s21, s9, 0
    s_and_b32 s21, s21, 0xffff
    s_mov_b32 s22, 16384
    s_mov_b32 s23, 0x20000
    v_mov_b32 v100, 0
    v_mov_b32 v101, 0
    v_mov_b32 v102, 0
    v_mov_b32 v103, 0
    s_waitcnt vmcnt(19)
    v_lshlrev_b32 v108, 16, v16
    v_and_b32 v109, s38, v16
    v_add_f32 v100, v100, v108
    v_add_f32 v101, v101, v109
    v_fma_f32 v102, v108, v108, v102
    v_fma_f32 v103, v109, v109, v103
    v_lshlrev_b32 v110, 16, v17
    v_and_b32 v111, s38, v17
    v_add_f32 v100, v100, v110
    v_add_f32 v101, v101, v111
    v_fma_f32 v102, v110, v110, v102
    v_fma_f32 v103, v111, v111, v103
    v_lshlrev_b32 v108, 16, v18
    v_and_b32 v109, s38, v18
    v_add_f32 v100, v100, v108
    v_add_f32 v101, v101, v109
    v_fma_f32 v102, v108, v108, v102
    v_fma_f32 v103, v109, v109, v103
    v_lshlrev_b32 v110, 16, v19
    v_and_b32 v111, s38, v19
    v_add_f32 v100, v100, v110
    v_add_f32 v101, v101, v111
    v_fma_f32 v102, v110, v110, v102
    v_fma_f32 v103, v111, v111, v103
    s_waitcnt vmcnt(18)
    v_lshlrev_b32 v108, 16, v20
    v_and_b32 v109, s38, v20
    v_add_f32 v100, v100, v108
    v_add_f32 v101, v101, v109
    v_fma_f32 v102, v108, v108, v102
    v_fma_f32 v103, v109, v109, v103
    v_lshlrev_b32 v110, 16, v21
    v_and_b32 v111, s38, v21
    v_add_f32 v100, v100, v110
    v_add_f32 v101, v101, v111
    v_fma_f32 v102, v110, v110, v102
    v_fma_f32 v103, v111, v111, v103
    v_lshlrev_b32 v108, 16, v22
    v_and_b32 v109, s38, v22
    v_add_f32 v100, v100, v108
    v_add_f32 v101, v101, v109
    v_fma_f32 v102, v108, v108, v102
    v_fma_f32 v103, v109, v109, v103
    v_lshlrev_b32 v110, 16, v23
    v_and_b32 v111, s38, v23
    v_add_f32 v100, v100, v110
    v_add_f32 v101, v101, v111
    v_fma_f32 v102, v110, v110, v102
    v_fma_f32 v103, v111, v111, v103
    s_waitcnt vmcnt(17)
    v_lshlrev_b32 v108, 16, v24
    v_and_b32 v109, s38, v24
    v_add_f32 v100, v100, v108
    v_add_f32 v101, v101, v109
    v_fma_f32 v102, v108, v108, v102
    v_fma_f32 v103, v109, v109, v103
    v_lshlrev_b32 v110, 16, v25
    v_and_b32 v111, s38, v25
    v_add_f32 v100, v100, v110
    v_add_f32 v101, v101, v111
    v_fma_f32 v102, v110, v110, v102
    v_fma_f32 v103, v111, v111, v103
    v_lshlrev_b32 v108, 16, v26
    v_and_b32 v109, s38, v26
    v_add_f32 v100, v100, v108
    v_add_f32 v101, v101, v109
    v_fma_f32 v102, v108, v108, v102
    v_fma_f32 v103, v109, v109, v103
    v_lshlrev_b32 v110, 16, v27
    v_and_b32 v111, s38, v27
    v_add_f32 v100, v100, v110
    v_add_f32 v101, v101, v111
    v_fma_f32 v102, v110, v110, v102
    v_fma_f32 v103, v111, v111, v103
    s_waitcnt vmcnt(16)
    v_lshlrev_b32 v108, 16, v28
    v_and_b32 v109, s38, v28
    v_add_f32 v100, v100, v108
    v_add_f32 v101, v101, v109
    v_fma_f32 v102, v108, v108, v102
    v_fma_f32 v103, v109, v109, v103
    v_lshlrev_b32 v110, 16, v29
    v_and_b32 v111, s38, v29
    v_add_f32 v100, v100, v110
    v_add_f32 v101, v101, v111
    v_fma_f32 v102, v110, v110, v102
    v_fma_f32 v103, v111, v111, v103
    v_lshlrev_b32 v108, 16, v30
    v_and_b32 v109, s38, v30
    v_add_f32 v100, v100, v108
    v_add_f32 v101, v101, v109
    v_fma_f32 v102, v108, v108, v102
    v_fma_f32 v103, v109, v109, v103
    v_lshlrev_b32 v110, 16, v31
    v_and_b32 v111, s38, v31
    v_add_f32 v100, v100, v110
    v_add_f32 v101, v101, v111
    v_fma_f32 v102, v110, v110, v102
    v_fma_f32 v103, v111, v111, v103
    s_waitcnt vmcnt(15)
    v_lshlrev_b32 v108, 16, v32
    v_and_b32 v109, s38, v32
    v_add_f32 v100, v100, v108
    v_add_f32 v101, v101, v109
    v_fma_f32 v102, v108, v108, v102
    v_fma_f32 v103, v109, v109, v103
    v_lshlrev_b32 v110, 16, v33
    v_and_b32 v111, s38, v33
    v_add_f32 v100, v100, v110
    v_add_f32 v101, v101, v111
    v_fma_f32 v102, v110, v110, v102
    v_fma_f32 v103, v111, v111, v103
    v_lshlrev_b32 v108, 16, v34
    v_and_b32 v109, s38, v34
    v_add_f32 v100, v100, v108
    v_add_f32 v101, v101, v109
    v_fma_f32 v102, v108, v108, v102
    v_fma_f32 v103, v109, v109, v103
    v_lshlrev_b32 v110, 16, v35
    v_and_b32 v111, s38, v35
    v_add_f32 v100, v100, v110
    v_add_f32 v101, v101, v111
    v_fma_f32 v102, v110, v110, v102
    v_fma_f32 v103, v111, v111, v103
    s_waitcnt vmcnt(14)
    v_lshlrev_b32 v108, 16, v36
    v_and_b32 v109, s38, v36
    v_add_f32 v100, v100, v108
    v_add_f32 v101, v101, v109
    v_fma_f32 v102, v108, v108, v102
    v_fma_f32 v103, v109, v109, v103
    v_lshlrev_b32 v110, 16, v37
    v_and_b32 v111, s38, v37
    v_add_f32 v100, v100, v110
    v_add_f32 v101, v101, v111
    v_fma_f32 v102, v110, v110, v102
    v_fma_f32 v103, v111, v111, v103
    v_lshlrev_b32 v108, 16, v38
    v_and_b32 v109, s38, v38
    v_add_f32 v100, v100, v108
    v_add_f32 v101, v101, v109
    v_fma_f32 v102, v108, v108, v102
    v_fma_f32 v103, v109, v109, v103
    v_lshlrev_b32 v110, 16, v39
    v_and_b32 v111, s38, v39
    v_add_f32 v100, v100, v110
    v_add_f32 v101, v101, v111
    v_fma_f32 v102, v110, v110, v102
    v_fma_f32 v103, v111, v111, v103
    s_waitcnt vmcnt(13)
    v_lshlrev_b32 v108, 16, v40
    v_and_b32 v109, s38, v40
    v_add_f32 v100, v100, v108
    v_add_f32 v101, v101, v109
    v_fma_f32 v102, v108, v108, v102
    v_fma_f32 v103, v109, v109, v103
    v_lshlrev_b32 v110, 16, v41
    v_and_b32 v111, s38, v41
    v_add_f32 v100, v100, v110
    v_add_f32 v101, v101, v111
    v_fma_f32 v102, v110, v110, v102
    v_fma_f32 v103, v111, v111, v103
    v_lshlrev_b32 v108, 16, v42
    v_and_b32 v109, s38, v42
    v_add_f32 v100, v100, v108
    v_add_f32 v101, v101, v109
    v_fma_f32 v102, v108, v108, v102
    v_fma_f32 v103, v109, v109, v103
    v_lshlrev_b32 v110, 16, v43
    v_and_b32 v111, s38, v43
    v_add_f32 v100, v100, v110
    v_add_f32 v101, v101, v111
    v_fma_f32 v102, v110, v110, v102
    v_fma_f32 v103, v111, v111, v103
    s_waitcnt vmcnt(12)
    v_lshlrev_b32 v108, 16, v44
    v_and_b32 v109, s38, v44
    v_add_f32 v100, v100, v108
    v_add_f32 v101, v101, v109
    v_fma_f32 v102, v108, v108, v102
    v_fma_f32 v103, v109, v109, v103
    v_lshlrev_b32 v110, 16, v45
    v_and_b32 v111, s38, v45
    v_add_f32 v100, v100, v110
    v_add_f32 v101, v101, v111
    v_fma_f32 v102, v110, v110, v102
    v_fma_f32 v103, v111, v111, v103
    v_lshlrev_b32 v108, 16, v46
    v_and_b32 v109, s38, v46
    v_add_f32 v100, v100, v108
    v_add_f32 v101, v101, v109
    v_fma_f32 v102, v108, v108, v102
    v_fma_f32 v103, v109, v109, v103
    v_lshlrev_b32 v110, 16, v47
    v_and_b32 v111, s38, v47
    v_add_f32 v100, v100, v110
    v_add_f32 v101, v101, v111
    v_fma_f32 v102, v110, v110, v102
    v_fma_f32 v103, v111, v111, v103
    s_waitcnt vmcnt(11)
    v_lshlrev_b32 v108, 16, v48
    v_and_b32 v109, s38, v48
    v_add_f32 v100, v100, v108
    v_add_f32 v101, v101, v109
    v_fma_f32 v102, v108, v108, v102
    v_fma_f32 v103, v109, v109, v103
    v_lshlrev_b32 v110, 16, v49
    v_and_b32 v111, s38, v49
    v_add_f32 v100, v100, v110
    v_add_f32 v101, v101, v111
    v_fma_f32 v102, v110, v110, v102
    v_fma_f32 v103, v111, v111, v103
    v_lshlrev_b32 v108, 16, v50
    v_and_b32 v109, s38, v50
    v_add_f32 v100, v100, v108
    v_add_f32 v101, v101, v109
    v_fma_f32 v102, v108, v108, v102
    v_fma_f32 v103, v109, v109, v103
    v_lshlrev_b32 v110, 16, v51
    v_and_b32 v111, s38, v51
    v_add_f32 v100, v100, v110
    v_add_f32 v101, v101, v111
    v_fma_f32 v102, v110, v110, v102
    v_fma_f32 v103, v111, v111, v103
    s_waitcnt vmcnt(10)
    v_lshlrev_b32 v108, 16, v52
    v_and_b32 v109, s38, v52
    v_add_f32 v100, v100, v108
    v_add_f32 v101, v101, v109
    v_fma_f32 v102, v108, v108, v102
    v_fma_f32 v103, v109, v109, v103
    v_lshlrev_b32 v110, 16, v53
    v_and_b32 v111, s38, v53
    v_add_f32 v100, v100, v110
    v_add_f32 v101, v101, v111
    v_fma_f32 v102, v110, v110, v102
    v_fma_f32 v103, v111, v111, v103
    v_lshlrev_b32 v108, 16, v54
    v_and_b32 v109, s38, v54
    v_add_f32 v100, v100, v108
    v_add_f32 v101, v101, v109
    v_fma_f32 v102, v108, v108, v102
    v_fma_f32 v103, v109, v109, v103
    v_lshlrev_b32 v110, 16, v55
    v_and_b32 v111, s38, v55
    v_add_f32 v100, v100, v110
    v_add_f32 v101, v101, v111
    v_fma_f32 v102, v110, v110, v102
    v_fma_f32 v103, v111, v111, v103
    v_add_f32 v100, v100, v101
    v_add_f32 v102, v102, v103
    s_nop 1
    v_add_f32_dpp v100, v100, v100 quad_perm:[1,0,3,2] row_mask:0xf bank_mask:0xf
    v_add_f32_dpp v102, v102, v102 quad_perm:[1,0,3,2] row_mask:0xf bank_mask:0xf
    s_nop 1
    v_add_f32_dpp v100, v100, v100 quad_perm:[2,3,0,1] row_mask:0xf bank_mask:0xf
    v_add_f32_dpp v102, v102, v102 quad_perm:[2,3,0,1] row_mask:0xf bank_mask:0xf
    s_nop 1
    v_add_f32_dpp v100, v100, v100 row_half_mirror row_mask:0xf bank_mask:0xf
    v_add_f32_dpp v102, v102, v102 row_half_mirror row_mask:0xf bank_mask:0xf
    v_mul_f32 v100, 0x3acccccd, v100
    v_mul_f32 v102, 0x3acccccd, v102
    v_fma_f32 v102, -v100, v100, v102
    v_max_f32 v102, 0, v102
    v_add_f32 v102, 0x3727c5ac, v102
    v_rsq_f32 v101, v102
    s_lshl_b32 s31, s24, 7
    s_lshl_b32 s32, s28, 4
    s_add_u32 s31, s31, s32
    s_add_u32 s31, s31, 0
    s_lshl_b32 s31, s31, 3
    v_lshlrev_b32 v9, 3, v2
    s_mov_b32 exec_lo, 0x01010101
    s_mov_b32 exec_hi, 0x01010101
    buffer_store_dwordx2 v[100:101], v9, s[20:23], s31 offen sc1
    s_mov_b64 exec, -1
    v_mov_b32 v104, 0
    v_mov_b32 v105, 0
    v_mov_b32 v106, 0
    v_mov_b32 v107, 0
    s_waitcnt vmcnt(9)
    v_lshlrev_b32 v108, 16, v56
    v_and_b32 v109, s38, v56
    v_add_f32 v104, v104, v108
    v_add_f32 v105, v105, v109
    v_fma_f32 v106, v108, v108, v106
    v_fma_f32 v107, v109, v109, v107
    v_lshlrev_b32 v110, 16, v57
    v_and_b32 v111, s38, v57
    v_add_f32 v104, v104, v110
    v_add_f32 v105, v105, v111
    v_fma_f32 v106, v110, v110, v106
    v_fma_f32 v107, v111, v111, v107
    v_lshlrev_b32 v108, 16, v58
    v_and_b32 v109, s38, v58
    v_add_f32 v104, v104, v108
    v_add_f32 v105, v105, v109
    v_fma_f32 v106, v108, v108, v106
    v_fma_f32 v107, v109, v109, v107
    v_lshlrev_b32 v110, 16, v59
    v_and_b32 v111, s38, v59
    v_add_f32 v104, v104, v110
    v_add_f32 v105, v105, v111
    v_fma_f32 v106, v110, v110, v106
    v_fma_f32 v107, v111, v111, v107
    s_waitcnt vmcnt(8)
    v_lshlrev_b32 v108, 16, v60
    v_and_b32 v109, s38, v60
    v_add_f32 v104, v104, v108
    v_add_f32 v105, v105, v109
    v_fma_f32 v106, v108, v108, v106
    v_fma_f32 v107, v109, v109, v107
    v_lshlrev_b32 v110, 16, v61
    v_and_b32 v111, s38, v61
    v_add_f32 v104, v104, v110
    v_add_f32 v105, v105, v111
    v_fma_f32 v106, v110, v110, v106
    v_fma_f32 v107, v111, v111, v107
    v_lshlrev_b32 v108, 16, v62
    v_and_b32 v109, s38, v62
    v_add_f32 v104, v104, v108
    v_add_f32 v105, v105, v109
    v_fma_f32 v106, v108, v108, v106
    v_fma_f32 v107, v109, v109, v107
    v_lshlrev_b32 v110, 16, v63
    v_and_b32 v111, s38, v63
    v_add_f32 v104, v104, v110
    v_add_f32 v105, v105, v111
    v_fma_f32 v106, v110, v110, v106
    v_fma_f32 v107, v111, v111, v107
    s_waitcnt vmcnt(7)
    v_lshlrev_b32 v108, 16, v64
    v_and_b32 v109, s38, v64
    v_add_f32 v104, v104, v108
    v_add_f32 v105, v105, v109
    v_fma_f32 v106, v108, v108, v106
    v_fma_f32 v107, v109, v109, v107
    v_lshlrev_b32 v110, 16, v65
    v_and_b32 v111, s38, v65
    v_add_f32 v104, v104, v110
    v_add_f32 v105, v105, v111
    v_fma_f32 v106, v110, v110, v106
    v_fma_f32 v107, v111, v111, v107
    v_lshlrev_b32 v108, 16, v66
    v_and_b32 v109, s38, v66
    v_add_f32 v104, v104, v108
    v_add_f32 v105, v105, v109
    v_fma_f32 v106, v108, v108, v106
    v_fma_f32 v107, v109, v109, v107
    v_lshlrev_b32 v110, 16, v67
    v_and_b32 v111, s38, v67
    v_add_f32 v104, v104, v110
    v_add_f32 v105, v105, v111
    v_fma_f32 v106, v110, v110, v106
    v_fma_f32 v107, v111, v111, v107
    s_waitcnt vmcnt(6)
    v_lshlrev_b32 v108, 16, v68
    v_and_b32 v109, s38, v68
    v_add_f32 v104, v104, v108
    v_add_f32 v105, v105, v109
    v_fma_f32 v106, v108, v108, v106
    v_fma_f32 v107, v109, v109, v107
    v_lshlrev_b32 v110, 16, v69
    v_and_b32 v111, s38, v69
    v_add_f32 v104, v104, v110
    v_add_f32 v105, v105, v111
    v_fma_f32 v106, v110, v110, v106
    v_fma_f32 v107, v111, v111, v107
    v_lshlrev_b32 v108, 16, v70
    v_and_b32 v109, s38, v70
    v_add_f32 v104, v104, v108
    v_add_f32 v105, v105, v109
    v_fma_f32 v106, v108, v108, v106
    v_fma_f32 v107, v109, v109, v107
    v_lshlrev_b32 v110, 16, v71
    v_and_b32 v111, s38, v71
    v_add_f32 v104, v104, v110
    v_add_f32 v105, v105, v111
    v_fma_f32 v106, v110, v110, v106
    v_fma_f32 v107, v111, v111, v107
    s_waitcnt vmcnt(5)
    v_lshlrev_b32 v108, 16, v72
    v_and_b32 v109, s38, v72
    v_add_f32 v104, v104, v108
    v_add_f32 v105, v105, v109
    v_fma_f32 v106, v108, v108, v106
    v_fma_f32 v107, v109, v109, v107
    v_lshlrev_b32 v110, 16, v73
    v_and_b32 v111, s38, v73
    v_add_f32 v104, v104, v110
    v_add_f32 v105, v105, v111
    v_fma_f32 v106, v110, v110, v106
    v_fma_f32 v107, v111, v111, v107
    v_lshlrev_b32 v108, 16, v74
    v_and_b32 v109, s38, v74
    v_add_f32 v104, v104, v108
    v_add_f32 v105, v105, v109
    v_fma_f32 v106, v108, v108, v106
    v_fma_f32 v107, v109, v109, v107
    v_lshlrev_b32 v110, 16, v75
    v_and_b32 v111, s38, v75
    v_add_f32 v104, v104, v110
    v_add_f32 v105, v105, v111
    v_fma_f32 v106, v110, v110, v106
    v_fma_f32 v107, v111, v111, v107
    s_waitcnt vmcnt(4)
    v_lshlrev_b32 v108, 16, v76
    v_and_b32 v109, s38, v76
    v_add_f32 v104, v104, v108
    v_add_f32 v105, v105, v109
    v_fma_f32 v106, v108, v108, v106
    v_fma_f32 v107, v109, v109, v107
    v_lshlrev_b32 v110, 16, v77
    v_and_b32 v111, s38, v77
    v_add_f32 v104, v104, v110
    v_add_f32 v105, v105, v111
    v_fma_f32 v106, v110, v110, v106
    v_fma_f32 v107, v111, v111, v107
    v_lshlrev_b32 v108, 16, v78
    v_and_b32 v109, s38, v78
    v_add_f32 v104, v104, v108
    v_add_f32 v105, v105, v109
    v_fma_f32 v106, v108, v108, v106
    v_fma_f32 v107, v109, v109, v107
    v_lshlrev_b32 v110, 16, v79
    v_and_b32 v111, s38, v79
    v_add_f32 v104, v104, v110
    v_add_f32 v105, v105, v111
    v_fma_f32 v106, v110, v110, v106
    v_fma_f32 v107, v111, v111, v107
    s_waitcnt vmcnt(3)
    v_lshlrev_b32 v108, 16, v80
    v_and_b32 v109, s38, v80
    v_add_f32 v104, v104, v108
    v_add_f32 v105, v105, v109
    v_fma_f32 v106, v108, v108, v106
    v_fma_f32 v107, v109, v109, v107
    v_lshlrev_b32 v110, 16, v81
    v_and_b32 v111, s38, v81
    v_add_f32 v104, v104, v110
    v_add_f32 v105, v105, v111
    v_fma_f32 v106, v110, v110, v106
    v_fma_f32 v107, v111, v111, v107
    v_lshlrev_b32 v108, 16, v82
    v_and_b32 v109, s38, v82
    v_add_f32 v104, v104, v108
    v_add_f32 v105, v105, v109
    v_fma_f32 v106, v108, v108, v106
    v_fma_f32 v107, v109, v109, v107
    v_lshlrev_b32 v110, 16, v83
    v_and_b32 v111, s38, v83
    v_add_f32 v104, v104, v110
    v_add_f32 v105, v105, v111
    v_fma_f32 v106, v110, v110, v106
    v_fma_f32 v107, v111, v111, v107
    s_waitcnt vmcnt(2)
    v_lshlrev_b32 v108, 16, v84
    v_and_b32 v109, s38, v84
    v_add_f32 v104, v104, v108
    v_add_f32 v105, v105, v109
    v_fma_f32 v106, v108, v108, v106
    v_fma_f32 v107, v109, v109, v107
    v_lshlrev_b32 v110, 16, v85
    v_and_b32 v111, s38, v85
    v_add_f32 v104, v104, v110
    v_add_f32 v105, v105, v111
    v_fma_f32 v106, v110, v110, v106
    v_fma_f32 v107, v111, v111, v107
    v_lshlrev_b32 v108, 16, v86
    v_and_b32 v109, s38, v86
    v_add_f32 v104, v104, v108
    v_add_f32 v105, v105, v109
    v_fma_f32 v106, v108, v108, v106
    v_fma_f32 v107, v109, v109, v107
    v_lshlrev_b32 v110, 16, v87
    v_and_b32 v111, s38, v87
    v_add_f32 v104, v104, v110
    v_add_f32 v105, v105, v111
    v_fma_f32 v106, v110, v110, v106
    v_fma_f32 v107, v111, v111, v107
    s_waitcnt vmcnt(1)
    v_lshlrev_b32 v108, 16, v88
    v_and_b32 v109, s38, v88
    v_add_f32 v104, v104, v108
    v_add_f32 v105, v105, v109
    v_fma_f32 v106, v108, v108, v106
    v_fma_f32 v107, v109, v109, v107
    v_lshlrev_b32 v110, 16, v89
    v_and_b32 v111, s38, v89
    v_add_f32 v104, v104, v110
    v_add_f32 v105, v105, v111
    v_fma_f32 v106, v110, v110, v106
    v_fma_f32 v107, v111, v111, v107
    v_lshlrev_b32 v108, 16, v90
    v_and_b32 v109, s38, v90
    v_add_f32 v104, v104, v108
    v_add_f32 v105, v105, v109
    v_fma_f32 v106, v108, v108, v106
    v_fma_f32 v107, v109, v109, v107
    v_lshlrev_b32 v110, 16, v91
    v_and_b32 v111, s38, v91
    v_add_f32 v104, v104, v110
    v_add_f32 v105, v105, v111
    v_fma_f32 v106, v110, v110, v106
    v_fma_f32 v107, v111, v111, v107
    s_waitcnt vmcnt(0)
    v_lshlrev_b32 v108, 16, v92
    v_and_b32 v109, s38, v92
    v_add_f32 v104, v104, v108
    v_add_f32 v105, v105, v109
    v_fma_f32 v106, v108, v108, v106
    v_fma_f32 v107, v109, v109, v107
    v_lshlrev_b32 v110, 16, v93
    v_and_b32 v111, s38, v93
    v_add_f32 v104, v104, v110
    v_add_f32 v105, v105, v111
    v_fma_f32 v106, v110, v110, v106
    v_fma_f32 v107, v111, v111, v107
    v_lshlrev_b32 v108, 16, v94
    v_and_b32 v109, s38, v94
    v_add_f32 v104, v104, v108
    v_add_f32 v105, v105, v109
    v_fma_f32 v106, v108, v108, v106
    v_fma_f32 v107, v109, v109, v107
    v_lshlrev_b32 v110, 16, v95
    v_and_b32 v111, s38, v95
    v_add_f32 v104, v104, v110
    v_add_f32 v105, v105, v111
    v_fma_f32 v106, v110, v110, v106
    v_fma_f32 v107, v111, v111, v107
    v_add_f32 v104, v104, v105
    v_add_f32 v106, v106, v107
    s_nop 1
    v_add_f32_dpp v104, v104, v104 quad_perm:[1,0,3,2] row_mask:0xf bank_mask:0xf
    v_add_f32_dpp v106, v106, v106 quad_perm:[1,0,3,2] row_mask:0xf bank_mask:0xf
    s_nop 1
    v_add_f32_dpp v104, v104, v104 quad_perm:[2,3,0,1] row_mask:0xf bank_mask:0xf
    v_add_f32_dpp v106, v106, v106 quad_perm:[2,3,0,1] row_mask:0xf bank_mask:0xf
    s_nop 1
    v_add_f32_dpp v104, v104, v104 row_half_mirror row_mask:0xf bank_mask:0xf
    v_add_f32_dpp v106, v106, v106 row_half_mirror row_mask:0xf bank_mask:0xf
    v_mul_f32 v104, 0x3acccccd, v104
    v_mul_f32 v106, 0x3acccccd, v106
    v_fma_f32 v106, -v104, v104, v106
    v_max_f32 v106, 0, v106
    v_add_f32 v106, 0x3727c5ac, v106
    v_rsq_f32 v105, v106
    s_lshl_b32 s31, s24, 7
    s_lshl_b32 s32, s28, 4
    s_add_u32 s31, s31, s32
    s_add_u32 s31, s31, 8
    s_lshl_b32 s31, s31, 3
    v_lshlrev_b32 v9, 3, v2
    s_mov_b32 exec_lo, 0x01010101
    s_mov_b32 exec_hi, 0x01010101
    buffer_store_dwordx2 v[104:105], v9, s[20:23], s31 offen sc1
    s_mov_b64 exec, -1
    s_load_dwordx2 s[46:47], s[0:1], 56
    s_waitcnt vmcnt(0) lgkmcnt(0)
    s_barrier
    s_cmp_lg_u32 s28, 0
    s_cbranch_scc1 sequential_preLN__softmax_full_mha__dense_activation_silu__prompt_kernel_end2
    s_lshl_b32 s30, s24, 2
    s_mov_b64 exec, 1
    v_mov_b32 v2, s30
    v_mov_b32 v3, 1
    global_atomic_add v2, v3, s[46:47] sc1
    v_mov_b32 v2, 64
    s_cmp_lg_u32 s2, 195
    s_cbranch_scc1 sequential_preLN__softmax_full_mha__dense_activation_silu__prompt_kernel_zw
    global_atomic_add v2, v3, s[46:47] sc1
sequential_preLN__softmax_full_mha__dense_activation_silu__prompt_kernel_zw:
    s_mov_b32 s31, 262144
sequential_preLN__softmax_full_mha__dense_activation_silu__prompt_kernel_zp:
    global_load_dword v4, v2, s[46:47] sc1
    s_waitcnt vmcnt(0)
    v_cmp_eq_u32 vcc, 0, v4
    s_cbranch_vccz sequential_preLN__softmax_full_mha__dense_activation_silu__prompt_kernel_zd
    s_sub_u32 s31, s31, 1
    s_cmp_lg_u32 s31, 0
    s_cbranch_scc1 sequential_preLN__softmax_full_mha__dense_activation_silu__prompt_kernel_zp
sequential_preLN__softmax_full_mha__dense_activation_silu__prompt_kernel_zd:
    s_mov_b64 exec, -1
sequential_preLN__softmax_full_mha__dense_activation_silu__prompt_kernel_end2:
    s_branch sequential_preLN__softmax_full_mha__dense_activation_silu__prompt_kernel_p2
sequential_preLN__softmax_full_mha__dense_activation_silu__prompt_kernel_p2:
    s_load_dwordx2 s[4:5], s[0:1], 64
    s_and_b32 s30, s2, 7
    s_lshr_b32 s31, s2, 3
    s_lshl_b32 s20, s30, 2
    s_lshr_b32 s32, s31, 3
    s_add_u32 s20, s20, s32
    s_and_b32 s21, s31, 7
    v_lshrrev_b32 v152, 6, v0
    v_and_b32 v148, 63, v0
    v_lshlrev_b32 v147, 4, v148
    v_readfirstlane_b32 s22, v152
    v_and_b32 v149, 31, v148
    v_lshrrev_b32 v150, 5, v148
    v_mov_b32 v8, 0
    v_mov_b32 v9, 0
    v_mov_b32 v14, 0
    v_mov_b32 v15, 0
    s_and_b32 s27, s22, 3
    s_lshr_b32 s35, s22, 2
    s_mov_b32 s26, 0
    s_waitcnt lgkmcnt(0)
    s_lshr_b32 s30, s20, 1
    s_mul_i32 s30, s30, 2560
    s_and_b32 s56, s20, 1
    s_add_u32 s8, s4, s30
    s_addc_u32 s9, s5, 0
    s_and_b32 s9, s9, 0xffff
    s_mov_b32 s10, 2621440
    s_mov_b32 s11, 0x20000
    s_add_u32 s30, s30, 5242880
    s_lshl_b32 s31, s21, 3
    s_lshl_b32 s32, s27, 1
    s_add_u32 s31, s31, s32
    s_mul_i32 s31, s31, 40960
    s_add_u32 s30, s30, s31
    s_add_u32 s12, s4, s30
    s_addc_u32 s13, s5, 0
    s_and_b32 s13, s13, 0xffff
    s_mov_b32 s14, 43520
    s_mov_b32 s15, 0x20000
    s_mul_i32 s30, s20, 81920
    s_add_u32 s30, s30, 2621440
    s_add_u32 s52, s4, s30
    s_addc_u32 s53, s5, 0
    s_and_b32 s53, s53, 0xffff
    s_mov_b32 s54, 81920
    s_mov_b32 s55, 0x20000
    s_mul_i32 s30, s56, 1536
    v_add_u32 v200, s30, v147
    s_lshl_b32 s30, s56, 3
    s_add_u32 s30, s30, 1024
    v_lshrrev_b32 v152, 1, v148
    v_lshlrev_b32 v152, 4, v152
    v_and_b32 v153, 1, v148
    v_lshl_add_u32 v152, v153, 2, v152
    v_add_u32 v201, s30, v152
    v_lshlrev_b32 v152, 4, v149
    v_add_u32 v202, s30, v152
    s_lshl_b32 s57, s35, 5
    s_add_u32 s57, s57, s27
    s_mul_i32 s23, s57, 40960
    s_mul_i32 s58, s35, 40960
    s_lshl_b32 s30, s27, 10
    s_add_u32 s58, s58, s30
    s_lshl_b32 s59, s57, 10
    s_lshl_b32 s60, s57, 8
    s_add_u32 s60, s60, 65536
    s_mul_i32 s61, s35, 40960
    s_lshl_b32 s30, s27, 8
    s_add_u32 s61, s61, s30
    s_add_u32 s61, s61, 4096
    s_add_u32 s16, s4, 7864320
    s_addc_u32 s17, s5, 0
    s_and_b32 s17, s17, 0xffff
    s_mov_b32 s18, 2621440
    s_mov_b32 s19, 0x20000
    s_mov_b32 s28, 0x000fffff
    s_mov_b32 s29, 0x000fffff
    v_cmp_eq_u32 vcc, 20, v149
    v_mov_b32 v152, 0x3f803f80
    s_nop 0
    v_cndmask_b32 v153, 0, v152, vcc
    v_mov_b32 v104, v153
    v_mov_b32 v108, v153
    v_mov_b32 v105, v153
    v_mov_b32 v109, v153
    v_mov_b32 v106, v153
    v_mov_b32 v110, v153
    v_mov_b32 v107, v153
    v_mov_b32 v111, v153
    s_lshl_b32 s30, s21, 2
    s_add_u32 s30, s30, s27
    s_mul_i32 s51, s30, 81920
    s_lshl_b32 s31, s35, 9
    s_add_u32 s51, s51, s31
    s_mul_i32 s31, s20, 5
    v_lshlrev_b32 v160, 4, v149
    v_add_u32 v156, s31, v150
    v_lshrrev_b32 v157, 3, v156
    v_lshlrev_b32 v157, 2, v157
    v_bfe_u32 v158, v156, 2, 1
    v_lshl_add_u32 v157, v158, 1, v157
    v_and_b32 v158, 1, v156
    v_add_u32 v157, v157, v158
    v_lshl_add_u32 v157, v157, 10, v160
    v_bfe_u32 v158, v156, 1, 1
    v_lshl_add_u32 v197, v158, 3, v157
    v_add_u32 v156, s31, v150
    v_add_u32 v156, 2, v156
    v_lshrrev_b32 v157, 3, v156
    v_lshlrev_b32 v157, 2, v157
    v_bfe_u32 v158, v156, 2, 1
    v_lshl_add_u32 v157, v158, 1, v157
    v_and_b32 v158, 1, v156
    v_add_u32 v157, v157, v158
    v_lshl_add_u32 v157, v157, 10, v160
    v_bfe_u32 v158, v156, 1, 1
    v_lshl_add_u32 v198, v158, 3, v157
    v_add_u32 v156, s31, v150
    v_add_u32 v156, 4, v156
    v_lshrrev_b32 v157, 3, v156
    v_lshlrev_b32 v157, 2, v157
    v_bfe_u32 v158, v156, 2, 1
    v_lshl_add_u32 v157, v158, 1, v157
    v_and_b32 v158, 1, v156
    v_add_u32 v157, v157, v158
    v_lshl_add_u32 v157, v157, 10, v160
    v_bfe_u32 v158, v156, 1, 1
    v_lshl_add_u32 v199, v158, 3, v157
    s_lshl_b32 s30, s35, 15
    v_add_u32 v144, s30, v147
    s_lshl_b32 s30, s35, 13
    s_add_u32 s30, s30, 65536
    v_lshlrev_b32 v145, 3, v149
    v_add_u32 v145, s30, v145
    s_mul_i32 s30, s35, 40960
    s_add_u32 s30, s30, 81920
    v_mul_u32_u24 v146, 320, v150
    v_lshl_add_u32 v146, v149, 4, v146
    v_add_u32 v146, s30, v146
    v_mov_b32 v64, 0
    v_mov_b32 v65, 0
    v_mov_b32 v66, 0
    v_mov_b32 v67, 0
    v_mov_b32 v68, 0
    v_mov_b32 v69, 0
    v_mov_b32 v70, 0
    v_mov_b32 v71, 0
    v_mov_b32 v72, 0
    v_mov_b32 v73, 0
    v_mov_b32 v74, 0
    v_mov_b32 v75, 0
    v_mov_b32 v76, 0
    v_mov_b32 v77, 0
    v_mov_b32 v78, 0
    v_mov_b32 v79, 0
    v_mov_b32 v80, 0
    v_mov_b32 v81, 0
    v_mov_b32 v82, 0
    v_mov_b32 v83, 0
    v_mov_b32 v84, 0
    v_mov_b32 v85, 0
    v_mov_b32 v86, 0
    v_mov_b32 v87, 0
    v_mov_b32 v88, 0
    v_mov_b32 v89, 0
    v_mov_b32 v90, 0
    v_mov_b32 v91, 0
    v_mov_b32 v92, 0
    v_mov_b32 v93, 0
    v_mov_b32 v94, 0
    v_mov_b32 v95, 0
    v_mov_b32 v56, 0
    v_mov_b32 v57, 0
    v_mov_b32 v58, 0
    v_mov_b32 v59, 0
    v_mov_b32 v60, 0
    v_mov_b32 v61, 0
    v_mov_b32 v62, 0
    v_mov_b32 v63, 0
    s_mov_b32 s40, s4
    s_and_b32 s41, s5, 0xffff
    s_mov_b32 s42, 0
    s_mov_b32 s43, 0x20000
    v_mov_b32 v192, 0
    v_mov_b32 v193, 0
    v_mov_b32 v194, 0
    v_mov_b32 v195, 0
    v_mov_b32 v196, 0
    s_mov_b32 s48, 0
    s_mov_b32 s49, 0
    s_lshl_b32 s30, s22, 8
    s_add_u32 s30, s30, s2
    s_mov_b32 s50, 0
    s_cmp_ge_u32 s30, 1184
    s_cbranch_scc1 sequential_preLN__softmax_full_mha__dense_activation_silu__prompt_kernel_att_rp_done
    s_cmp_ge_u32 s30, 640
    s_cbranch_scc1 sequential_preLN__softmax_full_mha__dense_activation_silu__prompt_kernel_att_rp_b
    s_load_dwordx2 s[40:41], s[0:1], 32
    s_mul_i32 s31, s30, 1639
    s_lshr_b32 s31, s31, 16
    s_mul_i32 s32, s31, 40
    s_sub_u32 s32, s30, s32
    s_mul_i32 s48, s32, 49152
    s_mul_i32 s33, s31, 192
    s_add_u32 s48, s48, s33
    s_mul_i32 s49, s31, 122880
    s_mul_i32 s33, s32, 3072
    s_add_u32 s49, s49, s33
    s_add_u32 s49, s49, 22183936
    v_add_u32 v152, 0, v148
    v_mul_u32_u24 v153, 5462, v152
    v_lshrrev_b32 v153, 16, v153
    v_mul_u32_u24 v154, 12, v153
    v_sub_u32 v154, v152, v154
    v_mul_u32_u24 v153, 3072, v153
    v_lshl_add_u32 v192, v154, 4, v153
    v_add_u32 v152, 64, v148
    v_mul_u32_u24 v153, 5462, v152
    v_lshrrev_b32 v153, 16, v153
    v_mul_u32_u24 v154, 12, v153
    v_sub_u32 v154, v152, v154
    v_mul_u32_u24 v153, 3072, v153
    v_lshl_add_u32 v193, v154, 4, v153
    v_add_u32 v152, 128, v148
    v_mul_u32_u24 v153, 5462, v152
    v_lshrrev_b32 v153, 16, v153
    v_mul_u32_u24 v154, 12, v153
    v_sub_u32 v154, v152, v154
    v_mul_u32_u24 v153, 3072, v153
    v_lshl_add_u32 v194, v154, 4, v153
    s_waitcnt lgkmcnt(0)
    s_and_b32 s41, s41, 0xffff
    s_mov_b32 s42, 1966080
    s_mov_b32 s43, 0x20000
    s_mov_b32 s50, 3
    s_branch sequential_preLN__softmax_full_mha__dense_activation_silu__prompt_kernel_att_rp_done
sequential_preLN__softmax_full_mha__dense_activation_silu__prompt_kernel_att_rp_b:
    s_cmp_ge_u32 s30, 1024
    s_cbranch_scc1 sequential_preLN__softmax_full_mha__dense_activation_silu__prompt_kernel_att_rp_c
    s_load_dwordx2 s[40:41], s[0:1], 40
    s_sub_u32 s30, s30, 640
    s_mul_i32 s31, s30, 1366
    s_lshr_b32 s31, s31, 16
    s_mul_i32 s32, s31, 48
    s_sub_u32 s32, s30, s32
    s_mul_i32 s49, s31, 245760
    s_add_u32 s49, s49, 20217856
    s_mov_b32 s42, 1966080
    s_branch sequential_preLN__softmax_full_mha__dense_activation_silu__prompt_kernel_att_rp_bc
sequential_preLN__softmax_full_mha__dense_activation_silu__prompt_kernel_att_rp_c:
    s_load_dwordx2 s[40:41], s[0:1], 16
    s_sub_u32 s30, s30, 1024
    s_mul_i32 s31, s30, 3277
    s_lshr_b32 s31, s31, 16
    s_mul_i32 s32, s31, 20
    s_sub_u32 s32, s30, s32
    s_mul_i32 s49, s31, 102400
    s_add_u32 s49, s49, 19398656
    s_mov_b32 s42, 819200
sequential_preLN__softmax_full_mha__dense_activation_silu__prompt_kernel_att_rp_bc:
    s_mul_i32 s48, s32, 40960
    s_mul_i32 s33, s31, 160
    s_add_u32 s48, s48, s33
    s_mul_i32 s33, s32, 5120
    s_add_u32 s49, s49, s33
    v_add_u32 v152, 0, v148
    v_mul_u32_u24 v153, 6554, v152
    v_lshrrev_b32 v153, 16, v153
    v_mul_u32_u24 v154, 10, v153
    v_sub_u32 v154, v152, v154
    v_mul_u32_u24 v153, 1280, v153
    v_lshl_add_u32 v192, v154, 4, v153
    v_add_u32 v152, 64, v148
    v_mul_u32_u24 v153, 6554, v152
    v_lshrrev_b32 v153, 16, v153
    v_mul_u32_u24 v154, 10, v153
    v_sub_u32 v154, v152, v154
    v_mul_u32_u24 v153, 1280, v153
    v_lshl_add_u32 v193, v154, 4, v153
    v_add_u32 v152, 128, v148
    v_mul_u32_u24 v153, 6554, v152
    v_lshrrev_b32 v153, 16, v153
    v_mul_u32_u24 v154, 10, v153
    v_sub_u32 v154, v152, v154
    v_mul_u32_u24 v153, 1280, v153
    v_lshl_add_u32 v194, v154, 4, v153
    v_add_u32 v152, 192, v148
    v_mul_u32_u24 v153, 6554, v152
    v_lshrrev_b32 v153, 16, v153
    v_mul_u32_u24 v154, 10, v153
    v_sub_u32 v154, v152, v154
    v_mul_u32_u24 v153, 1280, v153
    v_lshl_add_u32 v195, v154, 4, v153
    v_add_u32 v152, 256, v148
    v_mul_u32_u24 v153, 6554, v152
    v_lshrrev_b32 v153, 16, v153
    v_mul_u32_u24 v154, 10, v153
    v_sub_u32 v154, v152, v154
    v_mul_u32_u24 v153, 1280, v153
    v_lshl_add_u32 v196, v154, 4, v153
    s_waitcnt lgkmcnt(0)
    s_and_b32 s41, s41, 0xffff
    s_mov_b32 s43, 0x20000
    s_mov_b32 s50, 5
sequential_preLN__softmax_full_mha__dense_activation_silu__prompt_kernel_att_rp_done:
    s_mov_b32 s44, s4
    s_and_b32 s45, s5, 0xffff
    s_mov_b32 s46, 24322048
    s_mov_b32 s47, 0x20000
    s_cmp_lg_u32 s22, 0
    s_cbranch_scc1 sequential_preLN__softmax_full_mha__dense_activation_silu__prompt_kernel_att_tw
    v_lshrrev_b32 v152, 1, v148
    v_min_u32 v152, 2, v152
    v_and_b32 v153, 1, v148
    s_lshr_b32 s30, s20, 1
    s_mul_i32 s30, s30, 5
    v_lshlrev_b32 v154, 2, v153
    v_add_u32 v154, s30, v154
    v_lshrrev_b32 v154, 4, v154
    s_mul_i32 s30, s20, 20
    v_mul_u32_u24 v155, 19, v153
    v_add_u32 v155, s30, v155
    v_lshrrev_b32 v155, 7, v155
    v_cmp_gt_u32 vcc, 2, v152
    v_mul_u32_u24 v156, 5, v152
    s_nop 0
    v_cndmask_b32 v154, v155, v154, vcc
    v_add_u32 v154, v154, v156
    v_lshlrev_b32 v154, 8, v154
    v_add_u32 v154, 24295424, v154
    s_mov_b32 s30, 262144
    s_mov_b64 exec, 0x3f
sequential_preLN__softmax_full_mha__dense_activation_silu__prompt_kernel_att_tp:
    global_load_dword v157, v154, s[4:5] sc1
    s_waitcnt vmcnt(0)
    v_cmp_gt_u32 vcc, 16, v157
    s_cbranch_vccz sequential_preLN__softmax_full_mha__dense_activation_silu__prompt_kernel_att_tw
    s_sub_u32 s30, s30, 1
    s_cmp_lg_u32 s30, 0
    s_cbranch_scc1 sequential_preLN__softmax_full_mha__dense_activation_silu__prompt_kernel_att_tp
sequential_preLN__softmax_full_mha__dense_activation_silu__prompt_kernel_att_tw:
    s_mov_b64 exec, -1
    s_barrier
    s_mul_i32 s30, s35, 40960
    s_sub_u32 s31, 40960, s30
    buffer_load_dwordx4 v[4:7], v200, s[12:15], s30 offen sc1
    buffer_load_dwordx4 v[10:13], v200, s[12:15], s31 offen sc1
    s_mov_b32 exec_hi, 0
    buffer_load_dwordx2 v[8:9], v202, s[12:15], s30 offen sc1
    buffer_load_dwordx2 v[14:15], v202, s[12:15], s31 offen sc1
    s_mov_b32 exec_hi, -1
    s_add_u32 m0, s59, 0
    s_add_u32 s24, s23, 0
    buffer_load_dwordx4 v200, s[8:11], s24 offen sc1 lds
    s_add_u32 m0, s60, 0
    s_add_u32 s24, s23, 0
    buffer_load_dword v201, s[8:11], s24 offen sc1 lds
    s_add_u32 m0, s58, 81920
    s_add_u32 s24, s58, 0
    buffer_load_dwordx4 v147, s[52:55], s24 offen sc1 lds
    s_add_u32 m0, s61, 81920
    s_add_u32 s24, s61, 0
    s_mov_b64 exec, 0xffff
    buffer_load_dwordx4 v147, s[52:55], s24 offen sc1 lds
    s_mov_b64 exec, -1
    s_waitcnt vmcnt(0)
    s_barrier
    ds_read_b128 v[96:99], v144 offset:0
    ds_read_b64 v[100:101], v145 offset:0
    s_mov_b64 exec, s[28:29]
    ds_read_b128 v[104:107], v146 offset:0
    ds_read_b128 v[108:111], v146 offset:640
    s_mov_b64 exec, -1
    s_waitcnt lgkmcnt(0)
    v_mfma_f32_32x32x16_bf16 v[16:31], v[96:99], v[4:7], 0
    v_mfma_f32_32x32x8_bf16 v[16:31], v[100:101], v[8:9], v[16:31]
    s_nop 7
    s_nop 3
    v_mfma_f32_32x32x16_bf16 v[32:47], v[96:99], v[10:13], 0
    ds_read_b128 v[96:99], v144 offset:1024
    v_exp_f32 v16, v16
    v_exp_f32 v17, v17
    v_exp_f32 v18, v18
    v_exp_f32 v19, v19
    v_cvt_pk_bf16_f32 v48, v16, v17
    v_cvt_pk_bf16_f32 v49, v18, v19
    v_mfma_f32_32x32x16_bf16 v[80:95], v[104:107], v[56:59], v[80:95]
    s_waitcnt lgkmcnt(0)
    v_exp_f32 v20, v20
    v_exp_f32 v21, v21
    v_exp_f32 v22, v22
    v_exp_f32 v23, v23
    v_cvt_pk_bf16_f32 v50, v20, v21
    v_cvt_pk_bf16_f32 v51, v22, v23
    v_mfma_f32_32x32x8_bf16 v[32:47], v[100:101], v[14:15], v[32:47]
    ds_read_b64 v[100:101], v145 offset:256
    v_exp_f32 v24, v24
    v_exp_f32 v25, v25
    v_exp_f32 v26, v26
    v_exp_f32 v27, v27
    v_cvt_pk_bf16_f32 v52, v24, v25
    v_cvt_pk_bf16_f32 v53, v26, v27
    v_mfma_f32_32x32x16_bf16 v[80:95], v[108:111], v[60:63], v[80:95]
    s_mov_b64 exec, s[28:29]
    ds_read_b128 v[104:107], v146 offset:0
    ds_read_b128 v[108:111], v146 offset:640
    s_mov_b64 exec, -1
    v_exp_f32 v28, v28
    v_exp_f32 v29, v29
    v_exp_f32 v30, v30
    v_exp_f32 v31, v31
    v_cvt_pk_bf16_f32 v54, v28, v29
    v_cvt_pk_bf16_f32 v55, v30, v31
    v_mfma_f32_32x32x16_bf16 v[16:31], v[96:99], v[4:7], 0
    s_waitcnt lgkmcnt(1)
    v_exp_f32 v32, v32
    v_exp_f32 v33, v33
    v_exp_f32 v34, v34
    v_exp_f32 v35, v35
    v_cvt_pk_bf16_f32 v56, v32, v33
    v_cvt_pk_bf16_f32 v57, v34, v35
    v_mfma_f32_32x32x16_bf16 v[64:79], v[104:107], v[48:51], v[64:79]
    s_setprio 0
    s_add_u32 m0, s59, 4096
    s_add_u32 s24, s23, 163840
    buffer_load_dwordx4 v200, s[8:11], s24 offen sc1 lds
    v_exp_f32 v36, v36
    v_exp_f32 v37, v37
    v_exp_f32 v38, v38
    v_exp_f32 v39, v39
    v_cvt_pk_bf16_f32 v58, v36, v37
    v_cvt_pk_bf16_f32 v59, v38, v39
    v_mfma_f32_32x32x8_bf16 v[16:31], v[100:101], v[8:9], v[16:31]
    s_waitcnt lgkmcnt(0)
    v_exp_f32 v40, v40
    v_exp_f32 v41, v41
    v_exp_f32 v42, v42
    v_exp_f32 v43, v43
    v_cvt_pk_bf16_f32 v60, v40, v41
    v_cvt_pk_bf16_f32 v61, v42, v43
    v_mfma_f32_32x32x16_bf16 v[64:79], v[108:111], v[52:55], v[64:79]
    s_setprio 1
    s_add_u32 m0, s60, 1024
    s_add_u32 s24, s23, 163840
    buffer_load_dword v201, s[8:11], s24 offen sc1 lds
    v_exp_f32 v44, v44
    v_exp_f32 v45, v45
    v_exp_f32 v46, v46
    v_exp_f32 v47, v47
    v_cvt_pk_bf16_f32 v62, v44, v45
    v_cvt_pk_bf16_f32 v63, v46, v47
    v_mfma_f32_32x32x16_bf16 v[32:47], v[96:99], v[10:13], 0
    ds_read_b128 v[96:99], v144 offset:2048
    v_exp_f32 v16, v16
    v_exp_f32 v17, v17
    v_exp_f32 v18, v18
    v_exp_f32 v19, v19
    v_cvt_pk_bf16_f32 v48, v16, v17
    v_cvt_pk_bf16_f32 v49, v18, v19
    v_mfma_f32_32x32x16_bf16 v[80:95], v[104:107], v[56:59], v[80:95]
    s_waitcnt lgkmcnt(0)
    v_exp_f32 v20, v20
    v_exp_f32 v21, v21
    v_exp_f32 v22, v22
    v_exp_f32 v23, v23
    v_cvt_pk_bf16_f32 v50, v20, v21
    v_cvt_pk_bf16_f32 v51, v22, v23
    v_mfma_f32_32x32x8_bf16 v[32:47], v[100:101], v[14:15], v[32:47]
    ds_read_b64 v[100:101], v145 offset:512
    v_exp_f32 v24, v24
    v_exp_f32 v25, v25
    v_exp_f32 v26, v26
    v_exp_f32 v27, v27
    v_cvt_pk_bf16_f32 v52, v24, v25
    v_cvt_pk_bf16_f32 v53, v26, v27
    v_mfma_f32_32x32x16_bf16 v[80:95], v[108:111], v[60:63], v[80:95]
    s_mov_b64 exec, s[28:29]
    ds_read_b128 v[104:107], v146 offset:1280
    ds_read_b128 v[108:111], v146 offset:1920
    s_mov_b64 exec, -1
    v_exp_f32 v28, v28
    v_exp_f32 v29, v29
    v_exp_f32 v30, v30
    v_exp_f32 v31, v31
    v_cvt_pk_bf16_f32 v54, v28, v29
    v_cvt_pk_bf16_f32 v55, v30, v31
    v_mfma_f32_32x32x16_bf16 v[16:31], v[96:99], v[4:7], 0
    s_waitcnt lgkmcnt(1)
    v_exp_f32 v32, v32
    v_exp_f32 v33, v33
    v_exp_f32 v34, v34
    v_exp_f32 v35, v35
    v_cvt_pk_bf16_f32 v56, v32, v33
    v_cvt_pk_bf16_f32 v57, v34, v35
    v_mfma_f32_32x32x16_bf16 v[64:79], v[104:107], v[48:51], v[64:79]
    s_setprio 0
    s_add_u32 m0, s58, 87040
    s_add_u32 s24, s58, 5120
    buffer_load_dwordx4 v147, s[52:55], s24 offen sc1 lds
    v_exp_f32 v36, v36
    v_exp_f32 v37, v37
    v_exp_f32 v38, v38
    v_exp_f32 v39, v39
    v_cvt_pk_bf16_f32 v58, v36, v37
    v_cvt_pk_bf16_f32 v59, v38, v39
    v_mfma_f32_32x32x8_bf16 v[16:31], v[100:101], v[8:9], v[16:31]
    s_waitcnt lgkmcnt(0)
    v_exp_f32 v40, v40
    v_exp_f32 v41, v41
    v_exp_f32 v42, v42
    v_exp_f32 v43, v43
    v_cvt_pk_bf16_f32 v60, v40, v41
    v_cvt_pk_bf16_f32 v61, v42, v43
    v_mfma_f32_32x32x16_bf16 v[64:79], v[108:111], v[52:55], v[64:79]
    s_setprio 1
    s_add_u32 m0, s61, 87040
    s_add_u32 s24, s61, 5120
    s_mov_b64 exec, 0xffff
    buffer_load_dwordx4 v147, s[52:55], s24 offen sc1 lds
    s_mov_b64 exec, -1
    v_exp_f32 v44, v44
    v_exp_f32 v45, v45
    v_exp_f32 v46, v46
    v_exp_f32 v47, v47
    v_cvt_pk_bf16_f32 v62, v44, v45
    v_cvt_pk_bf16_f32 v63, v46, v47
    v_mfma_f32_32x32x16_bf16 v[32:47], v[96:99], v[10:13], 0
    ds_read_b128 v[96:99], v144 offset:3072
    v_exp_f32 v16, v16
    v_exp_f32 v17, v17
    v_exp_f32 v18, v18
    v_exp_f32 v19, v19
    v_cvt_pk_bf16_f32 v48, v16, v17
    v_cvt_pk_bf16_f32 v49, v18, v19
    v_mfma_f32_32x32x16_bf16 v[80:95], v[104:107], v[56:59], v[80:95]
    s_waitcnt lgkmcnt(0)
    v_exp_f32 v20, v20
    v_exp_f32 v21, v21
    v_exp_f32 v22, v22
    v_exp_f32 v23, v23
    v_cvt_pk_bf16_f32 v50, v20, v21
    v_cvt_pk_bf16_f32 v51, v22, v23
    v_mfma_f32_32x32x8_bf16 v[32:47], v[100:101], v[14:15], v[32:47]
    ds_read_b64 v[100:101], v145 offset:768
    v_exp_f32 v24, v24
    v_exp_f32 v25, v25
    v_exp_f32 v26, v26
    v_exp_f32 v27, v27
    v_cvt_pk_bf16_f32 v52, v24, v25
    v_cvt_pk_bf16_f32 v53, v26, v27
    v_mfma_f32_32x32x16_bf16 v[80:95], v[108:111], v[60:63], v[80:95]
    s_mov_b64 exec, s[28:29]
    ds_read_b128 v[104:107], v146 offset:2560
    ds_read_b128 v[108:111], v146 offset:3200
    s_mov_b64 exec, -1
    v_exp_f32 v28, v28
    v_exp_f32 v29, v29
    v_exp_f32 v30, v30
    v_exp_f32 v31, v31
    v_cvt_pk_bf16_f32 v54, v28, v29
    v_cvt_pk_bf16_f32 v55, v30, v31
    v_mfma_f32_32x32x16_bf16 v[16:31], v[96:99], v[4:7], 0
    s_waitcnt lgkmcnt(1)
    v_exp_f32 v32, v32
    v_exp_f32 v33, v33
    v_exp_f32 v34, v34
    v_exp_f32 v35, v35
    v_cvt_pk_bf16_f32 v56, v32, v33
    v_cvt_pk_bf16_f32 v57, v34, v35
    v_mfma_f32_32x32x16_bf16 v[64:79], v[104:107], v[48:51], v[64:79]
    s_setprio 0
    s_add_u32 m0, s59, 8192
    s_add_u32 s24, s23, 327680
    buffer_load_dwordx4 v200, s[8:11], s24 offen sc1 lds
    v_exp_f32 v36, v36
    v_exp_f32 v37, v37
    v_exp_f32 v38, v38
    v_exp_f32 v39, v39
    v_cvt_pk_bf16_f32 v58, v36, v37
    v_cvt_pk_bf16_f32 v59, v38, v39
    v_mfma_f32_32x32x8_bf16 v[16:31], v[100:101], v[8:9], v[16:31]
    s_waitcnt lgkmcnt(0)
    v_exp_f32 v40, v40
    v_exp_f32 v41, v41
    v_exp_f32 v42, v42
    v_exp_f32 v43, v43
    v_cvt_pk_bf16_f32 v60, v40, v41
    v_cvt_pk_bf16_f32 v61, v42, v43
    v_mfma_f32_32x32x16_bf16 v[64:79], v[108:111], v[52:55], v[64:79]
    s_setprio 1
    s_add_u32 m0, s60, 2048
    s_add_u32 s24, s23, 327680
    buffer_load_dword v201, s[8:11], s24 offen sc1 lds
    v_exp_f32 v44, v44
    v_exp_f32 v45, v45
    v_exp_f32 v46, v46
    v_exp_f32 v47, v47
    v_cvt_pk_bf16_f32 v62, v44, v45
    v_cvt_pk_bf16_f32 v63, v46, v47
    s_waitcnt vmcnt(2)
    s_barrier
    v_mfma_f32_32x32x16_bf16 v[32:47], v[96:99], v[10:13], 0
    ds_read_b128 v[96:99], v144 offset:4096
    v_exp_f32 v16, v16
    v_exp_f32 v17, v17
    v_exp_f32 v18, v18
    v_exp_f32 v19, v19
    v_cvt_pk_bf16_f32 v48, v16, v17
    v_cvt_pk_bf16_f32 v49, v18, v19
    v_mfma_f32_32x32x16_bf16 v[80:95], v[104:107], v[56:59], v[80:95]
    s_waitcnt lgkmcnt(0)
    v_exp_f32 v20, v20
    v_exp_f32 v21, v21
    v_exp_f32 v22, v22
    v_exp_f32 v23, v23
    v_cvt_pk_bf16_f32 v50, v20, v21
    v_cvt_pk_bf16_f32 v51, v22, v23
    v_mfma_f32_32x32x8_bf16 v[32:47], v[100:101], v[14:15], v[32:47]
    ds_read_b64 v[100:101], v145 offset:1024
    v_exp_f32 v24, v24
    v_exp_f32 v25, v25
    v_exp_f32 v26, v26
    v_exp_f32 v27, v27
    v_cvt_pk_bf16_f32 v52, v24, v25
    v_cvt_pk_bf16_f32 v53, v26, v27
    v_mfma_f32_32x32x16_bf16 v[80:95], v[108:111], v[60:63], v[80:95]
    s_mov_b64 exec, s[28:29]
    ds_read_b128 v[104:107], v146 offset:3840
    ds_read_b128 v[108:111], v146 offset:4480
    s_mov_b64 exec, -1
    v_exp_f32 v28, v28
    v_exp_f32 v29, v29
    v_exp_f32 v30, v30
    v_exp_f32 v31, v31
    v_cvt_pk_bf16_f32 v54, v28, v29
    v_cvt_pk_bf16_f32 v55, v30, v31
    v_mfma_f32_32x32x16_bf16 v[16:31], v[96:99], v[4:7], 0
    s_waitcnt lgkmcnt(1)
    v_exp_f32 v32, v32
    v_exp_f32 v33, v33
    v_exp_f32 v34, v34
    v_exp_f32 v35, v35
    v_cvt_pk_bf16_f32 v56, v32, v33
    v_cvt_pk_bf16_f32 v57, v34, v35
    v_mfma_f32_32x32x16_bf16 v[64:79], v[104:107], v[48:51], v[64:79]
    s_setprio 0
    s_add_u32 m0, s58, 92160
    s_add_u32 s24, s58, 10240
    buffer_load_dwordx4 v147, s[52:55], s24 offen sc1 lds
    v_exp_f32 v36, v36
    v_exp_f32 v37, v37
    v_exp_f32 v38, v38
    v_exp_f32 v39, v39
    v_cvt_pk_bf16_f32 v58, v36, v37
    v_cvt_pk_bf16_f32 v59, v38, v39
    v_mfma_f32_32x32x8_bf16 v[16:31], v[100:101], v[8:9], v[16:31]
    s_waitcnt lgkmcnt(0)
    v_exp_f32 v40, v40
    v_exp_f32 v41, v41
    v_exp_f32 v42, v42
    v_exp_f32 v43, v43
    v_cvt_pk_bf16_f32 v60, v40, v41
    v_cvt_pk_bf16_f32 v61, v42, v43
    v_mfma_f32_32x32x16_bf16 v[64:79], v[108:111], v[52:55], v[64:79]
    s_setprio 1
    s_add_u32 m0, s61, 92160
    s_add_u32 s24, s61, 10240
    s_mov_b64 exec, 0xffff
    buffer_load_dwordx4 v147, s[52:55], s24 offen sc1 lds
    s_mov_b64 exec, -1
    v_exp_f32 v44, v44
    v_exp_f32 v45, v45
    v_exp_f32 v46, v46
    v_exp_f32 v47, v47
    v_cvt_pk_bf16_f32 v62, v44, v45
    v_cvt_pk_bf16_f32 v63, v46, v47
    v_mfma_f32_32x32x16_bf16 v[32:47], v[96:99], v[10:13], 0
    ds_read_b128 v[96:99], v144 offset:5120
    v_exp_f32 v16, v16
    v_exp_f32 v17, v17
    v_exp_f32 v18, v18
    v_exp_f32 v19, v19
    v_cvt_pk_bf16_f32 v48, v16, v17
    v_cvt_pk_bf16_f32 v49, v18, v19
    v_mfma_f32_32x32x16_bf16 v[80:95], v[104:107], v[56:59], v[80:95]
    s_waitcnt lgkmcnt(0)
    v_exp_f32 v20, v20
    v_exp_f32 v21, v21
    v_exp_f32 v22, v22
    v_exp_f32 v23, v23
    v_cvt_pk_bf16_f32 v50, v20, v21
    v_cvt_pk_bf16_f32 v51, v22, v23
    v_mfma_f32_32x32x8_bf16 v[32:47], v[100:101], v[14:15], v[32:47]
    ds_read_b64 v[100:101], v145 offset:1280
    v_exp_f32 v24, v24
    v_exp_f32 v25, v25
    v_exp_f32 v26, v26
    v_exp_f32 v27, v27
    v_cvt_pk_bf16_f32 v52, v24, v25
    v_cvt_pk_bf16_f32 v53, v26, v27
    v_mfma_f32_32x32x16_bf16 v[80:95], v[108:111], v[60:63], v[80:95]
    s_mov_b64 exec, s[28:29]
    ds_read_b128 v[104:107], v146 offset:5120
    ds_read_b128 v[108:111], v146 offset:5760
    s_mov_b64 exec, -1
    v_exp_f32 v28, v28
    v_exp_f32 v29, v29
    v_exp_f32 v30, v30
    v_exp_f32 v31, v31
    v_cvt_pk_bf16_f32 v54, v28, v29
    v_cvt_pk_bf16_f32 v55, v30, v31
    v_mfma_f32_32x32x16_bf16 v[16:31], v[96:99], v[4:7], 0
    s_waitcnt lgkmcnt(1)
    v_exp_f32 v32, v32
    v_exp_f32 v33, v33
    v_exp_f32 v34, v34
    v_exp_f32 v35, v35
    v_cvt_pk_bf16_f32 v56, v32, v33
    v_cvt_pk_bf16_f32 v57, v34, v35
    v_mfma_f32_32x32x16_bf16 v[64:79], v[104:107], v[48:51], v[64:79]
    s_setprio 0
    s_add_u32 m0, s59, 12288
    s_add_u32 s24, s23, 491520
    buffer_load_dwordx4 v200, s[8:11], s24 offen sc1 lds
    v_exp_f32 v36, v36
    v_exp_f32 v37, v37
    v_exp_f32 v38, v38
    v_exp_f32 v39, v39
    v_cvt_pk_bf16_f32 v58, v36, v37
    v_cvt_pk_bf16_f32 v59, v38, v39
    v_mfma_f32_32x32x8_bf16 v[16:31], v[100:101], v[8:9], v[16:31]
    s_waitcnt lgkmcnt(0)
    v_exp_f32 v40, v40
    v_exp_f32 v41, v41
    v_exp_f32 v42, v42
    v_exp_f32 v43, v43
    v_cvt_pk_bf16_f32 v60, v40, v41
    v_cvt_pk_bf16_f32 v61, v42, v43
    v_mfma_f32_32x32x16_bf16 v[64:79], v[108:111], v[52:55], v[64:79]
    s_setprio 1
    s_add_u32 m0, s60, 3072
    s_add_u32 s24, s23, 491520
    buffer_load_dword v201, s[8:11], s24 offen sc1 lds
    v_exp_f32 v44, v44
    v_exp_f32 v45, v45
    v_exp_f32 v46, v46
    v_exp_f32 v47, v47
    v_cvt_pk_bf16_f32 v62, v44, v45
    v_cvt_pk_bf16_f32 v63, v46, v47
    v_mfma_f32_32x32x16_bf16 v[32:47], v[96:99], v[10:13], 0
    ds_read_b128 v[96:99], v144 offset:6144
    v_exp_f32 v16, v16
    v_exp_f32 v17, v17
    v_exp_f32 v18, v18
    v_exp_f32 v19, v19
    v_cvt_pk_bf16_f32 v48, v16, v17
    v_cvt_pk_bf16_f32 v49, v18, v19
    v_mfma_f32_32x32x16_bf16 v[80:95], v[104:107], v[56:59], v[80:95]
    s_waitcnt lgkmcnt(0)
    v_exp_f32 v20, v20
    v_exp_f32 v21, v21
    v_exp_f32 v22, v22
    v_exp_f32 v23, v23
    v_cvt_pk_bf16_f32 v50, v20, v21
    v_cvt_pk_bf16_f32 v51, v22, v23
    v_mfma_f32_32x32x8_bf16 v[32:47], v[100:101], v[14:15], v[32:47]
    ds_read_b64 v[100:101], v145 offset:1536
    v_exp_f32 v24, v24
    v_exp_f32 v25, v25
    v_exp_f32 v26, v26
    v_exp_f32 v27, v27
    v_cvt_pk_bf16_f32 v52, v24, v25
    v_cvt_pk_bf16_f32 v53, v26, v27
    v_mfma_f32_32x32x16_bf16 v[80:95], v[108:111], v[60:63], v[80:95]
    s_mov_b64 exec, s[28:29]
    ds_read_b128 v[104:107], v146 offset:6400
    ds_read_b128 v[108:111], v146 offset:7040
    s_mov_b64 exec, -1
    v_exp_f32 v28, v28
    v_exp_f32 v29, v29
    v_exp_f32 v30, v30
    v_exp_f32 v31, v31
    v_cvt_pk_bf16_f32 v54, v28, v29
    v_cvt_pk_bf16_f32 v55, v30, v31
    v_mfma_f32_32x32x16_bf16 v[16:31], v[96:99], v[4:7], 0
    s_waitcnt lgkmcnt(1)
    v_exp_f32 v32, v32
    v_exp_f32 v33, v33
    v_exp_f32 v34, v34
    v_exp_f32 v35, v35
    v_cvt_pk_bf16_f32 v56, v32, v33
    v_cvt_pk_bf16_f32 v57, v34, v35
    v_mfma_f32_32x32x16_bf16 v[64:79], v[104:107], v[48:51], v[64:79]
    s_setprio 0
    s_add_u32 m0, s58, 97280
    s_add_u32 s24, s58, 15360
    buffer_load_dwordx4 v147, s[52:55], s24 offen sc1 lds
    v_exp_f32 v36, v36
    v_exp_f32 v37, v37
    v_exp_f32 v38, v38
    v_exp_f32 v39, v39
    v_cvt_pk_bf16_f32 v58, v36, v37
    v_cvt_pk_bf16_f32 v59, v38, v39
    v_mfma_f32_32x32x8_bf16 v[16:31], v[100:101], v[8:9], v[16:31]
    s_waitcnt lgkmcnt(0)
    v_exp_f32 v40, v40
    v_exp_f32 v41, v41
    v_exp_f32 v42, v42
    v_exp_f32 v43, v43
    v_cvt_pk_bf16_f32 v60, v40, v41
    v_cvt_pk_bf16_f32 v61, v42, v43
    v_mfma_f32_32x32x16_bf16 v[64:79], v[108:111], v[52:55], v[64:79]
    s_setprio 1
    s_add_u32 m0, s61, 97280
    s_add_u32 s24, s61, 15360
    s_mov_b64 exec, 0xffff
    buffer_load_dwordx4 v147, s[52:55], s24 offen sc1 lds
    s_mov_b64 exec, -1
    v_exp_f32 v44, v44
    v_exp_f32 v45, v45
    v_exp_f32 v46, v46
    v_exp_f32 v47, v47
    v_cvt_pk_bf16_f32 v62, v44, v45
    v_cvt_pk_bf16_f32 v63, v46, v47
    v_mfma_f32_32x32x16_bf16 v[32:47], v[96:99], v[10:13], 0
    ds_read_b128 v[96:99], v144 offset:7168
    v_exp_f32 v16, v16
    v_exp_f32 v17, v17
    v_exp_f32 v18, v18
    v_exp_f32 v19, v19
    v_cvt_pk_bf16_f32 v48, v16, v17
    v_cvt_pk_bf16_f32 v49, v18, v19
    v_mfma_f32_32x32x16_bf16 v[80:95], v[104:107], v[56:59], v[80:95]
    s_waitcnt lgkmcnt(0)
    v_exp_f32 v20, v20
    v_exp_f32 v21, v21
    v_exp_f32 v22, v22
    v_exp_f32 v23, v23
    v_cvt_pk_bf16_f32 v50, v20, v21
    v_cvt_pk_bf16_f32 v51, v22, v23
    v_mfma_f32_32x32x8_bf16 v[32:47], v[100:101], v[14:15], v[32:47]
    ds_read_b64 v[100:101], v145 offset:1792
    v_exp_f32 v24, v24
    v_exp_f32 v25, v25
    v_exp_f32 v26, v26
    v_exp_f32 v27, v27
    v_cvt_pk_bf16_f32 v52, v24, v25
    v_cvt_pk_bf16_f32 v53, v26, v27
    v_mfma_f32_32x32x16_bf16 v[80:95], v[108:111], v[60:63], v[80:95]
    s_mov_b64 exec, s[28:29]
    ds_read_b128 v[104:107], v146 offset:7680
    ds_read_b128 v[108:111], v146 offset:8320
    s_mov_b64 exec, -1
    v_exp_f32 v28, v28
    v_exp_f32 v29, v29
    v_exp_f32 v30, v30
    v_exp_f32 v31, v31
    v_cvt_pk_bf16_f32 v54, v28, v29
    v_cvt_pk_bf16_f32 v55, v30, v31
    v_mfma_f32_32x32x16_bf16 v[16:31], v[96:99], v[4:7], 0
    s_waitcnt lgkmcnt(1)
    v_exp_f32 v32, v32
    v_exp_f32 v33, v33
    v_exp_f32 v34, v34
    v_exp_f32 v35, v35
    v_cvt_pk_bf16_f32 v56, v32, v33
    v_cvt_pk_bf16_f32 v57, v34, v35
    v_mfma_f32_32x32x16_bf16 v[64:79], v[104:107], v[48:51], v[64:79]
    s_setprio 0
    s_add_u32 m0, s59, 16384
    s_add_u32 s24, s23, 655360
    buffer_load_dwordx4 v200, s[8:11], s24 offen sc1 lds
    v_exp_f32 v36, v36
    v_exp_f32 v37, v37
    v_exp_f32 v38, v38
    v_exp_f32 v39, v39
    v_cvt_pk_bf16_f32 v58, v36, v37
    v_cvt_pk_bf16_f32 v59, v38, v39
    v_mfma_f32_32x32x8_bf16 v[16:31], v[100:101], v[8:9], v[16:31]
    s_waitcnt lgkmcnt(0)
    v_exp_f32 v40, v40
    v_exp_f32 v41, v41
    v_exp_f32 v42, v42
    v_exp_f32 v43, v43
    v_cvt_pk_bf16_f32 v60, v40, v41
    v_cvt_pk_bf16_f32 v61, v42, v43
    v_mfma_f32_32x32x16_bf16 v[64:79], v[108:111], v[52:55], v[64:79]
    s_setprio 1
    s_add_u32 m0, s60, 4096
    s_add_u32 s24, s23, 655360
    buffer_load_dword v201, s[8:11], s24 offen sc1 lds
    v_exp_f32 v44, v44
    v_exp_f32 v45, v45
    v_exp_f32 v46, v46
    v_exp_f32 v47, v47
    v_cvt_pk_bf16_f32 v62, v44, v45
    v_cvt_pk_bf16_f32 v63, v46, v47
    s_waitcnt vmcnt(6)
    s_barrier
    v_mfma_f32_32x32x16_bf16 v[32:47], v[96:99], v[10:13], 0
    ds_read_b128 v[96:99], v144 offset:8192
    v_exp_f32 v16, v16
    v_exp_f32 v17, v17
    v_exp_f32 v18, v18
    v_exp_f32 v19, v19
    v_cvt_pk_bf16_f32 v48, v16, v17
    v_cvt_pk_bf16_f32 v49, v18, v19
    v_mfma_f32_32x32x16_bf16 v[80:95], v[104:107], v[56:59], v[80:95]
    s_waitcnt lgkmcnt(0)
    v_exp_f32 v20, v20
    v_exp_f32 v21, v21
    v_exp_f32 v22, v22
    v_exp_f32 v23, v23
    v_cvt_pk_bf16_f32 v50, v20, v21
    v_cvt_pk_bf16_f32 v51, v22, v23
    v_mfma_f32_32x32x8_bf16 v[32:47], v[100:101], v[14:15], v[32:47]
    ds_read_b64 v[100:101], v145 offset:2048
    v_exp_f32 v24, v24
    v_exp_f32 v25, v25
    v_exp_f32 v26, v26
    v_exp_f32 v27, v27
    v_cvt_pk_bf16_f32 v52, v24, v25
    v_cvt_pk_bf16_f32 v53, v26, v27
    v_mfma_f32_32x32x16_bf16 v[80:95], v[108:111], v[60:63], v[80:95]
    s_mov_b64 exec, s[28:29]
    ds_read_b128 v[104:107], v146 offset:8960
    ds_read_b128 v[108:111], v146 offset:9600
    s_mov_b64 exec, -1
    v_exp_f32 v28, v28
    v_exp_f32 v29, v29
    v_exp_f32 v30, v30
    v_exp_f32 v31, v31
    v_cvt_pk_bf16_f32 v54, v28, v29
    v_cvt_pk_bf16_f32 v55, v30, v31
    v_mfma_f32_32x32x16_bf16 v[16:31], v[96:99], v[4:7], 0
    s_waitcnt lgkmcnt(1)
    v_exp_f32 v32, v32
    v_exp_f32 v33, v33
    v_exp_f32 v34, v34
    v_exp_f32 v35, v35
    v_cvt_pk_bf16_f32 v56, v32, v33
    v_cvt_pk_bf16_f32 v57, v34, v35
    v_mfma_f32_32x32x16_bf16 v[64:79], v[104:107], v[48:51], v[64:79]
    s_setprio 0
    s_add_u32 m0, s58, 102400
    s_add_u32 s24, s58, 20480
    buffer_load_dwordx4 v147, s[52:55], s24 offen sc1 lds
    v_exp_f32 v36, v36
    v_exp_f32 v37, v37
    v_exp_f32 v38, v38
    v_exp_f32 v39, v39
    v_cvt_pk_bf16_f32 v58, v36, v37
    v_cvt_pk_bf16_f32 v59, v38, v39
    v_mfma_f32_32x32x8_bf16 v[16:31], v[100:101], v[8:9], v[16:31]
    s_waitcnt lgkmcnt(0)
    v_exp_f32 v40, v40
    v_exp_f32 v41, v41
    v_exp_f32 v42, v42
    v_exp_f32 v43, v43
    v_cvt_pk_bf16_f32 v60, v40, v41
    v_cvt_pk_bf16_f32 v61, v42, v43
    v_mfma_f32_32x32x16_bf16 v[64:79], v[108:111], v[52:55], v[64:79]
    s_setprio 1
    s_add_u32 m0, s61, 102400
    s_add_u32 s24, s61, 20480
    s_mov_b64 exec, 0xffff
    buffer_load_dwordx4 v147, s[52:55], s24 offen sc1 lds
    s_mov_b64 exec, -1
    v_exp_f32 v44, v44
    v_exp_f32 v45, v45
    v_exp_f32 v46, v46
    v_exp_f32 v47, v47
    v_cvt_pk_bf16_f32 v62, v44, v45
    v_cvt_pk_bf16_f32 v63, v46, v47
    v_add_u32 v144, 8192, v144
    v_add_u32 v145, 2048, v145
    v_add_u32 v146, 10240, v146
    v_mfma_f32_32x32x16_bf16 v[32:47], v[96:99], v[10:13], 0
    ds_read_b128 v[96:99], v144 offset:1024
    v_exp_f32 v16, v16
    v_exp_f32 v17, v17
    v_exp_f32 v18, v18
    v_exp_f32 v19, v19
    v_cvt_pk_bf16_f32 v48, v16, v17
    v_cvt_pk_bf16_f32 v49, v18, v19
    v_mfma_f32_32x32x16_bf16 v[80:95], v[104:107], v[56:59], v[80:95]
    s_waitcnt lgkmcnt(0)
    v_exp_f32 v20, v20
    v_exp_f32 v21, v21
    v_exp_f32 v22, v22
    v_exp_f32 v23, v23
    v_cvt_pk_bf16_f32 v50, v20, v21
    v_cvt_pk_bf16_f32 v51, v22, v23
    v_mfma_f32_32x32x8_bf16 v[32:47], v[100:101], v[14:15], v[32:47]
    ds_read_b64 v[100:101], v145 offset:256
    v_exp_f32 v24, v24
    v_exp_f32 v25, v25
    v_exp_f32 v26, v26
    v_exp_f32 v27, v27
    v_cvt_pk_bf16_f32 v52, v24, v25
    v_cvt_pk_bf16_f32 v53, v26, v27
    v_mfma_f32_32x32x16_bf16 v[80:95], v[108:111], v[60:63], v[80:95]
    s_mov_b64 exec, s[28:29]
    ds_read_b128 v[104:107], v146 offset:0
    ds_read_b128 v[108:111], v146 offset:640
    s_mov_b64 exec, -1
    v_exp_f32 v28, v28
    v_exp_f32 v29, v29
    v_exp_f32 v30, v30
    v_exp_f32 v31, v31
    v_cvt_pk_bf16_f32 v54, v28, v29
    v_cvt_pk_bf16_f32 v55, v30, v31
    v_mfma_f32_32x32x16_bf16 v[16:31], v[96:99], v[4:7], 0
    s_waitcnt lgkmcnt(1)
    v_exp_f32 v32, v32
    v_exp_f32 v33, v33
    v_exp_f32 v34, v34
    v_exp_f32 v35, v35
    v_cvt_pk_bf16_f32 v56, v32, v33
    v_cvt_pk_bf16_f32 v57, v34, v35
    v_mfma_f32_32x32x16_bf16 v[64:79], v[104:107], v[48:51], v[64:79]
    s_setprio 0
    s_add_u32 m0, s59, 20480
    s_add_u32 s24, s23, 819200
    buffer_load_dwordx4 v200, s[8:11], s24 offen sc1 lds
    v_exp_f32 v36, v36
    v_exp_f32 v37, v37
    v_exp_f32 v38, v38
    v_exp_f32 v39, v39
    v_cvt_pk_bf16_f32 v58, v36, v37
    v_cvt_pk_bf16_f32 v59, v38, v39
    v_mfma_f32_32x32x8_bf16 v[16:31], v[100:101], v[8:9], v[16:31]
    s_waitcnt lgkmcnt(0)
    v_exp_f32 v40, v40
    v_exp_f32 v41, v41
    v_exp_f32 v42, v42
    v_exp_f32 v43, v43
    v_cvt_pk_bf16_f32 v60, v40, v41
    v_cvt_pk_bf16_f32 v61, v42, v43
    v_mfma_f32_32x32x16_bf16 v[64:79], v[108:111], v[52:55], v[64:79]
    s_setprio 1
    s_add_u32 m0, s60, 5120
    s_add_u32 s24, s23, 819200
    buffer_load_dword v201, s[8:11], s24 offen sc1 lds
    v_exp_f32 v44, v44
    v_exp_f32 v45, v45
    v_exp_f32 v46, v46
    v_exp_f32 v47, v47
    v_cvt_pk_bf16_f32 v62, v44, v45
    v_cvt_pk_bf16_f32 v63, v46, v47
    v_mfma_f32_32x32x16_bf16 v[32:47], v[96:99], v[10:13], 0
    ds_read_b128 v[96:99], v144 offset:2048
    v_exp_f32 v16, v16
    v_exp_f32 v17, v17
    v_exp_f32 v18, v18
    v_exp_f32 v19, v19
    v_cvt_pk_bf16_f32 v48, v16, v17
    v_cvt_pk_bf16_f32 v49, v18, v19
    v_mfma_f32_32x32x16_bf16 v[80:95], v[104:107], v[56:59], v[80:95]
    s_waitcnt lgkmcnt(0)
    v_exp_f32 v20, v20
    v_exp_f32 v21, v21
    v_exp_f32 v22, v22
    v_exp_f32 v23, v23
    v_cvt_pk_bf16_f32 v50, v20, v21
    v_cvt_pk_bf16_f32 v51, v22, v23
    v_mfma_f32_32x32x8_bf16 v[32:47], v[100:101], v[14:15], v[32:47]
    ds_read_b64 v[100:101], v145 offset:512
    v_exp_f32 v24, v24
    v_exp_f32 v25, v25
    v_exp_f32 v26, v26
    v_exp_f32 v27, v27
    v_cvt_pk_bf16_f32 v52, v24, v25
    v_cvt_pk_bf16_f32 v53, v26, v27
    v_mfma_f32_32x32x16_bf16 v[80:95], v[108:111], v[60:63], v[80:95]
    s_mov_b64 exec, s[28:29]
    ds_read_b128 v[104:107], v146 offset:1280
    ds_read_b128 v[108:111], v146 offset:1920
    s_mov_b64 exec, -1
    v_exp_f32 v28, v28
    v_exp_f32 v29, v29
    v_exp_f32 v30, v30
    v_exp_f32 v31, v31
    v_cvt_pk_bf16_f32 v54, v28, v29
    v_cvt_pk_bf16_f32 v55, v30, v31
    v_mfma_f32_32x32x16_bf16 v[16:31], v[96:99], v[4:7], 0
    s_waitcnt lgkmcnt(1)
    v_exp_f32 v32, v32
    v_exp_f32 v33, v33
    v_exp_f32 v34, v34
    v_exp_f32 v35, v35
    v_cvt_pk_bf16_f32 v56, v32, v33
    v_cvt_pk_bf16_f32 v57, v34, v35
    v_mfma_f32_32x32x16_bf16 v[64:79], v[104:107], v[48:51], v[64:79]
    s_setprio 0
    s_add_u32 m0, s58, 107520
    s_add_u32 s24, s58, 25600
    buffer_load_dwordx4 v147, s[52:55], s24 offen sc1 lds
    v_exp_f32 v36, v36
    v_exp_f32 v37, v37
    v_exp_f32 v38, v38
    v_exp_f32 v39, v39
    v_cvt_pk_bf16_f32 v58, v36, v37
    v_cvt_pk_bf16_f32 v59, v38, v39
    v_mfma_f32_32x32x8_bf16 v[16:31], v[100:101], v[8:9], v[16:31]
    s_waitcnt lgkmcnt(0)
    v_exp_f32 v40, v40
    v_exp_f32 v41, v41
    v_exp_f32 v42, v42
    v_exp_f32 v43, v43
    v_cvt_pk_bf16_f32 v60, v40, v41
    v_cvt_pk_bf16_f32 v61, v42, v43
    v_mfma_f32_32x32x16_bf16 v[64:79], v[108:111], v[52:55], v[64:79]
    s_setprio 1
    s_add_u32 m0, s61, 107520
    s_add_u32 s24, s61, 25600
    s_mov_b64 exec, 0xffff
    buffer_load_dwordx4 v147, s[52:55], s24 offen sc1 lds
    s_mov_b64 exec, -1
    v_exp_f32 v44, v44
    v_exp_f32 v45, v45
    v_exp_f32 v46, v46
    v_exp_f32 v47, v47
    v_cvt_pk_bf16_f32 v62, v44, v45
    v_cvt_pk_bf16_f32 v63, v46, v47
    v_mfma_f32_32x32x16_bf16 v[32:47], v[96:99], v[10:13], 0
    ds_read_b128 v[96:99], v144 offset:3072
    v_exp_f32 v16, v16
    v_exp_f32 v17, v17
    v_exp_f32 v18, v18
    v_exp_f32 v19, v19
    v_cvt_pk_bf16_f32 v48, v16, v17
    v_cvt_pk_bf16_f32 v49, v18, v19
    v_mfma_f32_32x32x16_bf16 v[80:95], v[104:107], v[56:59], v[80:95]
    s_waitcnt lgkmcnt(0)
    v_exp_f32 v20, v20
    v_exp_f32 v21, v21
    v_exp_f32 v22, v22
    v_exp_f32 v23, v23
    v_cvt_pk_bf16_f32 v50, v20, v21
    v_cvt_pk_bf16_f32 v51, v22, v23
    v_mfma_f32_32x32x8_bf16 v[32:47], v[100:101], v[14:15], v[32:47]
    ds_read_b64 v[100:101], v145 offset:768
    v_exp_f32 v24, v24
    v_exp_f32 v25, v25
    v_exp_f32 v26, v26
    v_exp_f32 v27, v27
    v_cvt_pk_bf16_f32 v52, v24, v25
    v_cvt_pk_bf16_f32 v53, v26, v27
    v_mfma_f32_32x32x16_bf16 v[80:95], v[108:111], v[60:63], v[80:95]
    s_mov_b64 exec, s[28:29]
    ds_read_b128 v[104:107], v146 offset:2560
    ds_read_b128 v[108:111], v146 offset:3200
    s_mov_b64 exec, -1
    v_exp_f32 v28, v28
    v_exp_f32 v29, v29
    v_exp_f32 v30, v30
    v_exp_f32 v31, v31
    v_cvt_pk_bf16_f32 v54, v28, v29
    v_cvt_pk_bf16_f32 v55, v30, v31
    v_mfma_f32_32x32x16_bf16 v[16:31], v[96:99], v[4:7], 0
    s_waitcnt lgkmcnt(1)
    v_exp_f32 v32, v32
    v_exp_f32 v33, v33
    v_exp_f32 v34, v34
    v_exp_f32 v35, v35
    v_cvt_pk_bf16_f32 v56, v32, v33
    v_cvt_pk_bf16_f32 v57, v34, v35
    v_mfma_f32_32x32x16_bf16 v[64:79], v[104:107], v[48:51], v[64:79]
    s_setprio 0
    s_add_u32 m0, s59, 24576
    s_add_u32 s24, s23, 983040
    buffer_load_dwordx4 v200, s[8:11], s24 offen sc1 lds
    v_exp_f32 v36, v36
    v_exp_f32 v37, v37
    v_exp_f32 v38, v38
    v_exp_f32 v39, v39
    v_cvt_pk_bf16_f32 v58, v36, v37
    v_cvt_pk_bf16_f32 v59, v38, v39
    v_mfma_f32_32x32x8_bf16 v[16:31], v[100:101], v[8:9], v[16:31]
    s_waitcnt lgkmcnt(0)
    v_exp_f32 v40, v40
    v_exp_f32 v41, v41
    v_exp_f32 v42, v42
    v_exp_f32 v43, v43
    v_cvt_pk_bf16_f32 v60, v40, v41
    v_cvt_pk_bf16_f32 v61, v42, v43
    v_mfma_f32_32x32x16_bf16 v[64:79], v[108:111], v[52:55], v[64:79]
    s_setprio 1
    s_add_u32 m0, s60, 6144
    s_add_u32 s24, s23, 983040
    buffer_load_dword v201, s[8:11], s24 offen sc1 lds
    v_exp_f32 v44, v44
    v_exp_f32 v45, v45
    v_exp_f32 v46, v46
    v_exp_f32 v47, v47
    v_cvt_pk_bf16_f32 v62, v44, v45
    v_cvt_pk_bf16_f32 v63, v46, v47
    s_waitcnt vmcnt(6)
    s_barrier
    v_mfma_f32_32x32x16_bf16 v[32:47], v[96:99], v[10:13], 0
    ds_read_b128 v[96:99], v144 offset:4096
    v_exp_f32 v16, v16
    v_exp_f32 v17, v17
    v_exp_f32 v18, v18
    v_exp_f32 v19, v19
    v_cvt_pk_bf16_f32 v48, v16, v17
    v_cvt_pk_bf16_f32 v49, v18, v19
    v_mfma_f32_32x32x16_bf16 v[80:95], v[104:107], v[56:59], v[80:95]
    s_waitcnt lgkmcnt(0)
    v_exp_f32 v20, v20
    v_exp_f32 v21, v21
    v_exp_f32 v22, v22
    v_exp_f32 v23, v23
    v_cvt_pk_bf16_f32 v50, v20, v21
    v_cvt_pk_bf16_f32 v51, v22, v23
    v_mfma_f32_32x32x8_bf16 v[32:47], v[100:101], v[14:15], v[32:47]
    ds_read_b64 v[100:101], v145 offset:1024
    v_exp_f32 v24, v24
    v_exp_f32 v25, v25
    v_exp_f32 v26, v26
    v_exp_f32 v27, v27
    v_cvt_pk_bf16_f32 v52, v24, v25
    v_cvt_pk_bf16_f32 v53, v26, v27
    v_mfma_f32_32x32x16_bf16 v[80:95], v[108:111], v[60:63], v[80:95]
    s_mov_b64 exec, s[28:29]
    ds_read_b128 v[104:107], v146 offset:3840
    ds_read_b128 v[108:111], v146 offset:4480
    s_mov_b64 exec, -1
    v_exp_f32 v28, v28
    v_exp_f32 v29, v29
    v_exp_f32 v30, v30
    v_exp_f32 v31, v31
    v_cvt_pk_bf16_f32 v54, v28, v29
    v_cvt_pk_bf16_f32 v55, v30, v31
    v_mfma_f32_32x32x16_bf16 v[16:31], v[96:99], v[4:7], 0
    s_waitcnt lgkmcnt(1)
    v_exp_f32 v32, v32
    v_exp_f32 v33, v33
    v_exp_f32 v34, v34
    v_exp_f32 v35, v35
    v_cvt_pk_bf16_f32 v56, v32, v33
    v_cvt_pk_bf16_f32 v57, v34, v35
    v_mfma_f32_32x32x16_bf16 v[64:79], v[104:107], v[48:51], v[64:79]
    s_setprio 0
    s_add_u32 m0, s58, 112640
    s_add_u32 s24, s58, 30720
    buffer_load_dwordx4 v147, s[52:55], s24 offen sc1 lds
    v_exp_f32 v36, v36
    v_exp_f32 v37, v37
    v_exp_f32 v38, v38
    v_exp_f32 v39, v39
    v_cvt_pk_bf16_f32 v58, v36, v37
    v_cvt_pk_bf16_f32 v59, v38, v39
    v_mfma_f32_32x32x8_bf16 v[16:31], v[100:101], v[8:9], v[16:31]
    s_waitcnt lgkmcnt(0)
    v_exp_f32 v40, v40
    v_exp_f32 v41, v41
    v_exp_f32 v42, v42
    v_exp_f32 v43, v43
    v_cvt_pk_bf16_f32 v60, v40, v41
    v_cvt_pk_bf16_f32 v61, v42, v43
    v_mfma_f32_32x32x16_bf16 v[64:79], v[108:111], v[52:55], v[64:79]
    s_setprio 1
    s_add_u32 m0, s61, 112640
    s_add_u32 s24, s61, 30720
    s_mov_b64 exec, 0xffff
    buffer_load_dwordx4 v147, s[52:55], s24 offen sc1 lds
    s_mov_b64 exec, -1
    v_exp_f32 v44, v44
    v_exp_f32 v45, v45
    v_exp_f32 v46, v46
    v_exp_f32 v47, v47
    v_cvt_pk_bf16_f32 v62, v44, v45
    v_cvt_pk_bf16_f32 v63, v46, v47
    s_cmp_eq_u32 s50, 0
    s_cbranch_scc1 sequential_preLN__softmax_full_mha__dense_activation_silu__prompt_kernel_att_rl_done
    buffer_load_dwordx4 v[172:175], v192, s[40:43], s48 offen
    buffer_load_dwordx4 v[176:179], v193, s[40:43], s48 offen
    buffer_load_dwordx4 v[180:183], v194, s[40:43], s48 offen
    s_cmp_eq_u32 s50, 3
    s_cbranch_scc1 sequential_preLN__softmax_full_mha__dense_activation_silu__prompt_kernel_att_rl_done
    buffer_load_dwordx4 v[184:187], v195, s[40:43], s48 offen
    buffer_load_dwordx4 v[188:191], v196, s[40:43], s48 offen
sequential_preLN__softmax_full_mha__dense_activation_silu__prompt_kernel_att_rl_done:
    v_mfma_f32_32x32x16_bf16 v[32:47], v[96:99], v[10:13], 0
    ds_read_b128 v[96:99], v144 offset:5120
    v_exp_f32 v16, v16
    v_exp_f32 v17, v17
    v_exp_f32 v18, v18
    v_exp_f32 v19, v19
    v_cvt_pk_bf16_f32 v48, v16, v17
    v_cvt_pk_bf16_f32 v49, v18, v19
    v_mfma_f32_32x32x16_bf16 v[80:95], v[104:107], v[56:59], v[80:95]
    s_waitcnt lgkmcnt(0)
    v_exp_f32 v20, v20
    v_exp_f32 v21, v21
    v_exp_f32 v22, v22
    v_exp_f32 v23, v23
    v_cvt_pk_bf16_f32 v50, v20, v21
    v_cvt_pk_bf16_f32 v51, v22, v23
    v_mfma_f32_32x32x8_bf16 v[32:47], v[100:101], v[14:15], v[32:47]
    ds_read_b64 v[100:101], v145 offset:1280
    v_exp_f32 v24, v24
    v_exp_f32 v25, v25
    v_exp_f32 v26, v26
    v_exp_f32 v27, v27
    v_cvt_pk_bf16_f32 v52, v24, v25
    v_cvt_pk_bf16_f32 v53, v26, v27
    v_mfma_f32_32x32x16_bf16 v[80:95], v[108:111], v[60:63], v[80:95]
    s_mov_b64 exec, s[28:29]
    ds_read_b128 v[104:107], v146 offset:5120
    ds_read_b128 v[108:111], v146 offset:5760
    s_mov_b64 exec, -1
    v_exp_f32 v28, v28
    v_exp_f32 v29, v29
    v_exp_f32 v30, v30
    v_exp_f32 v31, v31
    v_cvt_pk_bf16_f32 v54, v28, v29
    v_cvt_pk_bf16_f32 v55, v30, v31
    v_mfma_f32_32x32x16_bf16 v[16:31], v[96:99], v[4:7], 0
    s_waitcnt lgkmcnt(1)
    v_exp_f32 v32, v32
    v_exp_f32 v33, v33
    v_exp_f32 v34, v34
    v_exp_f32 v35, v35
    v_cvt_pk_bf16_f32 v56, v32, v33
    v_cvt_pk_bf16_f32 v57, v34, v35
    v_mfma_f32_32x32x16_bf16 v[64:79], v[104:107], v[48:51], v[64:79]
    s_setprio 0
    s_add_u32 m0, s59, 28672
    s_add_u32 s24, s23, 1146880
    buffer_load_dwordx4 v200, s[8:11], s24 offen sc1 lds
    v_exp_f32 v36, v36
    v_exp_f32 v37, v37
    v_exp_f32 v38, v38
    v_exp_f32 v39, v39
    v_cvt_pk_bf16_f32 v58, v36, v37
    v_cvt_pk_bf16_f32 v59, v38, v39
    v_mfma_f32_32x32x8_bf16 v[16:31], v[100:101], v[8:9], v[16:31]
    s_waitcnt lgkmcnt(0)
    v_exp_f32 v40, v40
    v_exp_f32 v41, v41
    v_exp_f32 v42, v42
    v_exp_f32 v43, v43
    v_cvt_pk_bf16_f32 v60, v40, v41
    v_cvt_pk_bf16_f32 v61, v42, v43
    v_mfma_f32_32x32x16_bf16 v[64:79], v[108:111], v[52:55], v[64:79]
    s_setprio 1
    s_add_u32 m0, s60, 7168
    s_add_u32 s24, s23, 1146880
    buffer_load_dword v201, s[8:11], s24 offen sc1 lds
    v_exp_f32 v44, v44
    v_exp_f32 v45, v45
    v_exp_f32 v46, v46
    v_exp_f32 v47, v47
    v_cvt_pk_bf16_f32 v62, v44, v45
    v_cvt_pk_bf16_f32 v63, v46, v47
    v_mfma_f32_32x32x16_bf16 v[32:47], v[96:99], v[10:13], 0
    ds_read_b128 v[96:99], v144 offset:6144
    v_exp_f32 v16, v16
    v_exp_f32 v17, v17
    v_exp_f32 v18, v18
    v_exp_f32 v19, v19
    v_cvt_pk_bf16_f32 v48, v16, v17
    v_cvt_pk_bf16_f32 v49, v18, v19
    v_mfma_f32_32x32x16_bf16 v[80:95], v[104:107], v[56:59], v[80:95]
    s_waitcnt lgkmcnt(0)
    v_exp_f32 v20, v20
    v_exp_f32 v21, v21
    v_exp_f32 v22, v22
    v_exp_f32 v23, v23
    v_cvt_pk_bf16_f32 v50, v20, v21
    v_cvt_pk_bf16_f32 v51, v22, v23
    v_mfma_f32_32x32x8_bf16 v[32:47], v[100:101], v[14:15], v[32:47]
    ds_read_b64 v[100:101], v145 offset:1536
    v_exp_f32 v24, v24
    v_exp_f32 v25, v25
    v_exp_f32 v26, v26
    v_exp_f32 v27, v27
    v_cvt_pk_bf16_f32 v52, v24, v25
    v_cvt_pk_bf16_f32 v53, v26, v27
    v_mfma_f32_32x32x16_bf16 v[80:95], v[108:111], v[60:63], v[80:95]
    s_mov_b64 exec, s[28:29]
    ds_read_b128 v[104:107], v146 offset:6400
    ds_read_b128 v[108:111], v146 offset:7040
    s_mov_b64 exec, -1
    v_exp_f32 v28, v28
    v_exp_f32 v29, v29
    v_exp_f32 v30, v30
    v_exp_f32 v31, v31
    v_cvt_pk_bf16_f32 v54, v28, v29
    v_cvt_pk_bf16_f32 v55, v30, v31
    v_mfma_f32_32x32x16_bf16 v[16:31], v[96:99], v[4:7], 0
    s_waitcnt lgkmcnt(1)
    v_exp_f32 v32, v32
    v_exp_f32 v33, v33
    v_exp_f32 v34, v34
    v_exp_f32 v35, v35
    v_cvt_pk_bf16_f32 v56, v32, v33
    v_cvt_pk_bf16_f32 v57, v34, v35
    v_mfma_f32_32x32x16_bf16 v[64:79], v[104:107], v[48:51], v[64:79]
    s_setprio 0
    s_add_u32 m0, s58, 117760
    s_add_u32 s24, s58, 35840
    buffer_load_dwordx4 v147, s[52:55], s24 offen sc1 lds
    v_exp_f32 v36, v36
    v_exp_f32 v37, v37
    v_exp_f32 v38, v38
    v_exp_f32 v39, v39
    v_cvt_pk_bf16_f32 v58, v36, v37
    v_cvt_pk_bf16_f32 v59, v38, v39
    v_mfma_f32_32x32x8_bf16 v[16:31], v[100:101], v[8:9], v[16:31]
    s_waitcnt lgkmcnt(0)
    v_exp_f32 v40, v40
    v_exp_f32 v41, v41
    v_exp_f32 v42, v42
    v_exp_f32 v43, v43
    v_cvt_pk_bf16_f32 v60, v40, v41
    v_cvt_pk_bf16_f32 v61, v42, v43
    v_mfma_f32_32x32x16_bf16 v[64:79], v[108:111], v[52:55], v[64:79]
    s_setprio 1
    s_add_u32 m0, s61, 117760
    s_add_u32 s24, s61, 35840
    s_mov_b64 exec, 0xffff
    buffer_load_dwordx4 v147, s[52:55], s24 offen sc1 lds
    s_mov_b64 exec, -1
    v_exp_f32 v44, v44
    v_exp_f32 v45, v45
    v_exp_f32 v46, v46
    v_exp_f32 v47, v47
    v_cvt_pk_bf16_f32 v62, v44, v45
    v_cvt_pk_bf16_f32 v63, v46, v47
    v_mfma_f32_32x32x16_bf16 v[32:47], v[96:99], v[10:13], 0
    ds_read_b128 v[96:99], v144 offset:7168
    v_exp_f32 v16, v16
    v_exp_f32 v17, v17
    v_exp_f32 v18, v18
    v_exp_f32 v19, v19
    v_cvt_pk_bf16_f32 v48, v16, v17
    v_cvt_pk_bf16_f32 v49, v18, v19
    v_mfma_f32_32x32x16_bf16 v[80:95], v[104:107], v[56:59], v[80:95]
    s_waitcnt lgkmcnt(0)
    v_exp_f32 v20, v20
    v_exp_f32 v21, v21
    v_exp_f32 v22, v22
    v_exp_f32 v23, v23
    v_cvt_pk_bf16_f32 v50, v20, v21
    v_cvt_pk_bf16_f32 v51, v22, v23
    v_mfma_f32_32x32x8_bf16 v[32:47], v[100:101], v[14:15], v[32:47]
    ds_read_b64 v[100:101], v145 offset:1792
    v_exp_f32 v24, v24
    v_exp_f32 v25, v25
    v_exp_f32 v26, v26
    v_exp_f32 v27, v27
    v_cvt_pk_bf16_f32 v52, v24, v25
    v_cvt_pk_bf16_f32 v53, v26, v27
    v_mfma_f32_32x32x16_bf16 v[80:95], v[108:111], v[60:63], v[80:95]
    s_mov_b64 exec, s[28:29]
    ds_read_b128 v[104:107], v146 offset:7680
    ds_read_b128 v[108:111], v146 offset:8320
    s_mov_b64 exec, -1
    v_exp_f32 v28, v28
    v_exp_f32 v29, v29
    v_exp_f32 v30, v30
    v_exp_f32 v31, v31
    v_cvt_pk_bf16_f32 v54, v28, v29
    v_cvt_pk_bf16_f32 v55, v30, v31
    v_mfma_f32_32x32x16_bf16 v[16:31], v[96:99], v[4:7], 0
    s_waitcnt lgkmcnt(1)
    v_exp_f32 v32, v32
    v_exp_f32 v33, v33
    v_exp_f32 v34, v34
    v_exp_f32 v35, v35
    v_cvt_pk_bf16_f32 v56, v32, v33
    v_cvt_pk_bf16_f32 v57, v34, v35
    v_mfma_f32_32x32x16_bf16 v[64:79], v[104:107], v[48:51], v[64:79]
    s_setprio 0
    v_exp_f32 v36, v36
    v_exp_f32 v37, v37
    v_exp_f32 v38, v38
    v_exp_f32 v39, v39
    v_cvt_pk_bf16_f32 v58, v36, v37
    v_cvt_pk_bf16_f32 v59, v38, v39
    v_mfma_f32_32x32x8_bf16 v[16:31], v[100:101], v[8:9], v[16:31]
    s_waitcnt lgkmcnt(0)
    v_exp_f32 v40, v40
    v_exp_f32 v41, v41
    v_exp_f32 v42, v42
    v_exp_f32 v43, v43
    v_cvt_pk_bf16_f32 v60, v40, v41
    v_cvt_pk_bf16_f32 v61, v42, v43
    v_mfma_f32_32x32x16_bf16 v[64:79], v[108:111], v[52:55], v[64:79]
    s_setprio 1
    v_exp_f32 v44, v44
    v_exp_f32 v45, v45
    v_exp_f32 v46, v46
    v_exp_f32 v47, v47
    v_cvt_pk_bf16_f32 v62, v44, v45
    v_cvt_pk_bf16_f32 v63, v46, v47
    v_mfma_f32_32x32x16_bf16 v[32:47], v[96:99], v[10:13], 0
    ds_read_b128 v[96:99], v144 offset:8192
    v_exp_f32 v16, v16
    v_exp_f32 v17, v17
    v_exp_f32 v18, v18
    v_exp_f32 v19, v19
    v_cvt_pk_bf16_f32 v48, v16, v17
    v_cvt_pk_bf16_f32 v49, v18, v19
    v_mfma_f32_32x32x16_bf16 v[80:95], v[104:107], v[56:59], v[80:95]
    s_waitcnt lgkmcnt(0)
    v_exp_f32 v20, v20
    v_exp_f32 v21, v21
    v_exp_f32 v22, v22
    v_exp_f32 v23, v23
    v_cvt_pk_bf16_f32 v50, v20, v21
    v_cvt_pk_bf16_f32 v51, v22, v23
    v_mfma_f32_32x32x8_bf16 v[32:47], v[100:101], v[14:15], v[32:47]
    ds_read_b64 v[100:101], v145 offset:2048
    v_exp_f32 v24, v24
    v_exp_f32 v25, v25
    v_exp_f32 v26, v26
    v_exp_f32 v27, v27
    v_cvt_pk_bf16_f32 v52, v24, v25
    v_cvt_pk_bf16_f32 v53, v26, v27
    v_mfma_f32_32x32x16_bf16 v[80:95], v[108:111], v[60:63], v[80:95]
    s_mov_b64 exec, s[28:29]
    ds_read_b128 v[104:107], v146 offset:8960
    ds_read_b128 v[108:111], v146 offset:9600
    s_mov_b64 exec, -1
    v_exp_f32 v28, v28
    v_exp_f32 v29, v29
    v_exp_f32 v30, v30
    v_exp_f32 v31, v31
    v_cvt_pk_bf16_f32 v54, v28, v29
    v_cvt_pk_bf16_f32 v55, v30, v31
    v_mfma_f32_32x32x16_bf16 v[16:31], v[96:99], v[4:7], 0
    s_waitcnt lgkmcnt(1)
    v_exp_f32 v32, v32
    v_exp_f32 v33, v33
    v_exp_f32 v34, v34
    v_exp_f32 v35, v35
    v_cvt_pk_bf16_f32 v56, v32, v33
    v_cvt_pk_bf16_f32 v57, v34, v35
    v_mfma_f32_32x32x16_bf16 v[64:79], v[104:107], v[48:51], v[64:79]
    s_setprio 0
    v_exp_f32 v36, v36
    v_exp_f32 v37, v37
    v_exp_f32 v38, v38
    v_exp_f32 v39, v39
    v_cvt_pk_bf16_f32 v58, v36, v37
    v_cvt_pk_bf16_f32 v59, v38, v39
    v_mfma_f32_32x32x8_bf16 v[16:31], v[100:101], v[8:9], v[16:31]
    s_waitcnt lgkmcnt(0)
    v_exp_f32 v40, v40
    v_exp_f32 v41, v41
    v_exp_f32 v42, v42
    v_exp_f32 v43, v43
    v_cvt_pk_bf16_f32 v60, v40, v41
    v_cvt_pk_bf16_f32 v61, v42, v43
    v_mfma_f32_32x32x16_bf16 v[64:79], v[108:111], v[52:55], v[64:79]
    s_setprio 1
    v_exp_f32 v44, v44
    v_exp_f32 v45, v45
    v_exp_f32 v46, v46
    v_exp_f32 v47, v47
    v_cvt_pk_bf16_f32 v62, v44, v45
    v_cvt_pk_bf16_f32 v63, v46, v47
    v_add_u32 v144, 8192, v144
    v_add_u32 v145, 2048, v145
    v_add_u32 v146, 10240, v146
    s_mov_b32 s25, 2
    v_and_b32 v2, 15, v148
    v_lshlrev_b32 v2, 8, v2
    v_add_u32 v2, 24291328, v2
    v_mov_b32 v3, 0
sequential_preLN__softmax_full_mha__dense_activation_silu__prompt_kernel_att_f_loop:
    s_cmp_lg_u32 s25, 2
    s_cbranch_scc1 sequential_preLN__softmax_full_mha__dense_activation_silu__prompt_kernel_att_f_nw2
    s_waitcnt vmcnt(0)
    s_barrier
    s_cmp_eq_u32 s50, 0
    s_cbranch_scc1 sequential_preLN__softmax_full_mha__dense_activation_silu__prompt_kernel_att_rs_done
    s_waitcnt vmcnt(0)
    buffer_store_dwordx4 v[172:175], v147, s[44:47], s49 offen offset:0 sc1
    buffer_store_dwordx4 v[176:179], v147, s[44:47], s49 offen offset:1024 sc1
    buffer_store_dwordx4 v[180:183], v147, s[44:47], s49 offen offset:2048 sc1
    s_cmp_eq_u32 s50, 3
    s_cbranch_scc1 sequential_preLN__softmax_full_mha__dense_activation_silu__prompt_kernel_att_rs_done
    buffer_store_dwordx4 v[184:187], v147, s[44:47], s49 offen offset:3072 sc1
    s_add_u32 s49, s49, 4096
    buffer_store_dwordx4 v[188:191], v147, s[44:47], s49 offen sc1
sequential_preLN__softmax_full_mha__dense_activation_silu__prompt_kernel_att_rs_done:
    s_branch sequential_preLN__softmax_full_mha__dense_activation_silu__prompt_kernel_att_f_go
sequential_preLN__softmax_full_mha__dense_activation_silu__prompt_kernel_att_f_nw2:
    s_waitcnt vmcnt(0)
    s_barrier
    s_cmp_lg_u32 s22, 0
    s_cbranch_scc1 sequential_preLN__softmax_full_mha__dense_activation_silu__prompt_kernel_att_f_go
    s_and_b32 s30, s2, 15
    s_lshl_b32 s30, s30, 8
    s_add_u32 s30, s30, 24291328
    s_mov_b64 exec, 1
    v_mov_b32 v152, s30
    v_mov_b32 v153, 1
    global_atomic_add v152, v153, s[4:5] sc1
    s_mov_b64 exec, -1
sequential_preLN__softmax_full_mha__dense_activation_silu__prompt_kernel_att_f_go:
    v_mfma_f32_32x32x16_bf16 v[32:47], v[96:99], v[10:13], 0
    ds_read_b128 v[96:99], v144 offset:1024
    v_exp_f32 v16, v16
    v_exp_f32 v17, v17
    v_exp_f32 v18, v18
    v_exp_f32 v19, v19
    v_cvt_pk_bf16_f32 v48, v16, v17
    v_cvt_pk_bf16_f32 v49, v18, v19
    v_mfma_f32_32x32x16_bf16 v[80:95], v[104:107], v[56:59], v[80:95]
    s_waitcnt lgkmcnt(0)
    v_exp_f32 v20, v20
    v_exp_f32 v21, v21
    v_exp_f32 v22, v22
    v_exp_f32 v23, v23
    v_cvt_pk_bf16_f32 v50, v20, v21
    v_cvt_pk_bf16_f32 v51, v22, v23
    v_mfma_f32_32x32x8_bf16 v[32:47], v[100:101], v[14:15], v[32:47]
    ds_read_b64 v[100:101], v145 offset:256
    v_exp_f32 v24, v24
    v_exp_f32 v25, v25
    v_exp_f32 v26, v26
    v_exp_f32 v27, v27
    v_cvt_pk_bf16_f32 v52, v24, v25
    v_cvt_pk_bf16_f32 v53, v26, v27
    v_mfma_f32_32x32x16_bf16 v[80:95], v[108:111], v[60:63], v[80:95]
    s_mov_b64 exec, s[28:29]
    ds_read_b128 v[104:107], v146 offset:0
    ds_read_b128 v[108:111], v146 offset:640
    s_mov_b64 exec, -1
    v_exp_f32 v28, v28
    v_exp_f32 v29, v29
    v_exp_f32 v30, v30
    v_exp_f32 v31, v31
    v_cvt_pk_bf16_f32 v54, v28, v29
    v_cvt_pk_bf16_f32 v55, v30, v31
    v_mfma_f32_32x32x16_bf16 v[16:31], v[96:99], v[4:7], 0
    s_waitcnt lgkmcnt(1)
    v_exp_f32 v32, v32
    v_exp_f32 v33, v33
    v_exp_f32 v34, v34
    v_exp_f32 v35, v35
    v_cvt_pk_bf16_f32 v56, v32, v33
    v_cvt_pk_bf16_f32 v57, v34, v35
    v_mfma_f32_32x32x16_bf16 v[64:79], v[104:107], v[48:51], v[64:79]
    s_setprio 0
    v_exp_f32 v36, v36
    v_exp_f32 v37, v37
    v_exp_f32 v38, v38
    v_exp_f32 v39, v39
    v_cvt_pk_bf16_f32 v58, v36, v37
    v_cvt_pk_bf16_f32 v59, v38, v39
    v_mfma_f32_32x32x8_bf16 v[16:31], v[100:101], v[8:9], v[16:31]
    s_waitcnt lgkmcnt(0)
    v_exp_f32 v40, v40
    v_exp_f32 v41, v41
    v_exp_f32 v42, v42
    v_exp_f32 v43, v43
    v_cvt_pk_bf16_f32 v60, v40, v41
    v_cvt_pk_bf16_f32 v61, v42, v43
    v_mfma_f32_32x32x16_bf16 v[64:79], v[108:111], v[52:55], v[64:79]
    s_setprio 1
    v_exp_f32 v44, v44
    v_exp_f32 v45, v45
    v_exp_f32 v46, v46
    v_exp_f32 v47, v47
    v_cvt_pk_bf16_f32 v62, v44, v45
    v_cvt_pk_bf16_f32 v63, v46, v47
    v_mfma_f32_32x32x16_bf16 v[32:47], v[96:99], v[10:13], 0
    ds_read_b128 v[96:99], v144 offset:2048
    v_exp_f32 v16, v16
    v_exp_f32 v17, v17
    v_exp_f32 v18, v18
    v_exp_f32 v19, v19
    v_cvt_pk_bf16_f32 v48, v16, v17
    v_cvt_pk_bf16_f32 v49, v18, v19
    v_mfma_f32_32x32x16_bf16 v[80:95], v[104:107], v[56:59], v[80:95]
    s_waitcnt lgkmcnt(0)
    v_exp_f32 v20, v20
    v_exp_f32 v21, v21
    v_exp_f32 v22, v22
    v_exp_f32 v23, v23
    v_cvt_pk_bf16_f32 v50, v20, v21
    v_cvt_pk_bf16_f32 v51, v22, v23
    v_mfma_f32_32x32x8_bf16 v[32:47], v[100:101], v[14:15], v[32:47]
    ds_read_b64 v[100:101], v145 offset:512
    v_exp_f32 v24, v24
    v_exp_f32 v25, v25
    v_exp_f32 v26, v26
    v_exp_f32 v27, v27
    v_cvt_pk_bf16_f32 v52, v24, v25
    v_cvt_pk_bf16_f32 v53, v26, v27
    v_mfma_f32_32x32x16_bf16 v[80:95], v[108:111], v[60:63], v[80:95]
    s_mov_b64 exec, s[28:29]
    ds_read_b128 v[104:107], v146 offset:1280
    ds_read_b128 v[108:111], v146 offset:1920
    s_mov_b64 exec, -1
    v_exp_f32 v28, v28
    v_exp_f32 v29, v29
    v_exp_f32 v30, v30
    v_exp_f32 v31, v31
    v_cvt_pk_bf16_f32 v54, v28, v29
    v_cvt_pk_bf16_f32 v55, v30, v31
    v_mfma_f32_32x32x16_bf16 v[16:31], v[96:99], v[4:7], 0
    s_waitcnt lgkmcnt(1)
    v_exp_f32 v32, v32
    v_exp_f32 v33, v33
    v_exp_f32 v34, v34
    v_exp_f32 v35, v35
    v_cvt_pk_bf16_f32 v56, v32, v33
    v_cvt_pk_bf16_f32 v57, v34, v35
    v_mfma_f32_32x32x16_bf16 v[64:79], v[104:107], v[48:51], v[64:79]
    s_setprio 0
    v_exp_f32 v36, v36
    v_exp_f32 v37, v37
    v_exp_f32 v38, v38
    v_exp_f32 v39, v39
    v_cvt_pk_bf16_f32 v58, v36, v37
    v_cvt_pk_bf16_f32 v59, v38, v39
    v_mfma_f32_32x32x8_bf16 v[16:31], v[100:101], v[8:9], v[16:31]
    s_waitcnt lgkmcnt(0)
    v_exp_f32 v40, v40
    v_exp_f32 v41, v41
    v_exp_f32 v42, v42
    v_exp_f32 v43, v43
    v_cvt_pk_bf16_f32 v60, v40, v41
    v_cvt_pk_bf16_f32 v61, v42, v43
    v_mfma_f32_32x32x16_bf16 v[64:79], v[108:111], v[52:55], v[64:79]
    s_setprio 1
    v_exp_f32 v44, v44
    v_exp_f32 v45, v45
    v_exp_f32 v46, v46
    v_exp_f32 v47, v47
    v_cvt_pk_bf16_f32 v62, v44, v45
    v_cvt_pk_bf16_f32 v63, v46, v47
    v_mfma_f32_32x32x16_bf16 v[32:47], v[96:99], v[10:13], 0
    ds_read_b128 v[96:99], v144 offset:3072
    v_exp_f32 v16, v16
    v_exp_f32 v17, v17
    v_exp_f32 v18, v18
    v_exp_f32 v19, v19
    v_cvt_pk_bf16_f32 v48, v16, v17
    v_cvt_pk_bf16_f32 v49, v18, v19
    v_mfma_f32_32x32x16_bf16 v[80:95], v[104:107], v[56:59], v[80:95]
    s_waitcnt lgkmcnt(0)
    v_exp_f32 v20, v20
    v_exp_f32 v21, v21
    v_exp_f32 v22, v22
    v_exp_f32 v23, v23
    v_cvt_pk_bf16_f32 v50, v20, v21
    v_cvt_pk_bf16_f32 v51, v22, v23
    v_mfma_f32_32x32x8_bf16 v[32:47], v[100:101], v[14:15], v[32:47]
    ds_read_b64 v[100:101], v145 offset:768
    v_exp_f32 v24, v24
    v_exp_f32 v25, v25
    v_exp_f32 v26, v26
    v_exp_f32 v27, v27
    v_cvt_pk_bf16_f32 v52, v24, v25
    v_cvt_pk_bf16_f32 v53, v26, v27
    v_mfma_f32_32x32x16_bf16 v[80:95], v[108:111], v[60:63], v[80:95]
    s_mov_b64 exec, s[28:29]
    ds_read_b128 v[104:107], v146 offset:2560
    ds_read_b128 v[108:111], v146 offset:3200
    s_mov_b64 exec, -1
    v_exp_f32 v28, v28
    v_exp_f32 v29, v29
    v_exp_f32 v30, v30
    v_exp_f32 v31, v31
    v_cvt_pk_bf16_f32 v54, v28, v29
    v_cvt_pk_bf16_f32 v55, v30, v31
    v_mfma_f32_32x32x16_bf16 v[16:31], v[96:99], v[4:7], 0
    s_waitcnt lgkmcnt(1)
    v_exp_f32 v32, v32
    v_exp_f32 v33, v33
    v_exp_f32 v34, v34
    v_exp_f32 v35, v35
    v_cvt_pk_bf16_f32 v56, v32, v33
    v_cvt_pk_bf16_f32 v57, v34, v35
    v_mfma_f32_32x32x16_bf16 v[64:79], v[104:107], v[48:51], v[64:79]
    s_setprio 0
    v_exp_f32 v36, v36
    v_exp_f32 v37, v37
    v_exp_f32 v38, v38
    v_exp_f32 v39, v39
    v_cvt_pk_bf16_f32 v58, v36, v37
    v_cvt_pk_bf16_f32 v59, v38, v39
    v_mfma_f32_32x32x8_bf16 v[16:31], v[100:101], v[8:9], v[16:31]
    s_waitcnt lgkmcnt(0)
    v_exp_f32 v40, v40
    v_exp_f32 v41, v41
    v_exp_f32 v42, v42
    v_exp_f32 v43, v43
    v_cvt_pk_bf16_f32 v60, v40, v41
    v_cvt_pk_bf16_f32 v61, v42, v43
    v_mfma_f32_32x32x16_bf16 v[64:79], v[108:111], v[52:55], v[64:79]
    s_setprio 1
    v_exp_f32 v44, v44
    v_exp_f32 v45, v45
    v_exp_f32 v46, v46
    v_exp_f32 v47, v47
    v_cvt_pk_bf16_f32 v62, v44, v45
    v_cvt_pk_bf16_f32 v63, v46, v47
    v_mfma_f32_32x32x16_bf16 v[32:47], v[96:99], v[10:13], 0
    ds_read_b128 v[96:99], v144 offset:4096
    v_exp_f32 v16, v16
    v_exp_f32 v17, v17
    v_exp_f32 v18, v18
    v_exp_f32 v19, v19
    v_cvt_pk_bf16_f32 v48, v16, v17
    v_cvt_pk_bf16_f32 v49, v18, v19
    v_mfma_f32_32x32x16_bf16 v[80:95], v[104:107], v[56:59], v[80:95]
    s_waitcnt lgkmcnt(0)
    v_exp_f32 v20, v20
    v_exp_f32 v21, v21
    v_exp_f32 v22, v22
    v_exp_f32 v23, v23
    v_cvt_pk_bf16_f32 v50, v20, v21
    v_cvt_pk_bf16_f32 v51, v22, v23
    v_mfma_f32_32x32x8_bf16 v[32:47], v[100:101], v[14:15], v[32:47]
    ds_read_b64 v[100:101], v145 offset:1024
    v_exp_f32 v24, v24
    v_exp_f32 v25, v25
    v_exp_f32 v26, v26
    v_exp_f32 v27, v27
    v_cvt_pk_bf16_f32 v52, v24, v25
    v_cvt_pk_bf16_f32 v53, v26, v27
    v_mfma_f32_32x32x16_bf16 v[80:95], v[108:111], v[60:63], v[80:95]
    s_mov_b64 exec, s[28:29]
    ds_read_b128 v[104:107], v146 offset:3840
    ds_read_b128 v[108:111], v146 offset:4480
    s_mov_b64 exec, -1
    v_exp_f32 v28, v28
    v_exp_f32 v29, v29
    v_exp_f32 v30, v30
    v_exp_f32 v31, v31
    v_cvt_pk_bf16_f32 v54, v28, v29
    v_cvt_pk_bf16_f32 v55, v30, v31
    v_mfma_f32_32x32x16_bf16 v[16:31], v[96:99], v[4:7], 0
    s_waitcnt lgkmcnt(1)
    v_exp_f32 v32, v32
    v_exp_f32 v33, v33
    v_exp_f32 v34, v34
    v_exp_f32 v35, v35
    v_cvt_pk_bf16_f32 v56, v32, v33
    v_cvt_pk_bf16_f32 v57, v34, v35
    v_mfma_f32_32x32x16_bf16 v[64:79], v[104:107], v[48:51], v[64:79]
    s_setprio 0
    v_exp_f32 v36, v36
    v_exp_f32 v37, v37
    v_exp_f32 v38, v38
    v_exp_f32 v39, v39
    v_cvt_pk_bf16_f32 v58, v36, v37
    v_cvt_pk_bf16_f32 v59, v38, v39
    v_mfma_f32_32x32x8_bf16 v[16:31], v[100:101], v[8:9], v[16:31]
    s_waitcnt lgkmcnt(0)
    v_exp_f32 v40, v40
    v_exp_f32 v41, v41
    v_exp_f32 v42, v42
    v_exp_f32 v43, v43
    v_cvt_pk_bf16_f32 v60, v40, v41
    v_cvt_pk_bf16_f32 v61, v42, v43
    v_mfma_f32_32x32x16_bf16 v[64:79], v[108:111], v[52:55], v[64:79]
    s_setprio 1
    v_exp_f32 v44, v44
    v_exp_f32 v45, v45
    v_exp_f32 v46, v46
    v_exp_f32 v47, v47
    v_cvt_pk_bf16_f32 v62, v44, v45
    v_cvt_pk_bf16_f32 v63, v46, v47
    v_mfma_f32_32x32x16_bf16 v[32:47], v[96:99], v[10:13], 0
    ds_read_b128 v[96:99], v144 offset:5120
    v_exp_f32 v16, v16
    v_exp_f32 v17, v17
    v_exp_f32 v18, v18
    v_exp_f32 v19, v19
    v_cvt_pk_bf16_f32 v48, v16, v17
    v_cvt_pk_bf16_f32 v49, v18, v19
    v_mfma_f32_32x32x16_bf16 v[80:95], v[104:107], v[56:59], v[80:95]
    s_waitcnt lgkmcnt(0)
    v_exp_f32 v20, v20
    v_exp_f32 v21, v21
    v_exp_f32 v22, v22
    v_exp_f32 v23, v23
    v_cvt_pk_bf16_f32 v50, v20, v21
    v_cvt_pk_bf16_f32 v51, v22, v23
    v_mfma_f32_32x32x8_bf16 v[32:47], v[100:101], v[14:15], v[32:47]
    ds_read_b64 v[100:101], v145 offset:1280
    v_exp_f32 v24, v24
    v_exp_f32 v25, v25
    v_exp_f32 v26, v26
    v_exp_f32 v27, v27
    v_cvt_pk_bf16_f32 v52, v24, v25
    v_cvt_pk_bf16_f32 v53, v26, v27
    v_mfma_f32_32x32x16_bf16 v[80:95], v[108:111], v[60:63], v[80:95]
    s_mov_b64 exec, s[28:29]
    ds_read_b128 v[104:107], v146 offset:5120
    ds_read_b128 v[108:111], v146 offset:5760
    s_mov_b64 exec, -1
    v_exp_f32 v28, v28
    v_exp_f32 v29, v29
    v_exp_f32 v30, v30
    v_exp_f32 v31, v31
    v_cvt_pk_bf16_f32 v54, v28, v29
    v_cvt_pk_bf16_f32 v55, v30, v31
    v_mfma_f32_32x32x16_bf16 v[16:31], v[96:99], v[4:7], 0
    s_waitcnt lgkmcnt(1)
    v_exp_f32 v32, v32
    v_exp_f32 v33, v33
    v_exp_f32 v34, v34
    v_exp_f32 v35, v35
    v_cvt_pk_bf16_f32 v56, v32, v33
    v_cvt_pk_bf16_f32 v57, v34, v35
    v_mfma_f32_32x32x16_bf16 v[64:79], v[104:107], v[48:51], v[64:79]
    s_setprio 0
    v_exp_f32 v36, v36
    v_exp_f32 v37, v37
    v_exp_f32 v38, v38
    v_exp_f32 v39, v39
    v_cvt_pk_bf16_f32 v58, v36, v37
    v_cvt_pk_bf16_f32 v59, v38, v39
    v_mfma_f32_32x32x8_bf16 v[16:31], v[100:101], v[8:9], v[16:31]
    s_waitcnt lgkmcnt(0)
    v_exp_f32 v40, v40
    v_exp_f32 v41, v41
    v_exp_f32 v42, v42
    v_exp_f32 v43, v43
    v_cvt_pk_bf16_f32 v60, v40, v41
    v_cvt_pk_bf16_f32 v61, v42, v43
    v_mfma_f32_32x32x16_bf16 v[64:79], v[108:111], v[52:55], v[64:79]
    s_setprio 1
    v_exp_f32 v44, v44
    v_exp_f32 v45, v45
    v_exp_f32 v46, v46
    v_exp_f32 v47, v47
    v_cvt_pk_bf16_f32 v62, v44, v45
    v_cvt_pk_bf16_f32 v63, v46, v47
    v_mfma_f32_32x32x16_bf16 v[32:47], v[96:99], v[10:13], 0
    ds_read_b128 v[96:99], v144 offset:6144
    v_exp_f32 v16, v16
    v_exp_f32 v17, v17
    v_exp_f32 v18, v18
    v_exp_f32 v19, v19
    v_cvt_pk_bf16_f32 v48, v16, v17
    v_cvt_pk_bf16_f32 v49, v18, v19
    v_mfma_f32_32x32x16_bf16 v[80:95], v[104:107], v[56:59], v[80:95]
    s_waitcnt lgkmcnt(0)
    v_exp_f32 v20, v20
    v_exp_f32 v21, v21
    v_exp_f32 v22, v22
    v_exp_f32 v23, v23
    v_cvt_pk_bf16_f32 v50, v20, v21
    v_cvt_pk_bf16_f32 v51, v22, v23
    v_mfma_f32_32x32x8_bf16 v[32:47], v[100:101], v[14:15], v[32:47]
    ds_read_b64 v[100:101], v145 offset:1536
    v_exp_f32 v24, v24
    v_exp_f32 v25, v25
    v_exp_f32 v26, v26
    v_exp_f32 v27, v27
    v_cvt_pk_bf16_f32 v52, v24, v25
    v_cvt_pk_bf16_f32 v53, v26, v27
    v_mfma_f32_32x32x16_bf16 v[80:95], v[108:111], v[60:63], v[80:95]
    s_mov_b64 exec, s[28:29]
    ds_read_b128 v[104:107], v146 offset:6400
    ds_read_b128 v[108:111], v146 offset:7040
    s_mov_b64 exec, -1
    v_exp_f32 v28, v28
    v_exp_f32 v29, v29
    v_exp_f32 v30, v30
    v_exp_f32 v31, v31
    v_cvt_pk_bf16_f32 v54, v28, v29
    v_cvt_pk_bf16_f32 v55, v30, v31
    v_mfma_f32_32x32x16_bf16 v[16:31], v[96:99], v[4:7], 0
    s_waitcnt lgkmcnt(1)
    v_exp_f32 v32, v32
    v_exp_f32 v33, v33
    v_exp_f32 v34, v34
    v_exp_f32 v35, v35
    v_cvt_pk_bf16_f32 v56, v32, v33
    v_cvt_pk_bf16_f32 v57, v34, v35
    v_mfma_f32_32x32x16_bf16 v[64:79], v[104:107], v[48:51], v[64:79]
    s_setprio 0
    v_exp_f32 v36, v36
    v_exp_f32 v37, v37
    v_exp_f32 v38, v38
    v_exp_f32 v39, v39
    v_cvt_pk_bf16_f32 v58, v36, v37
    v_cvt_pk_bf16_f32 v59, v38, v39
    v_mfma_f32_32x32x8_bf16 v[16:31], v[100:101], v[8:9], v[16:31]
    s_waitcnt lgkmcnt(0)
    v_exp_f32 v40, v40
    v_exp_f32 v41, v41
    v_exp_f32 v42, v42
    v_exp_f32 v43, v43
    v_cvt_pk_bf16_f32 v60, v40, v41
    v_cvt_pk_bf16_f32 v61, v42, v43
    v_mfma_f32_32x32x16_bf16 v[64:79], v[108:111], v[52:55], v[64:79]
    s_setprio 1
    v_exp_f32 v44, v44
    v_exp_f32 v45, v45
    v_exp_f32 v46, v46
    v_exp_f32 v47, v47
    v_cvt_pk_bf16_f32 v62, v44, v45
    v_cvt_pk_bf16_f32 v63, v46, v47
    v_mfma_f32_32x32x16_bf16 v[32:47], v[96:99], v[10:13], 0
    ds_read_b128 v[96:99], v144 offset:7168
    v_exp_f32 v16, v16
    v_exp_f32 v17, v17
    v_exp_f32 v18, v18
    v_exp_f32 v19, v19
    v_cvt_pk_bf16_f32 v48, v16, v17
    v_cvt_pk_bf16_f32 v49, v18, v19
    v_mfma_f32_32x32x16_bf16 v[80:95], v[104:107], v[56:59], v[80:95]
    s_waitcnt lgkmcnt(0)
    v_exp_f32 v20, v20
    v_exp_f32 v21, v21
    v_exp_f32 v22, v22
    v_exp_f32 v23, v23
    v_cvt_pk_bf16_f32 v50, v20, v21
    v_cvt_pk_bf16_f32 v51, v22, v23
    v_mfma_f32_32x32x8_bf16 v[32:47], v[100:101], v[14:15], v[32:47]
    ds_read_b64 v[100:101], v145 offset:1792
    v_exp_f32 v24, v24
    v_exp_f32 v25, v25
    v_exp_f32 v26, v26
    v_exp_f32 v27, v27
    v_cvt_pk_bf16_f32 v52, v24, v25
    v_cvt_pk_bf16_f32 v53, v26, v27
    v_mfma_f32_32x32x16_bf16 v[80:95], v[108:111], v[60:63], v[80:95]
    s_mov_b64 exec, s[28:29]
    ds_read_b128 v[104:107], v146 offset:7680
    ds_read_b128 v[108:111], v146 offset:8320
    s_mov_b64 exec, -1
    v_exp_f32 v28, v28
    v_exp_f32 v29, v29
    v_exp_f32 v30, v30
    v_exp_f32 v31, v31
    v_cvt_pk_bf16_f32 v54, v28, v29
    v_cvt_pk_bf16_f32 v55, v30, v31
    v_mfma_f32_32x32x16_bf16 v[16:31], v[96:99], v[4:7], 0
    s_waitcnt lgkmcnt(1)
    v_exp_f32 v32, v32
    v_exp_f32 v33, v33
    v_exp_f32 v34, v34
    v_exp_f32 v35, v35
    v_cvt_pk_bf16_f32 v56, v32, v33
    v_cvt_pk_bf16_f32 v57, v34, v35
    v_mfma_f32_32x32x16_bf16 v[64:79], v[104:107], v[48:51], v[64:79]
    s_setprio 0
    v_exp_f32 v36, v36
    v_exp_f32 v37, v37
    v_exp_f32 v38, v38
    v_exp_f32 v39, v39
    v_cvt_pk_bf16_f32 v58, v36, v37
    v_cvt_pk_bf16_f32 v59, v38, v39
    v_mfma_f32_32x32x8_bf16 v[16:31], v[100:101], v[8:9], v[16:31]
    s_waitcnt lgkmcnt(0)
    v_exp_f32 v40, v40
    v_exp_f32 v41, v41
    v_exp_f32 v42, v42
    v_exp_f32 v43, v43
    v_cvt_pk_bf16_f32 v60, v40, v41
    v_cvt_pk_bf16_f32 v61, v42, v43
    v_mfma_f32_32x32x16_bf16 v[64:79], v[108:111], v[52:55], v[64:79]
    s_setprio 1
    v_exp_f32 v44, v44
    v_exp_f32 v45, v45
    v_exp_f32 v46, v46
    v_exp_f32 v47, v47
    v_cvt_pk_bf16_f32 v62, v44, v45
    v_cvt_pk_bf16_f32 v63, v46, v47
    s_cmp_lg_u32 s25, 3
    s_cbranch_scc1 sequential_preLN__softmax_full_mha__dense_activation_silu__prompt_kernel_att_f_h3
    global_load_dword v3, v2, s[4:5] sc1
sequential_preLN__softmax_full_mha__dense_activation_silu__prompt_kernel_att_f_h3:
    v_mfma_f32_32x32x16_bf16 v[32:47], v[96:99], v[10:13], 0
    ds_read_b128 v[96:99], v144 offset:8192
    v_exp_f32 v16, v16
    v_exp_f32 v17, v17
    v_exp_f32 v18, v18
    v_exp_f32 v19, v19
    v_cvt_pk_bf16_f32 v48, v16, v17
    v_cvt_pk_bf16_f32 v49, v18, v19
    v_mfma_f32_32x32x16_bf16 v[80:95], v[104:107], v[56:59], v[80:95]
    s_waitcnt lgkmcnt(0)
    v_exp_f32 v20, v20
    v_exp_f32 v21, v21
    v_exp_f32 v22, v22
    v_exp_f32 v23, v23
    v_cvt_pk_bf16_f32 v50, v20, v21
    v_cvt_pk_bf16_f32 v51, v22, v23
    v_mfma_f32_32x32x8_bf16 v[32:47], v[100:101], v[14:15], v[32:47]
    ds_read_b64 v[100:101], v145 offset:2048
    v_exp_f32 v24, v24
    v_exp_f32 v25, v25
    v_exp_f32 v26, v26
    v_exp_f32 v27, v27
    v_cvt_pk_bf16_f32 v52, v24, v25
    v_cvt_pk_bf16_f32 v53, v26, v27
    v_mfma_f32_32x32x16_bf16 v[80:95], v[108:111], v[60:63], v[80:95]
    s_mov_b64 exec, s[28:29]
    ds_read_b128 v[104:107], v146 offset:8960
    ds_read_b128 v[108:111], v146 offset:9600
    s_mov_b64 exec, -1
    v_exp_f32 v28, v28
    v_exp_f32 v29, v29
    v_exp_f32 v30, v30
    v_exp_f32 v31, v31
    v_cvt_pk_bf16_f32 v54, v28, v29
    v_cvt_pk_bf16_f32 v55, v30, v31
    v_mfma_f32_32x32x16_bf16 v[16:31], v[96:99], v[4:7], 0
    s_waitcnt lgkmcnt(1)
    v_exp_f32 v32, v32
    v_exp_f32 v33, v33
    v_exp_f32 v34, v34
    v_exp_f32 v35, v35
    v_cvt_pk_bf16_f32 v56, v32, v33
    v_cvt_pk_bf16_f32 v57, v34, v35
    v_mfma_f32_32x32x16_bf16 v[64:79], v[104:107], v[48:51], v[64:79]
    s_setprio 0
    v_exp_f32 v36, v36
    v_exp_f32 v37, v37
    v_exp_f32 v38, v38
    v_exp_f32 v39, v39
    v_cvt_pk_bf16_f32 v58, v36, v37
    v_cvt_pk_bf16_f32 v59, v38, v39
    v_mfma_f32_32x32x8_bf16 v[16:31], v[100:101], v[8:9], v[16:31]
    s_waitcnt lgkmcnt(0)
    v_exp_f32 v40, v40
    v_exp_f32 v41, v41
    v_exp_f32 v42, v42
    v_exp_f32 v43, v43
    v_cvt_pk_bf16_f32 v60, v40, v41
    v_cvt_pk_bf16_f32 v61, v42, v43
    v_mfma_f32_32x32x16_bf16 v[64:79], v[108:111], v[52:55], v[64:79]
    s_setprio 1
    v_exp_f32 v44, v44
    v_exp_f32 v45, v45
    v_exp_f32 v46, v46
    v_exp_f32 v47, v47
    v_cvt_pk_bf16_f32 v62, v44, v45
    v_cvt_pk_bf16_f32 v63, v46, v47
    v_add_u32 v144, 8192, v144
    v_add_u32 v145, 2048, v145
    v_add_u32 v146, 10240, v146
    s_add_u32 s25, s25, 1
    s_cmp_lt_u32 s25, 4
    s_cbranch_scc1 sequential_preLN__softmax_full_mha__dense_activation_silu__prompt_kernel_att_f_loop
    s_nop 1
    v_mfma_f32_32x32x16_bf16 v[80:95], v[104:107], v[56:59], v[80:95]
    v_mfma_f32_32x32x16_bf16 v[80:95], v[108:111], v[60:63], v[80:95]
    s_mul_i32 s30, s22, 3072
    v_add_u32 v152, s30, v147
    s_xor_b32 s31, s22, 4
    s_mul_i32 s31, s31, 3072
    v_add_u32 v153, s31, v147
    s_nop 7
    s_nop 3
    ds_write_b128 v152, v[80:83] offset:0
    ds_write_b128 v152, v[84:87] offset:1024
    ds_write_b128 v152, v[88:91] offset:2048
    v_mov_b32 v154, 140000
    v_mov_b32 v158, 0
    v_mov_b32 v159, 0
    ds_write_b64 v154, v[158:159]
    s_waitcnt lgkmcnt(0)
    s_barrier
    ds_read_b128 v[80:83], v153 offset:0
    ds_read_b128 v[84:87], v153 offset:1024
    ds_read_b128 v[88:91], v153 offset:2048
    s_waitcnt lgkmcnt(2)
    v_add_f32 v64, v64, v80
    v_add_f32 v65, v65, v81
    v_add_f32 v66, v66, v82
    v_add_f32 v67, v67, v83
    s_waitcnt lgkmcnt(1)
    v_add_f32 v68, v68, v84
    v_add_f32 v69, v69, v85
    v_add_f32 v70, v70, v86
    v_add_f32 v71, v71, v87
    s_waitcnt lgkmcnt(0)
    v_add_f32 v72, v72, v88
    v_add_f32 v73, v73, v89
    v_add_f32 v74, v74, v90
    v_add_f32 v75, v75, v91
sequential_preLN__softmax_full_mha__dense_activation_silu__prompt_kernel_att_norm:
    v_mov_b32 v152, v72
    v_mov_b32 v153, v72
    s_nop 1
    v_permlane32_swap_b32 v152, v153
    s_nop 1
    v_rcp_f32 v154, v153
    v_mov_b32 v155, 0
    v_mul_f32 v64, v154, v64
    v_mul_f32 v65, v154, v65
    v_mul_f32 v66, v154, v66
    v_mul_f32 v67, v154, v67
    v_mul_f32 v68, v154, v68
    v_mul_f32 v69, v154, v69
    v_mul_f32 v70, v154, v70
    v_mul_f32 v71, v154, v71
    v_mul_f32 v72, v154, v72
    v_mul_f32 v73, v154, v73
    v_mul_f32 v74, v154, v74
    v_mul_f32 v75, v154, v75
    v_cvt_pk_bf16_f32 v48, v64, v65
    v_cvt_pk_bf16_f32 v49, v66, v67
    buffer_store_dwordx2 v[48:49], v197, s[16:19], s51 offen sc1
    v_cvt_pk_bf16_f32 v50, v68, v69
    v_cvt_pk_bf16_f32 v51, v70, v71
    buffer_store_dwordx2 v[50:51], v198, s[16:19], s51 offen sc1
    v_cvt_pk_bf16_f32 v52, v72, v73
    v_cvt_pk_bf16_f32 v53, v74, v75
    s_mov_b32 exec_hi, 0
    buffer_store_dwordx2 v[52:53], v199, s[16:19], s51 offen sc1
    s_mov_b64 exec, -1
    s_cmp_lg_u32 s26, 0
    s_cbranch_scc1 sequential_preLN__softmax_full_mha__dense_activation_silu__prompt_kernel_att_fin
    v_fma_f32 v155, v64, 0, v155
    v_fma_f32 v155, v65, 0, v155
    v_fma_f32 v155, v66, 0, v155
    v_fma_f32 v155, v67, 0, v155
    v_fma_f32 v155, v68, 0, v155
    v_fma_f32 v155, v69, 0, v155
    v_fma_f32 v155, v70, 0, v155
    v_fma_f32 v155, v71, 0, v155
    v_fma_f32 v155, v72, 0, v155
    v_fma_f32 v155, v73, 0, v155
    v_fma_f32 v155, v74, 0, v155
    v_fma_f32 v155, v75, 0, v155
    v_fma_f32 v155, v153, 0, v155
    v_cmp_gt_f32 vcc, 0x2b800000, v153
    v_cmp_u_f32 s[38:39], v155, v155
    s_nop 1
    s_or_b64 s[38:39], s[38:39], vcc
    v_cmp_lt_f32 vcc, 0x71800000, v153
    s_nop 1
    s_or_b64 s[38:39], s[38:39], vcc
    s_cmp_eq_u64 s[38:39], 0
    s_cbranch_scc1 sequential_preLN__softmax_full_mha__dense_activation_silu__prompt_kernel_att_fin
    s_mov_b32 s26, 1
    v_mov_b32 v168, 0xff800000
    v_mul_u32_u24 v146, 320, v150
    v_lshl_add_u32 v146, v149, 4, v146
    s_mov_b32 s25, 0
    s_mov_b32 s57, 0
sequential_preLN__softmax_full_mha__dense_activation_silu__prompt_kernel_att_maxloop:
    buffer_load_dwordx4 v[96:99], v200, s[8:11], s57 offen sc1
    buffer_load_dwordx2 v[100:101], v202, s[8:11], s57 offen sc1
    s_waitcnt vmcnt(0)
    v_mfma_f32_32x32x16_bf16 v[16:31], v[96:99], v[4:7], 0
    v_mfma_f32_32x32x8_bf16 v[16:31], v[100:101], v[8:9], v[16:31]
    s_nop 15
    v_max3_f32 v168, v168, v16, v17
    v_max3_f32 v168, v168, v18, v19
    v_max3_f32 v168, v168, v20, v21
    v_max3_f32 v168, v168, v22, v23
    v_max3_f32 v168, v168, v24, v25
    v_max3_f32 v168, v168, v26, v27
    v_max3_f32 v168, v168, v28, v29
    v_max3_f32 v168, v168, v30, v31
    s_add_u32 s57, s57, 40960
    s_add_u32 s25, s25, 1
    s_cmp_lt_u32 s25, 64
    s_cbranch_scc1 sequential_preLN__softmax_full_mha__dense_activation_silu__prompt_kernel_att_maxloop
    v_mov_b32 v169, v168
    s_nop 1
    v_permlane32_swap_b32 v168, v169
    s_nop 1
    v_max_f32 v168, v168, v169
    v_sub_f32 v112, 0, v168
    v_mov_b32 v64, 0
    v_sub_f32 v113, 0, v168
    v_mov_b32 v65, 0
    v_sub_f32 v114, 0, v168
    v_mov_b32 v66, 0
    v_sub_f32 v115, 0, v168
    v_mov_b32 v67, 0
    v_sub_f32 v116, 0, v168
    v_mov_b32 v68, 0
    v_sub_f32 v117, 0, v168
    v_mov_b32 v69, 0
    v_sub_f32 v118, 0, v168
    v_mov_b32 v70, 0
    v_sub_f32 v119, 0, v168
    v_mov_b32 v71, 0
    v_sub_f32 v120, 0, v168
    v_mov_b32 v72, 0
    v_sub_f32 v121, 0, v168
    v_mov_b32 v73, 0
    v_sub_f32 v122, 0, v168
    v_mov_b32 v74, 0
    v_sub_f32 v123, 0, v168
    v_mov_b32 v75, 0
    v_sub_f32 v124, 0, v168
    v_mov_b32 v76, 0
    v_sub_f32 v125, 0, v168
    v_mov_b32 v77, 0
    v_sub_f32 v126, 0, v168
    v_mov_b32 v78, 0
    v_sub_f32 v127, 0, v168
    v_mov_b32 v79, 0
    s_mov_b32 s25, 0
    s_mov_b32 s57, 0
    s_mov_b32 s58, 0
sequential_preLN__softmax_full_mha__dense_activation_silu__prompt_kernel_att_exploop:
    buffer_load_dwordx4 v[96:99], v200, s[8:11], s57 offen sc1
    buffer_load_dwordx2 v[100:101], v202, s[8:11], s57 offen sc1
    s_mov_b64 exec, s[28:29]
    buffer_load_dwordx4 v[104:107], v146, s[52:55], s58 offen sc1
    buffer_load_dwordx4 v[108:111], v146, s[52:55], s58 offen offset:640 sc1
    s_mov_b64 exec, -1
    s_waitcnt vmcnt(0)
    v_mfma_f32_32x32x16_bf16 v[16:31], v[96:99], v[4:7], v[112:127]
    v_mfma_f32_32x32x8_bf16 v[16:31], v[100:101], v[8:9], v[16:31]
    s_nop 15
    v_exp_f32 v16, v16
    v_exp_f32 v17, v17
    v_exp_f32 v18, v18
    v_exp_f32 v19, v19
    v_cvt_pk_bf16_f32 v48, v16, v17
    v_cvt_pk_bf16_f32 v49, v18, v19
    v_exp_f32 v20, v20
    v_exp_f32 v21, v21
    v_exp_f32 v22, v22
    v_exp_f32 v23, v23
    v_cvt_pk_bf16_f32 v50, v20, v21
    v_cvt_pk_bf16_f32 v51, v22, v23
    v_exp_f32 v24, v24
    v_exp_f32 v25, v25
    v_exp_f32 v26, v26
    v_exp_f32 v27, v27
    v_cvt_pk_bf16_f32 v52, v24, v25
    v_cvt_pk_bf16_f32 v53, v26, v27
    v_exp_f32 v28, v28
    v_exp_f32 v29, v29
    v_exp_f32 v30, v30
    v_exp_f32 v31, v31
    v_cvt_pk_bf16_f32 v54, v28, v29
    v_cvt_pk_bf16_f32 v55, v30, v31
    s_nop 1
    v_mfma_f32_32x32x16_bf16 v[64:79], v[104:107], v[48:51], v[64:79]
    v_mfma_f32_32x32x16_bf16 v[64:79], v[108:111], v[52:55], v[64:79]
    s_add_u32 s57, s57, 40960
    s_add_u32 s58, s58, 1280
    s_add_u32 s25, s25, 1
    s_cmp_lt_u32 s25, 64
    s_cbranch_scc1 sequential_preLN__softmax_full_mha__dense_activation_silu__prompt_kernel_att_exploop
    s_nop 15
    s_branch sequential_preLN__softmax_full_mha__dense_activation_silu__prompt_kernel_att_norm
sequential_preLN__softmax_full_mha__dense_activation_silu__prompt_kernel_att_fin:
    s_mov_b64 exec, -1
    v_mov_b32 v245, v148
    s_lshl_b32 s34, s21, 8
    s_add_u32 s34, s34, 24281088
    s_waitcnt vmcnt(0)
    s_barrier
    s_cmp_lg_u32 s22, 0
    s_cbranch_scc1 sequential_preLN__softmax_full_mha__dense_activation_silu__prompt_kernel_att_w0_1
    s_mov_b64 exec, 1
    v_mov_b32 v60, s34
    v_mov_b32 v61, 1
    global_atomic_add v60, v61, s[4:5] sc1
    s_mov_b64 exec, -1
sequential_preLN__softmax_full_mha__dense_activation_silu__prompt_kernel_att_w0_1:
    s_cmp_ge_u32 s22, 4
    s_cbranch_scc1 sequential_preLN__softmax_full_mha__dense_activation_silu__prompt_kernel_att_L
    s_setprio 3
    s_load_dwordx2 s[56:57], s[0:1], 0
    s_and_b32 s30, s2, 7
    s_lshr_b32 s31, s2, 3
    s_lshr_b32 s24, s30, 1
    s_lshl_b32 s24, s24, 3
    s_and_b32 s32, s31, 7
    s_add_u32 s24, s24, s32
    s_and_b32 s25, s30, 1
    s_lshl_b32 s25, s25, 2
    s_lshr_b32 s32, s31, 3
    s_add_u32 s25, s25, s32
    s_and_b32 s26, s22, 1
    s_bfe_u32 s27, s22, 0x10001
    v_and_b32 v71, 15, v245
    v_lshrrev_b32 v72, 4, v245
    v_lshlrev_b32 v84, 10, v72
    v_lshl_add_u32 v84, v71, 4, v84
    s_lshl_b32 s30, s26, 9
    v_add_u32 v84, s30, v84
    s_lshl_b32 s30, s27, 8
    v_add_u32 v65, s30, v84
    s_xor_b32 s30, s30, 256
    v_add_u32 v66, s30, v84
    s_mul_i32 s37, s27, 40960
    s_mul_i32 s30, s24, 81920
    s_add_u32 s30, s30, 7864320
    s_add_u32 s12, s4, s30
    s_addc_u32 s13, s5, 0
    s_and_b32 s13, s13, 0xffff
    s_mov_b32 s14, 81920
    s_mov_b32 s15, 0x20000
    v_mul_u32_u24 v108, 1280, v71
    v_lshl_add_u32 v108, v72, 3, v108
    v_lshrrev_b32 v84, 1, v72
    v_lshlrev_b32 v84, 10, v84
    v_and_b32 v85, 1, v72
    v_lshl_add_u32 v84, v85, 3, v84
    v_lshl_add_u32 v109, v71, 4, v84
    s_lshl_b32 s30, s26, 5
    s_lshl_b32 s31, s27, 4
    s_add_u32 s30, s30, s31
    s_lshl_b32 s48, s30, 4
    s_mul_i32 s31, s24, 81920
    s_add_u32 s48, s48, s31
    s_mul_i32 s31, s25, 10240
    s_add_u32 s48, s48, s31
    s_lshl_b32 s31, s24, 6
    s_add_u32 s32, s30, s31
    s_mul_i32 s39, s32, 1280
    s_mul_i32 s31, s25, 160
    s_add_u32 s39, s39, s31
    s_lshl_b32 s49, s32, 3
    s_lshl_b32 s31, s25, 14
    s_add_u32 s49, s49, s31
    v_lshrrev_b32 v84, 1, v72
    v_lshlrev_b32 v84, 4, v84
    v_and_b32 v85, 1, v72
    v_lshl_add_u32 v84, v85, 2, v84
    v_lshrrev_b32 v85, 2, v71
    v_add_u32 v84, v84, v85
    v_mul_u32_u24 v84, 160, v84
    v_and_b32 v85, 3, v71
    v_lshl_add_u32 v84, v85, 3, v84
    s_mul_i32 s30, s27, 51200
    v_add_u32 v67, s30, v84
    v_add_u32 v67, 40960, v67
    s_waitcnt lgkmcnt(0)
    s_mov_b32 s16, s56
    s_and_b32 s17, s57, 0xffff
    s_mov_b32 s18, 2621440
    s_mov_b32 s19, 0x20000
    s_add_u32 s40, s4, 10485760
    s_addc_u32 s41, s5, 0
    s_and_b32 s41, s41, 0xffff
    s_mov_b32 s42, 2621440
    s_mov_b32 s43, 0x20000
    s_add_u32 s44, s4, 24150016
    s_addc_u32 s45, s5, 0
    s_and_b32 s45, s45, 0xffff
    s_mov_b32 s46, 131072
    s_mov_b32 s47, 0x20000
    buffer_load_dwordx2 v[74:75], v108, s[16:19], s39 offen offset:0
    buffer_load_dwordx2 v[76:77], v108, s[16:19], s39 offen offset:32
    buffer_load_dwordx2 v[78:79], v108, s[16:19], s39 offen offset:64
    buffer_load_dwordx2 v[80:81], v108, s[16:19], s39 offen offset:96
    buffer_load_dwordx2 v[82:83], v108, s[16:19], s39 offen offset:128
    s_lshr_b32 s34, s24, 2
    s_lshl_b32 s34, s34, 8
    s_add_u32 s34, s34, 24281088
    s_cmp_lg_u32 s22, 0
    s_cbranch_scc1 sequential_preLN__softmax_full_mha__dense_activation_silu__prompt_kernel_att_w0_2
    s_mov_b64 exec, 1
    v_mov_b32 v60, s34
    global_load_dword v61, v60, s[4:5] sc1
    s_mov_b64 exec, -1
sequential_preLN__softmax_full_mha__dense_activation_silu__prompt_kernel_att_w0_2:
    s_waitcnt vmcnt(0)
    v_lshlrev_b32 v0, 16, v74
    v_and_b32 v1, 0xffff0000, v74
    v_lshlrev_b32 v2, 16, v75
    v_and_b32 v3, 0xffff0000, v75
    v_lshlrev_b32 v4, 16, v76
    v_and_b32 v5, 0xffff0000, v76
    v_lshlrev_b32 v6, 16, v77
    v_and_b32 v7, 0xffff0000, v77
    v_lshlrev_b32 v8, 16, v78
    v_and_b32 v9, 0xffff0000, v78
    v_lshlrev_b32 v10, 16, v79
    v_and_b32 v11, 0xffff0000, v79
    v_lshlrev_b32 v12, 16, v80
    v_and_b32 v13, 0xffff0000, v80
    v_lshlrev_b32 v14, 16, v81
    v_and_b32 v15, 0xffff0000, v81
    v_lshlrev_b32 v16, 16, v82
    v_and_b32 v17, 0xffff0000, v82
    v_lshlrev_b32 v18, 16, v83
    v_and_b32 v19, 0xffff0000, v83
    s_cmp_lg_u32 s22, 0
    s_cbranch_scc1 sequential_preLN__softmax_full_mha__dense_activation_silu__prompt_kernel_att_w0_3
    s_mov_b64 exec, 1
    s_mov_b32 s35, 262144
    v_cmp_gt_u32 vcc, 32, v61
    s_cbranch_vccz sequential_preLN__softmax_full_mha__dense_activation_silu__prompt_kernel_att_poll4_d
sequential_preLN__softmax_full_mha__dense_activation_silu__prompt_kernel_att_poll4:
    global_load_dword v61, v60, s[4:5] sc1
    s_waitcnt vmcnt(0)
    v_cmp_gt_u32 vcc, 32, v61
    s_cbranch_vccz sequential_preLN__softmax_full_mha__dense_activation_silu__prompt_kernel_att_poll4_d
    s_sub_u32 s35, s35, 1
    s_cmp_lg_u32 s35, 0
    s_cbranch_scc1 sequential_preLN__softmax_full_mha__dense_activation_silu__prompt_kernel_att_poll4
sequential_preLN__softmax_full_mha__dense_activation_silu__prompt_kernel_att_poll4_d:
    s_mov_b64 exec, -1
sequential_preLN__softmax_full_mha__dense_activation_silu__prompt_kernel_att_w0_3:
    s_barrier
    s_add_u32 s31, s37, 0
    buffer_load_dwordx4 v[112:115], v65, s[12:15], s31 offen sc1
    buffer_load_dwordx4 v[116:119], v66, s[12:15], s31 offen sc1
    s_add_u32 s31, s37, 4096
    buffer_load_dwordx4 v[120:123], v65, s[12:15], s31 offen sc1
    buffer_load_dwordx4 v[124:127], v66, s[12:15], s31 offen sc1
    s_add_u32 s31, s37, 8192
    buffer_load_dwordx4 v[128:131], v65, s[12:15], s31 offen sc1
    buffer_load_dwordx4 v[132:135], v66, s[12:15], s31 offen sc1
    s_add_u32 s31, s37, 12288
    buffer_load_dwordx4 v[136:139], v65, s[12:15], s31 offen sc1
    buffer_load_dwordx4 v[140:143], v66, s[12:15], s31 offen sc1
    ds_read_b64_tr_b16 v[40:41], v67 offset:0
    ds_read_b64_tr_b16 v[42:43], v67 offset:1280
    ds_read_b64_tr_b16 v[44:45], v67 offset:32
    ds_read_b64_tr_b16 v[46:47], v67 offset:1312
    ds_read_b64_tr_b16 v[48:49], v67 offset:64
    ds_read_b64_tr_b16 v[50:51], v67 offset:1344
    ds_read_b64_tr_b16 v[52:53], v67 offset:96
    ds_read_b64_tr_b16 v[54:55], v67 offset:1376
    ds_read_b64_tr_b16 v[56:57], v67 offset:128
    ds_read_b64_tr_b16 v[58:59], v67 offset:1408
    s_add_u32 s31, s37, 16384
    buffer_load_dwordx4 v[144:147], v65, s[12:15], s31 offen sc1
    buffer_load_dwordx4 v[148:151], v66, s[12:15], s31 offen sc1
    s_add_u32 s31, s37, 20480
    buffer_load_dwordx4 v[152:155], v65, s[12:15], s31 offen sc1
    buffer_load_dwordx4 v[156:159], v66, s[12:15], s31 offen sc1
    s_add_u32 s31, s37, 24576
    buffer_load_dwordx4 v[160:163], v65, s[12:15], s31 offen sc1
    buffer_load_dwordx4 v[164:167], v66, s[12:15], s31 offen sc1
    s_add_u32 s31, s37, 28672
    buffer_load_dwordx4 v[168:171], v65, s[12:15], s31 offen sc1
    buffer_load_dwordx4 v[172:175], v66, s[12:15], s31 offen sc1
    s_add_u32 s31, s37, 32768
    buffer_load_dwordx4 v[176:179], v65, s[12:15], s31 offen sc1
    buffer_load_dwordx4 v[180:183], v66, s[12:15], s31 offen sc1
    s_add_u32 s31, s37, 36864
    buffer_load_dwordx4 v[184:187], v65, s[12:15], s31 offen sc1
    buffer_load_dwordx4 v[188:191], v66, s[12:15], s31 offen sc1
    s_barrier
    s_waitcnt vmcnt(18)
    s_waitcnt lgkmcnt(0)
    v_mfma_f32_16x16x32_bf16 v[0:3], v[40:43], v[112:115], v[0:3]
    ds_read_b64_tr_b16 v[88:89], v67 offset:5120
    v_mfma_f32_16x16x32_bf16 v[20:23], v[40:43], v[116:119], 0
    ds_read_b64_tr_b16 v[90:91], v67 offset:6400
    v_mfma_f32_16x16x32_bf16 v[4:7], v[44:47], v[112:115], v[4:7]
    ds_read_b64_tr_b16 v[92:93], v67 offset:5152
    v_mfma_f32_16x16x32_bf16 v[24:27], v[44:47], v[116:119], 0
    ds_read_b64_tr_b16 v[94:95], v67 offset:6432
    v_mfma_f32_16x16x32_bf16 v[8:11], v[48:51], v[112:115], v[8:11]
    ds_read_b64_tr_b16 v[96:97], v67 offset:5184
    v_mfma_f32_16x16x32_bf16 v[28:31], v[48:51], v[116:119], 0
    ds_read_b64_tr_b16 v[98:99], v67 offset:6464
    v_mfma_f32_16x16x32_bf16 v[12:15], v[52:55], v[112:115], v[12:15]
    ds_read_b64_tr_b16 v[100:101], v67 offset:5216
    v_mfma_f32_16x16x32_bf16 v[32:35], v[52:55], v[116:119], 0
    ds_read_b64_tr_b16 v[102:103], v67 offset:6496
    v_mfma_f32_16x16x32_bf16 v[16:19], v[56:59], v[112:115], v[16:19]
    ds_read_b64_tr_b16 v[104:105], v67 offset:5248
    v_mfma_f32_16x16x32_bf16 v[36:39], v[56:59], v[116:119], 0
    ds_read_b64_tr_b16 v[106:107], v67 offset:6528
    s_waitcnt vmcnt(16)
    s_waitcnt lgkmcnt(0)
    v_mfma_f32_16x16x32_bf16 v[0:3], v[88:91], v[120:123], v[0:3]
    ds_read_b64_tr_b16 v[40:41], v67 offset:10240
    v_mfma_f32_16x16x32_bf16 v[20:23], v[88:91], v[124:127], v[20:23]
    ds_read_b64_tr_b16 v[42:43], v67 offset:11520
    v_mfma_f32_16x16x32_bf16 v[4:7], v[92:95], v[120:123], v[4:7]
    ds_read_b64_tr_b16 v[44:45], v67 offset:10272
    v_mfma_f32_16x16x32_bf16 v[24:27], v[92:95], v[124:127], v[24:27]
    ds_read_b64_tr_b16 v[46:47], v67 offset:11552
    v_mfma_f32_16x16x32_bf16 v[8:11], v[96:99], v[120:123], v[8:11]
    ds_read_b64_tr_b16 v[48:49], v67 offset:10304
    v_mfma_f32_16x16x32_bf16 v[28:31], v[96:99], v[124:127], v[28:31]
    ds_read_b64_tr_b16 v[50:51], v67 offset:11584
    v_mfma_f32_16x16x32_bf16 v[12:15], v[100:103], v[120:123], v[12:15]
    ds_read_b64_tr_b16 v[52:53], v67 offset:10336
    v_mfma_f32_16x16x32_bf16 v[32:35], v[100:103], v[124:127], v[32:35]
    ds_read_b64_tr_b16 v[54:55], v67 offset:11616
    v_mfma_f32_16x16x32_bf16 v[16:19], v[104:107], v[120:123], v[16:19]
    ds_read_b64_tr_b16 v[56:57], v67 offset:10368
    v_mfma_f32_16x16x32_bf16 v[36:39], v[104:107], v[124:127], v[36:39]
    ds_read_b64_tr_b16 v[58:59], v67 offset:11648
    s_waitcnt vmcnt(14)
    s_waitcnt lgkmcnt(0)
    v_mfma_f32_16x16x32_bf16 v[0:3], v[40:43], v[128:131], v[0:3]
    ds_read_b64_tr_b16 v[88:89], v67 offset:15360
    v_mfma_f32_16x16x32_bf16 v[20:23], v[40:43], v[132:135], v[20:23]
    ds_read_b64_tr_b16 v[90:91], v67 offset:16640
    v_mfma_f32_16x16x32_bf16 v[4:7], v[44:47], v[128:131], v[4:7]
    ds_read_b64_tr_b16 v[92:93], v67 offset:15392
    v_mfma_f32_16x16x32_bf16 v[24:27], v[44:47], v[132:135], v[24:27]
    ds_read_b64_tr_b16 v[94:95], v67 offset:16672
    v_mfma_f32_16x16x32_bf16 v[8:11], v[48:51], v[128:131], v[8:11]
    ds_read_b64_tr_b16 v[96:97], v67 offset:15424
    v_mfma_f32_16x16x32_bf16 v[28:31], v[48:51], v[132:135], v[28:31]
    ds_read_b64_tr_b16 v[98:99], v67 offset:16704
    v_mfma_f32_16x16x32_bf16 v[12:15], v[52:55], v[128:131], v[12:15]
    ds_read_b64_tr_b16 v[100:101], v67 offset:15456
    v_mfma_f32_16x16x32_bf16 v[32:35], v[52:55], v[132:135], v[32:35]
    ds_read_b64_tr_b16 v[102:103], v67 offset:16736
    v_mfma_f32_16x16x32_bf16 v[16:19], v[56:59], v[128:131], v[16:19]
    ds_read_b64_tr_b16 v[104:105], v67 offset:15488
    v_mfma_f32_16x16x32_bf16 v[36:39], v[56:59], v[132:135], v[36:39]
    ds_read_b64_tr_b16 v[106:107], v67 offset:16768
    s_waitcnt vmcnt(12)
    s_waitcnt lgkmcnt(0)
    v_mfma_f32_16x16x32_bf16 v[0:3], v[88:91], v[136:139], v[0:3]
    ds_read_b64_tr_b16 v[40:41], v67 offset:20480
    v_mfma_f32_16x16x32_bf16 v[20:23], v[88:91], v[140:143], v[20:23]
    ds_read_b64_tr_b16 v[42:43], v67 offset:21760
    v_mfma_f32_16x16x32_bf16 v[4:7], v[92:95], v[136:139], v[4:7]
    ds_read_b64_tr_b16 v[44:45], v67 offset:20512
    v_mfma_f32_16x16x32_bf16 v[24:27], v[92:95], v[140:143], v[24:27]
    ds_read_b64_tr_b16 v[46:47], v67 offset:21792
    v_mfma_f32_16x16x32_bf16 v[8:11], v[96:99], v[136:139], v[8:11]
    ds_read_b64_tr_b16 v[48:49], v67 offset:20544
    v_mfma_f32_16x16x32_bf16 v[28:31], v[96:99], v[140:143], v[28:31]
    ds_read_b64_tr_b16 v[50:51], v67 offset:21824
    v_mfma_f32_16x16x32_bf16 v[12:15], v[100:103], v[136:139], v[12:15]
    ds_read_b64_tr_b16 v[52:53], v67 offset:20576
    v_mfma_f32_16x16x32_bf16 v[32:35], v[100:103], v[140:143], v[32:35]
    ds_read_b64_tr_b16 v[54:55], v67 offset:21856
    v_mfma_f32_16x16x32_bf16 v[16:19], v[104:107], v[136:139], v[16:19]
    ds_read_b64_tr_b16 v[56:57], v67 offset:20608
    v_mfma_f32_16x16x32_bf16 v[36:39], v[104:107], v[140:143], v[36:39]
    ds_read_b64_tr_b16 v[58:59], v67 offset:21888
    s_waitcnt vmcnt(10)
    s_waitcnt lgkmcnt(0)
    v_mfma_f32_16x16x32_bf16 v[0:3], v[40:43], v[144:147], v[0:3]
    ds_read_b64_tr_b16 v[88:89], v67 offset:25600
    v_mfma_f32_16x16x32_bf16 v[20:23], v[40:43], v[148:151], v[20:23]
    ds_read_b64_tr_b16 v[90:91], v67 offset:26880
    v_mfma_f32_16x16x32_bf16 v[4:7], v[44:47], v[144:147], v[4:7]
    ds_read_b64_tr_b16 v[92:93], v67 offset:25632
    v_mfma_f32_16x16x32_bf16 v[24:27], v[44:47], v[148:151], v[24:27]
    ds_read_b64_tr_b16 v[94:95], v67 offset:26912
    v_mfma_f32_16x16x32_bf16 v[8:11], v[48:51], v[144:147], v[8:11]
    ds_read_b64_tr_b16 v[96:97], v67 offset:25664
    v_mfma_f32_16x16x32_bf16 v[28:31], v[48:51], v[148:151], v[28:31]
    ds_read_b64_tr_b16 v[98:99], v67 offset:26944
    v_mfma_f32_16x16x32_bf16 v[12:15], v[52:55], v[144:147], v[12:15]
    ds_read_b64_tr_b16 v[100:101], v67 offset:25696
    v_mfma_f32_16x16x32_bf16 v[32:35], v[52:55], v[148:151], v[32:35]
    ds_read_b64_tr_b16 v[102:103], v67 offset:26976
    v_mfma_f32_16x16x32_bf16 v[16:19], v[56:59], v[144:147], v[16:19]
    ds_read_b64_tr_b16 v[104:105], v67 offset:25728
    v_mfma_f32_16x16x32_bf16 v[36:39], v[56:59], v[148:151], v[36:39]
    ds_read_b64_tr_b16 v[106:107], v67 offset:27008
    s_waitcnt vmcnt(8)
    s_waitcnt lgkmcnt(0)
    v_mfma_f32_16x16x32_bf16 v[0:3], v[88:91], v[152:155], v[0:3]
    ds_read_b64_tr_b16 v[40:41], v67 offset:30720
    v_mfma_f32_16x16x32_bf16 v[20:23], v[88:91], v[156:159], v[20:23]
    ds_read_b64_tr_b16 v[42:43], v67 offset:32000
    v_mfma_f32_16x16x32_bf16 v[4:7], v[92:95], v[152:155], v[4:7]
    ds_read_b64_tr_b16 v[44:45], v67 offset:30752
    v_mfma_f32_16x16x32_bf16 v[24:27], v[92:95], v[156:159], v[24:27]
    ds_read_b64_tr_b16 v[46:47], v67 offset:32032
    v_mfma_f32_16x16x32_bf16 v[8:11], v[96:99], v[152:155], v[8:11]
    ds_read_b64_tr_b16 v[48:49], v67 offset:30784
    v_mfma_f32_16x16x32_bf16 v[28:31], v[96:99], v[156:159], v[28:31]
    ds_read_b64_tr_b16 v[50:51], v67 offset:32064
    v_mfma_f32_16x16x32_bf16 v[12:15], v[100:103], v[152:155], v[12:15]
    ds_read_b64_tr_b16 v[52:53], v67 offset:30816
    v_mfma_f32_16x16x32_bf16 v[32:35], v[100:103], v[156:159], v[32:35]
    ds_read_b64_tr_b16 v[54:55], v67 offset:32096
    v_mfma_f32_16x16x32_bf16 v[16:19], v[104:107], v[152:155], v[16:19]
    ds_read_b64_tr_b16 v[56:57], v67 offset:30848
    v_mfma_f32_16x16x32_bf16 v[36:39], v[104:107], v[156:159], v[36:39]
    ds_read_b64_tr_b16 v[58:59], v67 offset:32128
    s_waitcnt vmcnt(6)
    s_waitcnt lgkmcnt(0)
    v_mfma_f32_16x16x32_bf16 v[0:3], v[40:43], v[160:163], v[0:3]
    ds_read_b64_tr_b16 v[88:89], v67 offset:35840
    v_mfma_f32_16x16x32_bf16 v[20:23], v[40:43], v[164:167], v[20:23]
    ds_read_b64_tr_b16 v[90:91], v67 offset:37120
    v_mfma_f32_16x16x32_bf16 v[4:7], v[44:47], v[160:163], v[4:7]
    ds_read_b64_tr_b16 v[92:93], v67 offset:35872
    v_mfma_f32_16x16x32_bf16 v[24:27], v[44:47], v[164:167], v[24:27]
    ds_read_b64_tr_b16 v[94:95], v67 offset:37152
    v_mfma_f32_16x16x32_bf16 v[8:11], v[48:51], v[160:163], v[8:11]
    ds_read_b64_tr_b16 v[96:97], v67 offset:35904
    v_mfma_f32_16x16x32_bf16 v[28:31], v[48:51], v[164:167], v[28:31]
    ds_read_b64_tr_b16 v[98:99], v67 offset:37184
    v_mfma_f32_16x16x32_bf16 v[12:15], v[52:55], v[160:163], v[12:15]
    ds_read_b64_tr_b16 v[100:101], v67 offset:35936
    v_mfma_f32_16x16x32_bf16 v[32:35], v[52:55], v[164:167], v[32:35]
    ds_read_b64_tr_b16 v[102:103], v67 offset:37216
    v_mfma_f32_16x16x32_bf16 v[16:19], v[56:59], v[160:163], v[16:19]
    ds_read_b64_tr_b16 v[104:105], v67 offset:35968
    v_mfma_f32_16x16x32_bf16 v[36:39], v[56:59], v[164:167], v[36:39]
    ds_read_b64_tr_b16 v[106:107], v67 offset:37248
    s_waitcnt vmcnt(4)
    s_waitcnt lgkmcnt(0)
    v_mfma_f32_16x16x32_bf16 v[0:3], v[88:91], v[168:171], v[0:3]
    ds_read_b64_tr_b16 v[40:41], v67 offset:40960
    v_mfma_f32_16x16x32_bf16 v[20:23], v[88:91], v[172:175], v[20:23]
    ds_read_b64_tr_b16 v[42:43], v67 offset:42240
    v_mfma_f32_16x16x32_bf16 v[4:7], v[92:95], v[168:171], v[4:7]
    ds_read_b64_tr_b16 v[44:45], v67 offset:40992
    v_mfma_f32_16x16x32_bf16 v[24:27], v[92:95], v[172:175], v[24:27]
    ds_read_b64_tr_b16 v[46:47], v67 offset:42272
    v_mfma_f32_16x16x32_bf16 v[8:11], v[96:99], v[168:171], v[8:11]
    ds_read_b64_tr_b16 v[48:49], v67 offset:41024
    v_mfma_f32_16x16x32_bf16 v[28:31], v[96:99], v[172:175], v[28:31]
    ds_read_b64_tr_b16 v[50:51], v67 offset:42304
    v_mfma_f32_16x16x32_bf16 v[12:15], v[100:103], v[168:171], v[12:15]
    ds_read_b64_tr_b16 v[52:53], v67 offset:41056
    v_mfma_f32_16x16x32_bf16 v[32:35], v[100:103], v[172:175], v[32:35]
    ds_read_b64_tr_b16 v[54:55], v67 offset:42336
    v_mfma_f32_16x16x32_bf16 v[16:19], v[104:107], v[168:171], v[16:19]
    ds_read_b64_tr_b16 v[56:57], v67 offset:41088
    v_mfma_f32_16x16x32_bf16 v[36:39], v[104:107], v[172:175], v[36:39]
    ds_read_b64_tr_b16 v[58:59], v67 offset:42368
    s_waitcnt vmcnt(2)
    s_waitcnt lgkmcnt(0)
    v_mfma_f32_16x16x32_bf16 v[0:3], v[40:43], v[176:179], v[0:3]
    ds_read_b64_tr_b16 v[88:89], v67 offset:46080
    v_mfma_f32_16x16x32_bf16 v[20:23], v[40:43], v[180:183], v[20:23]
    ds_read_b64_tr_b16 v[90:91], v67 offset:47360
    v_mfma_f32_16x16x32_bf16 v[4:7], v[44:47], v[176:179], v[4:7]
    ds_read_b64_tr_b16 v[92:93], v67 offset:46112
    v_mfma_f32_16x16x32_bf16 v[24:27], v[44:47], v[180:183], v[24:27]
    ds_read_b64_tr_b16 v[94:95], v67 offset:47392
    v_mfma_f32_16x16x32_bf16 v[8:11], v[48:51], v[176:179], v[8:11]
    ds_read_b64_tr_b16 v[96:97], v67 offset:46144
    v_mfma_f32_16x16x32_bf16 v[28:31], v[48:51], v[180:183], v[28:31]
    ds_read_b64_tr_b16 v[98:99], v67 offset:47424
    v_mfma_f32_16x16x32_bf16 v[12:15], v[52:55], v[176:179], v[12:15]
    ds_read_b64_tr_b16 v[100:101], v67 offset:46176
    v_mfma_f32_16x16x32_bf16 v[32:35], v[52:55], v[180:183], v[32:35]
    ds_read_b64_tr_b16 v[102:103], v67 offset:47456
    v_mfma_f32_16x16x32_bf16 v[16:19], v[56:59], v[176:179], v[16:19]
    ds_read_b64_tr_b16 v[104:105], v67 offset:46208
    v_mfma_f32_16x16x32_bf16 v[36:39], v[56:59], v[180:183], v[36:39]
    ds_read_b64_tr_b16 v[106:107], v67 offset:47488
    s_waitcnt vmcnt(0)
    s_waitcnt lgkmcnt(0)
    v_mfma_f32_16x16x32_bf16 v[0:3], v[88:91], v[184:187], v[0:3]
    v_mfma_f32_16x16x32_bf16 v[20:23], v[88:91], v[188:191], v[20:23]
    v_mfma_f32_16x16x32_bf16 v[4:7], v[92:95], v[184:187], v[4:7]
    v_mfma_f32_16x16x32_bf16 v[24:27], v[92:95], v[188:191], v[24:27]
    v_mfma_f32_16x16x32_bf16 v[8:11], v[96:99], v[184:187], v[8:11]
    v_mfma_f32_16x16x32_bf16 v[28:31], v[96:99], v[188:191], v[28:31]
    v_mfma_f32_16x16x32_bf16 v[12:15], v[100:103], v[184:187], v[12:15]
    v_mfma_f32_16x16x32_bf16 v[32:35], v[100:103], v[188:191], v[32:35]
    v_mfma_f32_16x16x32_bf16 v[16:19], v[104:107], v[184:187], v[16:19]
    v_mfma_f32_16x16x32_bf16 v[36:39], v[104:107], v[188:191], v[36:39]
    v_lshlrev_b32 v84, 4, v245
    s_mul_i32 s30, s22, 5120
    s_add_u32 s30, s30, 143360
    v_add_u32 v85, s30, v84
    s_xor_b32 s31, s22, 2
    s_mul_i32 s31, s31, 5120
    s_add_u32 s31, s31, 143360
    v_add_u32 v86, s31, v84
    s_nop 1
    ds_write_b128 v85, v[20:23] offset:0
    ds_write_b128 v85, v[24:27] offset:1024
    ds_write_b128 v85, v[28:31] offset:2048
    ds_write_b128 v85, v[32:35] offset:3072
    ds_write_b128 v85, v[36:39] offset:4096
    s_waitcnt lgkmcnt(0)
    s_barrier
    ds_read_b128 v[20:23], v86 offset:0
    ds_read_b128 v[24:27], v86 offset:1024
    ds_read_b128 v[28:31], v86 offset:2048
    ds_read_b128 v[32:35], v86 offset:3072
    ds_read_b128 v[36:39], v86 offset:4096
    s_waitcnt lgkmcnt(4)
    v_pk_add_f32 v[0:1], v[0:1], v[20:21]
    v_pk_add_f32 v[2:3], v[2:3], v[22:23]
    v_cvt_pk_bf16_f32 v246, v0, v1
    v_cvt_pk_bf16_f32 v247, v2, v3
    s_add_u32 s30, s48, 0
    buffer_store_dwordx2 v[246:247], v109, s[40:43], s30 offen sc1
    s_waitcnt lgkmcnt(3)
    v_pk_add_f32 v[4:5], v[4:5], v[24:25]
    v_pk_add_f32 v[6:7], v[6:7], v[26:27]
    v_cvt_pk_bf16_f32 v248, v4, v5
    v_cvt_pk_bf16_f32 v249, v6, v7
    s_add_u32 s30, s48, 2048
    buffer_store_dwordx2 v[248:249], v109, s[40:43], s30 offen sc1
    s_waitcnt lgkmcnt(2)
    v_pk_add_f32 v[8:9], v[8:9], v[28:29]
    v_pk_add_f32 v[10:11], v[10:11], v[30:31]
    v_cvt_pk_bf16_f32 v250, v8, v9
    v_cvt_pk_bf16_f32 v251, v10, v11
    s_add_u32 s30, s48, 4096
    buffer_store_dwordx2 v[250:251], v109, s[40:43], s30 offen sc1
    s_waitcnt lgkmcnt(1)
    v_pk_add_f32 v[12:13], v[12:13], v[32:33]
    v_pk_add_f32 v[14:15], v[14:15], v[34:35]
    v_cvt_pk_bf16_f32 v252, v12, v13
    v_cvt_pk_bf16_f32 v253, v14, v15
    s_add_u32 s30, s48, 6144
    buffer_store_dwordx2 v[252:253], v109, s[40:43], s30 offen sc1
    s_waitcnt lgkmcnt(0)
    v_pk_add_f32 v[16:17], v[16:17], v[36:37]
    v_pk_add_f32 v[18:19], v[18:19], v[38:39]
    v_cvt_pk_bf16_f32 v254, v16, v17
    v_cvt_pk_bf16_f32 v255, v18, v19
    s_add_u32 s30, s48, 8192
    buffer_store_dwordx2 v[254:255], v109, s[40:43], s30 offen sc1
    v_pk_mul_f32 v[98:99], v[0:1], v[0:1]
    v_pk_add_f32 v[96:97], v[0:1], v[2:3]
    v_pk_fma_f32 v[98:99], v[2:3], v[2:3], v[98:99]
    v_pk_fma_f32 v[98:99], v[4:5], v[4:5], v[98:99]
    v_pk_add_f32 v[96:97], v[96:97], v[4:5]
    v_pk_fma_f32 v[98:99], v[6:7], v[6:7], v[98:99]
    v_pk_add_f32 v[96:97], v[96:97], v[6:7]
    v_pk_fma_f32 v[98:99], v[8:9], v[8:9], v[98:99]
    v_pk_add_f32 v[96:97], v[96:97], v[8:9]
    v_pk_fma_f32 v[98:99], v[10:11], v[10:11], v[98:99]
    v_pk_add_f32 v[96:97], v[96:97], v[10:11]
    v_pk_fma_f32 v[98:99], v[12:13], v[12:13], v[98:99]
    v_pk_add_f32 v[96:97], v[96:97], v[12:13]
    v_pk_fma_f32 v[98:99], v[14:15], v[14:15], v[98:99]
    v_pk_add_f32 v[96:97], v[96:97], v[14:15]
    v_pk_fma_f32 v[98:99], v[16:17], v[16:17], v[98:99]
    v_pk_add_f32 v[96:97], v[96:97], v[16:17]
    v_pk_fma_f32 v[98:99], v[18:19], v[18:19], v[98:99]
    v_pk_add_f32 v[96:97], v[96:97], v[18:19]
    v_add_f32 v96, v96, v97
    v_add_f32 v98, v98, v99
    v_mov_b32 v97, v96
    v_mov_b32 v99, v98
    s_nop 1
    v_permlane32_swap_b32 v96, v97
    v_permlane32_swap_b32 v98, v99
    s_nop 1
    v_add_f32 v96, v96, v97
    v_add_f32 v98, v98, v99
    v_mov_b32 v97, v96
    v_mov_b32 v99, v98
    s_nop 1
    v_permlane16_swap_b32 v96, v97
    v_permlane16_swap_b32 v98, v99
    s_nop 1
    v_add_f32 v96, v96, v97
    v_add_f32 v98, v98, v99
    v_mov_b32 v97, v98
    v_lshlrev_b32 v84, 3, v71
    s_mov_b64 exec, 0xffff
    buffer_store_dwordx2 v[96:97], v84, s[44:47], s49 offen sc1
    s_mov_b64 exec, -1
    s_lshr_b32 s34, s24, 1
    s_lshl_b32 s34, s34, 8
    s_add_u32 s34, s34, 24283136
    s_barrier
    s_waitcnt vmcnt(0)
    s_barrier
    s_cmp_lg_u32 s22, 0
    s_cbranch_scc1 sequential_preLN__softmax_full_mha__dense_activation_silu__prompt_kernel_att_w0_5
    s_mov_b64 exec, 1
    v_mov_b32 v60, s34
    v_mov_b32 v61, 1
    global_atomic_add v60, v61, s[4:5] sc1
    s_mov_b64 exec, -1
sequential_preLN__softmax_full_mha__dense_activation_silu__prompt_kernel_att_w0_5:
    s_and_b32 s30, s2, 7
    s_lshr_b32 s31, s2, 3
    s_lshr_b32 s24, s30, 1
    s_lshl_b32 s24, s24, 2
    s_and_b32 s32, s31, 3
    s_add_u32 s24, s24, s32
    s_and_b32 s25, s30, 1
    s_lshl_b32 s25, s25, 3
    s_lshr_b32 s32, s31, 2
    s_add_u32 s25, s25, s32
    s_and_b32 s28, s22, 3
    v_and_b32 v214, 31, v245
    v_lshrrev_b32 v215, 5, v245
    v_lshlrev_b32 v204, 10, v215
    v_lshl_add_u32 v204, v214, 4, v204
    s_lshl_b32 s30, s24, 1
    s_lshr_b32 s31, s28, 1
    s_add_u32 s33, s30, s31
    s_mul_i32 s30, s33, 81920
    s_add_u32 s30, s30, 10485760
    s_add_u32 s12, s4, s30
    s_addc_u32 s13, s5, 0
    s_and_b32 s13, s13, 0xffff
    s_mov_b32 s14, 81920
    s_mov_b32 s15, 0x20000
    s_and_b32 s37, s28, 1
    s_lshl_b32 s37, s37, 9
    s_mul_i32 s50, s33, 196608
    s_add_u32 s50, s50, s37
    s_add_u32 s40, s4, 13107200
    s_addc_u32 s41, s5, 0
    s_and_b32 s41, s41, 0xffff
    s_mov_b32 s42, 6291456
    s_mov_b32 s43, 0x20000
    s_add_u32 s52, s28, 0
    s_cmp_ge_u32 s52, 3
    s_cselect_b32 s30, 3, 0
    s_sub_u32 s52, s52, s30
    s_cmp_ge_u32 s52, 3
    s_cselect_b32 s30, 3, 0
    s_sub_u32 s52, s52, s30
    s_add_u32 s53, s28, 1
    s_cmp_ge_u32 s53, 3
    s_cselect_b32 s30, 3, 0
    s_sub_u32 s53, s53, s30
    s_cmp_ge_u32 s53, 3
    s_cselect_b32 s30, 3, 0
    s_sub_u32 s53, s53, s30
    s_add_u32 s54, s28, 2
    s_cmp_ge_u32 s54, 3
    s_cselect_b32 s30, 3, 0
    s_sub_u32 s54, s54, s30
    s_cmp_ge_u32 s54, 3
    s_cselect_b32 s30, 3, 0
    s_sub_u32 s54, s54, s30
    v_bfe_u32 v216, v245, 2, 2
    v_lshl_add_u32 v216, v215, 3, v216
    v_mul_u32_u24 v216, 192, v216
    v_bfe_u32 v217, v245, 4, 1
    v_lshl_add_u32 v216, v217, 5, v216
    v_and_b32 v217, 3, v245
    v_lshl_add_u32 v216, v217, 3, v216
    s_lshl_b32 s30, s52, 6
    v_add_u32 v205, s30, v216
    s_lshl_b32 s30, s53, 6
    v_add_u32 v206, s30, v216
    s_lshl_b32 s30, s54, 6
    v_add_u32 v207, s30, v216
    v_and_b32 v216, 15, v245
    v_bfe_u32 v217, v245, 4, 1
    v_cmp_eq_u32 vcc, v216, v217
    v_mov_b32 v218, 0x3f803f80
    s_nop 0
    v_cndmask_b32 v188, 0, v218, vcc
    v_mov_b32 v189, v188
    v_mov_b32 v190, v188
    v_mov_b32 v191, v188
    s_lshl_b32 s30, s24, 7
    s_lshl_b32 s31, s28, 5
    s_add_u32 s30, s30, s31
    s_lshl_b32 s49, s30, 3
    v_lshlrev_b32 v219, 16, v215
    v_lshl_add_u32 v219, v214, 3, v219
    s_lshl_b32 s34, s24, 8
    s_add_u32 s34, s34, 24283136
    s_cmp_lg_u32 s22, 0
    s_cbranch_scc1 sequential_preLN__softmax_full_mha__dense_activation_silu__prompt_kernel_att_w0_6
    s_mov_b64 exec, 1
    v_mov_b32 v222, s34
    s_mov_b32 s35, 262144
sequential_preLN__softmax_full_mha__dense_activation_silu__prompt_kernel_att_poll7:
    global_load_dword v223, v222, s[4:5] sc1
    s_waitcnt vmcnt(0)
    v_cmp_gt_u32 vcc, 16, v223
    s_cbranch_vccz sequential_preLN__softmax_full_mha__dense_activation_silu__prompt_kernel_att_poll7_d
    s_sub_u32 s35, s35, 1
    s_cmp_lg_u32 s35, 0
    s_cbranch_scc1 sequential_preLN__softmax_full_mha__dense_activation_silu__prompt_kernel_att_poll7
sequential_preLN__softmax_full_mha__dense_activation_silu__prompt_kernel_att_poll7_d:
    s_mov_b64 exec, -1
sequential_preLN__softmax_full_mha__dense_activation_silu__prompt_kernel_att_w0_6:
    s_barrier
    s_add_u32 s31, s37, 0
    buffer_load_dwordx4 v[60:63], v204, s[12:15], s31 offen offset:0 sc1
    s_add_u32 s31, s37, 0
    buffer_load_dwordx4 v[64:67], v204, s[12:15], s31 offen offset:2048 sc1
    s_add_u32 s31, s37, 4096
    buffer_load_dwordx4 v[68:71], v204, s[12:15], s31 offen offset:0 sc1
    s_add_u32 s31, s37, 4096
    buffer_load_dwordx4 v[72:75], v204, s[12:15], s31 offen offset:2048 sc1
    ds_read_b64_tr_b16 v[48:49], v205 offset:0
    ds_read_b64_tr_b16 v[50:51], v205 offset:768
    ds_read_b64_tr_b16 v[52:53], v206 offset:0
    ds_read_b64_tr_b16 v[54:55], v206 offset:768
    ds_read_b64_tr_b16 v[56:57], v207 offset:0
    ds_read_b64_tr_b16 v[58:59], v207 offset:768
    buffer_load_dwordx2 v[196:197], v219, s[44:47], s49 offen sc1
    s_add_u32 s49, s49, 16384
    buffer_load_dwordx2 v[198:199], v219, s[44:47], s49 offen sc1
    s_add_u32 s49, s49, 16384
    buffer_load_dwordx2 v[200:201], v219, s[44:47], s49 offen sc1
    s_add_u32 s49, s49, 16384
    buffer_load_dwordx2 v[202:203], v219, s[44:47], s49 offen sc1
    s_add_u32 s31, s37, 8192
    buffer_load_dwordx4 v[76:79], v204, s[12:15], s31 offen offset:0 sc1
    s_add_u32 s31, s37, 8192
    buffer_load_dwordx4 v[80:83], v204, s[12:15], s31 offen offset:2048 sc1
    s_add_u32 s31, s37, 12288
    buffer_load_dwordx4 v[84:87], v204, s[12:15], s31 offen offset:0 sc1
    s_add_u32 s31, s37, 12288
    buffer_load_dwordx4 v[88:91], v204, s[12:15], s31 offen offset:2048 sc1
    s_add_u32 s31, s37, 16384
    buffer_load_dwordx4 v[92:95], v204, s[12:15], s31 offen offset:0 sc1
    s_add_u32 s31, s37, 16384
    buffer_load_dwordx4 v[96:99], v204, s[12:15], s31 offen offset:2048 sc1
    s_add_u32 s31, s37, 20480
    buffer_load_dwordx4 v[100:103], v204, s[12:15], s31 offen offset:0 sc1
    s_add_u32 s31, s37, 20480
    buffer_load_dwordx4 v[104:107], v204, s[12:15], s31 offen offset:2048 sc1
    s_waitcnt vmcnt(15)
    s_waitcnt lgkmcnt(4)
    v_mfma_f32_32x32x16_bf16 v[0:15], v[48:51], v[60:63], 0
    v_mfma_f32_16x16x32_bf16 v[192:195], v[188:191], v[48:51], 0
    ds_read_b64_tr_b16 v[48:49], v205 offset:3072
    ds_read_b64_tr_b16 v[50:51], v205 offset:3840
    s_waitcnt lgkmcnt(4)
    v_mfma_f32_32x32x16_bf16 v[16:31], v[52:55], v[60:63], 0
    ds_read_b64_tr_b16 v[52:53], v206 offset:3072
    ds_read_b64_tr_b16 v[54:55], v206 offset:3840
    s_waitcnt lgkmcnt(4)
    v_mfma_f32_32x32x16_bf16 v[32:47], v[56:59], v[60:63], 0
    ds_read_b64_tr_b16 v[56:57], v207 offset:3072
    ds_read_b64_tr_b16 v[58:59], v207 offset:3840
    s_add_u32 s31, s37, 24576
    buffer_load_dwordx4 v[108:111], v204, s[12:15], s31 offen offset:0 sc1
    s_add_u32 s31, s37, 24576
    buffer_load_dwordx4 v[112:115], v204, s[12:15], s31 offen offset:2048 sc1
    s_waitcnt vmcnt(16)
    s_waitcnt lgkmcnt(4)
    v_mfma_f32_32x32x16_bf16 v[0:15], v[48:51], v[64:67], v[0:15]
    v_mfma_f32_16x16x32_bf16 v[192:195], v[188:191], v[48:51], v[192:195]
    ds_read_b64_tr_b16 v[48:49], v205 offset:6144
    ds_read_b64_tr_b16 v[50:51], v205 offset:6912
    s_waitcnt lgkmcnt(4)
    v_mfma_f32_32x32x16_bf16 v[16:31], v[52:55], v[64:67], v[16:31]
    ds_read_b64_tr_b16 v[52:53], v206 offset:6144
    ds_read_b64_tr_b16 v[54:55], v206 offset:6912
    s_waitcnt lgkmcnt(4)
    v_mfma_f32_32x32x16_bf16 v[32:47], v[56:59], v[64:67], v[32:47]
    ds_read_b64_tr_b16 v[56:57], v207 offset:6144
    ds_read_b64_tr_b16 v[58:59], v207 offset:6912
    s_add_u32 s31, s37, 28672
    buffer_load_dwordx4 v[116:119], v204, s[12:15], s31 offen offset:0 sc1
    s_add_u32 s31, s37, 28672
    buffer_load_dwordx4 v[120:123], v204, s[12:15], s31 offen offset:2048 sc1
    s_waitcnt vmcnt(17)
    s_waitcnt lgkmcnt(4)
    v_mfma_f32_32x32x16_bf16 v[0:15], v[48:51], v[68:71], v[0:15]
    v_mfma_f32_16x16x32_bf16 v[192:195], v[188:191], v[48:51], v[192:195]
    ds_read_b64_tr_b16 v[48:49], v205 offset:9216
    ds_read_b64_tr_b16 v[50:51], v205 offset:9984
    s_waitcnt lgkmcnt(4)
    v_mfma_f32_32x32x16_bf16 v[16:31], v[52:55], v[68:71], v[16:31]
    ds_read_b64_tr_b16 v[52:53], v206 offset:9216
    ds_read_b64_tr_b16 v[54:55], v206 offset:9984
    s_waitcnt lgkmcnt(4)
    v_mfma_f32_32x32x16_bf16 v[32:47], v[56:59], v[68:71], v[32:47]
    ds_read_b64_tr_b16 v[56:57], v207 offset:9216
    ds_read_b64_tr_b16 v[58:59], v207 offset:9984
    s_add_u32 s31, s37, 32768
    buffer_load_dwordx4 v[124:127], v204, s[12:15], s31 offen offset:0 sc1
    s_waitcnt vmcnt(17)
    s_waitcnt lgkmcnt(4)
    v_mfma_f32_32x32x16_bf16 v[0:15], v[48:51], v[72:75], v[0:15]
    v_mfma_f32_16x16x32_bf16 v[192:195], v[188:191], v[48:51], v[192:195]
    ds_read_b64_tr_b16 v[48:49], v205 offset:12288
    ds_read_b64_tr_b16 v[50:51], v205 offset:13056
    s_waitcnt lgkmcnt(4)
    v_mfma_f32_32x32x16_bf16 v[16:31], v[52:55], v[72:75], v[16:31]
    ds_read_b64_tr_b16 v[52:53], v206 offset:12288
    ds_read_b64_tr_b16 v[54:55], v206 offset:13056
    s_waitcnt lgkmcnt(4)
    v_mfma_f32_32x32x16_bf16 v[32:47], v[56:59], v[72:75], v[32:47]
    ds_read_b64_tr_b16 v[56:57], v207 offset:12288
    ds_read_b64_tr_b16 v[58:59], v207 offset:13056
    s_add_u32 s31, s37, 32768
    buffer_load_dwordx4 v[128:131], v204, s[12:15], s31 offen offset:2048 sc1
    s_waitcnt vmcnt(13)
    s_waitcnt lgkmcnt(4)
    v_mfma_f32_32x32x16_bf16 v[0:15], v[48:51], v[76:79], v[0:15]
    v_mfma_f32_16x16x32_bf16 v[192:195], v[188:191], v[48:51], v[192:195]
    ds_read_b64_tr_b16 v[48:49], v205 offset:15360
    ds_read_b64_tr_b16 v[50:51], v205 offset:16128
    s_waitcnt lgkmcnt(4)
    v_mfma_f32_32x32x16_bf16 v[16:31], v[52:55], v[76:79], v[16:31]
    ds_read_b64_tr_b16 v[52:53], v206 offset:15360
    ds_read_b64_tr_b16 v[54:55], v206 offset:16128
    s_waitcnt lgkmcnt(4)
    v_mfma_f32_32x32x16_bf16 v[32:47], v[56:59], v[76:79], v[32:47]
    ds_read_b64_tr_b16 v[56:57], v207 offset:15360
    ds_read_b64_tr_b16 v[58:59], v207 offset:16128
    s_add_u32 s31, s37, 36864
    buffer_load_dwordx4 v[132:135], v204, s[12:15], s31 offen offset:0 sc1
    s_waitcnt vmcnt(13)
    s_waitcnt lgkmcnt(4)
    v_mfma_f32_32x32x16_bf16 v[0:15], v[48:51], v[80:83], v[0:15]
    v_mfma_f32_16x16x32_bf16 v[192:195], v[188:191], v[48:51], v[192:195]
    ds_read_b64_tr_b16 v[48:49], v205 offset:18432
    ds_read_b64_tr_b16 v[50:51], v205 offset:19200
    s_waitcnt lgkmcnt(4)
    v_mfma_f32_32x32x16_bf16 v[16:31], v[52:55], v[80:83], v[16:31]
    ds_read_b64_tr_b16 v[52:53], v206 offset:18432
    ds_read_b64_tr_b16 v[54:55], v206 offset:19200
    s_waitcnt lgkmcnt(4)
    v_mfma_f32_32x32x16_bf16 v[32:47], v[56:59], v[80:83], v[32:47]
    ds_read_b64_tr_b16 v[56:57], v207 offset:18432
    ds_read_b64_tr_b16 v[58:59], v207 offset:19200
    s_add_u32 s31, s37, 36864
    buffer_load_dwordx4 v[136:139], v204, s[12:15], s31 offen offset:2048 sc1
    s_waitcnt vmcnt(13)
    s_waitcnt lgkmcnt(4)
    v_mfma_f32_32x32x16_bf16 v[0:15], v[48:51], v[84:87], v[0:15]
    v_mfma_f32_16x16x32_bf16 v[192:195], v[188:191], v[48:51], v[192:195]
    ds_read_b64_tr_b16 v[48:49], v205 offset:21504
    ds_read_b64_tr_b16 v[50:51], v205 offset:22272
    s_waitcnt lgkmcnt(4)
    v_mfma_f32_32x32x16_bf16 v[16:31], v[52:55], v[84:87], v[16:31]
    ds_read_b64_tr_b16 v[52:53], v206 offset:21504
    ds_read_b64_tr_b16 v[54:55], v206 offset:22272
    s_waitcnt lgkmcnt(4)
    v_mfma_f32_32x32x16_bf16 v[32:47], v[56:59], v[84:87], v[32:47]
    ds_read_b64_tr_b16 v[56:57], v207 offset:21504
    ds_read_b64_tr_b16 v[58:59], v207 offset:22272
    s_add_u32 s31, s37, 40960
    buffer_load_dwordx4 v[140:143], v204, s[12:15], s31 offen offset:0 sc1
    s_barrier
    s_waitcnt vmcnt(13)
    s_waitcnt lgkmcnt(4)
    v_mfma_f32_32x32x16_bf16 v[0:15], v[48:51], v[88:91], v[0:15]
    v_mfma_f32_16x16x32_bf16 v[192:195], v[188:191], v[48:51], v[192:195]
    ds_read_b64_tr_b16 v[48:49], v205 offset:24576
    ds_read_b64_tr_b16 v[50:51], v205 offset:25344
    s_waitcnt lgkmcnt(4)
    v_mfma_f32_32x32x16_bf16 v[16:31], v[52:55], v[88:91], v[16:31]
    ds_read_b64_tr_b16 v[52:53], v206 offset:24576
    ds_read_b64_tr_b16 v[54:55], v206 offset:25344
    s_waitcnt lgkmcnt(4)
    v_mfma_f32_32x32x16_bf16 v[32:47], v[56:59], v[88:91], v[32:47]
    ds_read_b64_tr_b16 v[56:57], v207 offset:24576
    ds_read_b64_tr_b16 v[58:59], v207 offset:25344
    s_add_u32 s31, s37, 40960
    buffer_load_dwordx4 v[144:147], v204, s[12:15], s31 offen offset:2048 sc1
    s_waitcnt vmcnt(13)
    s_waitcnt lgkmcnt(4)
    v_mfma_f32_32x32x16_bf16 v[0:15], v[48:51], v[92:95], v[0:15]
    v_mfma_f32_16x16x32_bf16 v[192:195], v[188:191], v[48:51], v[192:195]
    ds_read_b64_tr_b16 v[48:49], v205 offset:27648
    ds_read_b64_tr_b16 v[50:51], v205 offset:28416
    s_waitcnt lgkmcnt(4)
    v_mfma_f32_32x32x16_bf16 v[16:31], v[52:55], v[92:95], v[16:31]
    ds_read_b64_tr_b16 v[52:53], v206 offset:27648
    ds_read_b64_tr_b16 v[54:55], v206 offset:28416
    s_waitcnt lgkmcnt(4)
    v_mfma_f32_32x32x16_bf16 v[32:47], v[56:59], v[92:95], v[32:47]
    ds_read_b64_tr_b16 v[56:57], v207 offset:27648
    ds_read_b64_tr_b16 v[58:59], v207 offset:28416
    s_add_u32 s31, s37, 45056
    buffer_load_dwordx4 v[148:151], v204, s[12:15], s31 offen offset:0 sc1
    s_waitcnt vmcnt(13)
    s_waitcnt lgkmcnt(4)
    v_mfma_f32_32x32x16_bf16 v[0:15], v[48:51], v[96:99], v[0:15]
    v_mfma_f32_16x16x32_bf16 v[192:195], v[188:191], v[48:51], v[192:195]
    ds_read_b64_tr_b16 v[48:49], v205 offset:30720
    ds_read_b64_tr_b16 v[50:51], v205 offset:31488
    s_waitcnt lgkmcnt(4)
    v_mfma_f32_32x32x16_bf16 v[16:31], v[52:55], v[96:99], v[16:31]
    ds_read_b64_tr_b16 v[52:53], v206 offset:30720
    ds_read_b64_tr_b16 v[54:55], v206 offset:31488
    s_waitcnt lgkmcnt(4)
    v_mfma_f32_32x32x16_bf16 v[32:47], v[56:59], v[96:99], v[32:47]
    ds_read_b64_tr_b16 v[56:57], v207 offset:30720
    ds_read_b64_tr_b16 v[58:59], v207 offset:31488
    s_add_u32 s31, s37, 45056
    buffer_load_dwordx4 v[152:155], v204, s[12:15], s31 offen offset:2048 sc1
    s_waitcnt vmcnt(13)
    s_waitcnt lgkmcnt(4)
    v_mfma_f32_32x32x16_bf16 v[0:15], v[48:51], v[100:103], v[0:15]
    v_mfma_f32_16x16x32_bf16 v[192:195], v[188:191], v[48:51], v[192:195]
    ds_read_b64_tr_b16 v[48:49], v205 offset:33792
    ds_read_b64_tr_b16 v[50:51], v205 offset:34560
    s_waitcnt lgkmcnt(4)
    v_mfma_f32_32x32x16_bf16 v[16:31], v[52:55], v[100:103], v[16:31]
    ds_read_b64_tr_b16 v[52:53], v206 offset:33792
    ds_read_b64_tr_b16 v[54:55], v206 offset:34560
    s_waitcnt lgkmcnt(4)
    v_mfma_f32_32x32x16_bf16 v[32:47], v[56:59], v[100:103], v[32:47]
    ds_read_b64_tr_b16 v[56:57], v207 offset:33792
    ds_read_b64_tr_b16 v[58:59], v207 offset:34560
    s_add_u32 s31, s37, 49152
    buffer_load_dwordx4 v[156:159], v204, s[12:15], s31 offen offset:0 sc1
    s_waitcnt vmcnt(13)
    s_waitcnt lgkmcnt(4)
    v_mfma_f32_32x32x16_bf16 v[0:15], v[48:51], v[104:107], v[0:15]
    v_mfma_f32_16x16x32_bf16 v[192:195], v[188:191], v[48:51], v[192:195]
    ds_read_b64_tr_b16 v[48:49], v205 offset:36864
    ds_read_b64_tr_b16 v[50:51], v205 offset:37632
    s_waitcnt lgkmcnt(4)
    v_mfma_f32_32x32x16_bf16 v[16:31], v[52:55], v[104:107], v[16:31]
    ds_read_b64_tr_b16 v[52:53], v206 offset:36864
    ds_read_b64_tr_b16 v[54:55], v206 offset:37632
    s_waitcnt lgkmcnt(4)
    v_mfma_f32_32x32x16_bf16 v[32:47], v[56:59], v[104:107], v[32:47]
    ds_read_b64_tr_b16 v[56:57], v207 offset:36864
    ds_read_b64_tr_b16 v[58:59], v207 offset:37632
    s_add_u32 s31, s37, 49152
    buffer_load_dwordx4 v[160:163], v204, s[12:15], s31 offen offset:2048 sc1
    s_waitcnt vmcnt(13)
    s_waitcnt lgkmcnt(4)
    v_mfma_f32_32x32x16_bf16 v[0:15], v[48:51], v[108:111], v[0:15]
    v_mfma_f32_16x16x32_bf16 v[192:195], v[188:191], v[48:51], v[192:195]
    ds_read_b64_tr_b16 v[48:49], v205 offset:39936
    ds_read_b64_tr_b16 v[50:51], v205 offset:40704
    s_waitcnt lgkmcnt(4)
    v_mfma_f32_32x32x16_bf16 v[16:31], v[52:55], v[108:111], v[16:31]
    ds_read_b64_tr_b16 v[52:53], v206 offset:39936
    ds_read_b64_tr_b16 v[54:55], v206 offset:40704
    s_waitcnt lgkmcnt(4)
    v_mfma_f32_32x32x16_bf16 v[32:47], v[56:59], v[108:111], v[32:47]
    ds_read_b64_tr_b16 v[56:57], v207 offset:39936
    ds_read_b64_tr_b16 v[58:59], v207 offset:40704
    s_add_u32 s31, s37, 53248
    buffer_load_dwordx4 v[164:167], v204, s[12:15], s31 offen offset:0 sc1
    s_waitcnt vmcnt(13)
    s_waitcnt lgkmcnt(4)
    v_mfma_f32_32x32x16_bf16 v[0:15], v[48:51], v[112:115], v[0:15]
    v_mfma_f32_16x16x32_bf16 v[192:195], v[188:191], v[48:51], v[192:195]
    ds_read_b64_tr_b16 v[48:49], v205 offset:43008
    ds_read_b64_tr_b16 v[50:51], v205 offset:43776
    s_waitcnt lgkmcnt(4)
    v_mfma_f32_32x32x16_bf16 v[16:31], v[52:55], v[112:115], v[16:31]
    ds_read_b64_tr_b16 v[52:53], v206 offset:43008
    ds_read_b64_tr_b16 v[54:55], v206 offset:43776
    s_waitcnt lgkmcnt(4)
    v_mfma_f32_32x32x16_bf16 v[32:47], v[56:59], v[112:115], v[32:47]
    ds_read_b64_tr_b16 v[56:57], v207 offset:43008
    ds_read_b64_tr_b16 v[58:59], v207 offset:43776
    s_add_u32 s31, s37, 53248
    buffer_load_dwordx4 v[168:171], v204, s[12:15], s31 offen offset:2048 sc1
    s_barrier
    s_waitcnt vmcnt(13)
    s_waitcnt lgkmcnt(4)
    v_mfma_f32_32x32x16_bf16 v[0:15], v[48:51], v[116:119], v[0:15]
    v_mfma_f32_16x16x32_bf16 v[192:195], v[188:191], v[48:51], v[192:195]
    ds_read_b64_tr_b16 v[48:49], v205 offset:46080
    ds_read_b64_tr_b16 v[50:51], v205 offset:46848
    s_waitcnt lgkmcnt(4)
    v_mfma_f32_32x32x16_bf16 v[16:31], v[52:55], v[116:119], v[16:31]
    ds_read_b64_tr_b16 v[52:53], v206 offset:46080
    ds_read_b64_tr_b16 v[54:55], v206 offset:46848
    s_waitcnt lgkmcnt(4)
    v_mfma_f32_32x32x16_bf16 v[32:47], v[56:59], v[116:119], v[32:47]
    ds_read_b64_tr_b16 v[56:57], v207 offset:46080
    ds_read_b64_tr_b16 v[58:59], v207 offset:46848
    s_add_u32 s31, s37, 57344
    buffer_load_dwordx4 v[172:175], v204, s[12:15], s31 offen offset:0 sc1
    s_waitcnt vmcnt(13)
    s_waitcnt lgkmcnt(4)
    v_mfma_f32_32x32x16_bf16 v[0:15], v[48:51], v[120:123], v[0:15]
    v_mfma_f32_16x16x32_bf16 v[192:195], v[188:191], v[48:51], v[192:195]
    ds_read_b64_tr_b16 v[48:49], v205 offset:49152
    ds_read_b64_tr_b16 v[50:51], v205 offset:49920
    s_waitcnt lgkmcnt(4)
    v_mfma_f32_32x32x16_bf16 v[16:31], v[52:55], v[120:123], v[16:31]
    ds_read_b64_tr_b16 v[52:53], v206 offset:49152
    ds_read_b64_tr_b16 v[54:55], v206 offset:49920
    s_waitcnt lgkmcnt(4)
    v_mfma_f32_32x32x16_bf16 v[32:47], v[56:59], v[120:123], v[32:47]
    ds_read_b64_tr_b16 v[56:57], v207 offset:49152
    ds_read_b64_tr_b16 v[58:59], v207 offset:49920
    s_add_u32 s31, s37, 57344
    buffer_load_dwordx4 v[176:179], v204, s[12:15], s31 offen offset:2048 sc1
    s_waitcnt vmcnt(13)
    s_waitcnt lgkmcnt(4)
    v_mfma_f32_32x32x16_bf16 v[0:15], v[48:51], v[124:127], v[0:15]
    v_mfma_f32_16x16x32_bf16 v[192:195], v[188:191], v[48:51], v[192:195]
    ds_read_b64_tr_b16 v[48:49], v205 offset:52224
    ds_read_b64_tr_b16 v[50:51], v205 offset:52992
    s_waitcnt lgkmcnt(4)
    v_mfma_f32_32x32x16_bf16 v[16:31], v[52:55], v[124:127], v[16:31]
    ds_read_b64_tr_b16 v[52:53], v206 offset:52224
    ds_read_b64_tr_b16 v[54:55], v206 offset:52992
    s_waitcnt lgkmcnt(4)
    v_mfma_f32_32x32x16_bf16 v[32:47], v[56:59], v[124:127], v[32:47]
    ds_read_b64_tr_b16 v[56:57], v207 offset:52224
    ds_read_b64_tr_b16 v[58:59], v207 offset:52992
    s_add_u32 s31, s37, 61440
    buffer_load_dwordx4 v[180:183], v204, s[12:15], s31 offen offset:0 sc1
    s_waitcnt vmcnt(13)
    s_waitcnt lgkmcnt(4)
    v_mfma_f32_32x32x16_bf16 v[0:15], v[48:51], v[128:131], v[0:15]
    v_mfma_f32_16x16x32_bf16 v[192:195], v[188:191], v[48:51], v[192:195]
    ds_read_b64_tr_b16 v[48:49], v205 offset:55296
    ds_read_b64_tr_b16 v[50:51], v205 offset:56064
    s_waitcnt lgkmcnt(4)
    v_mfma_f32_32x32x16_bf16 v[16:31], v[52:55], v[128:131], v[16:31]
    ds_read_b64_tr_b16 v[52:53], v206 offset:55296
    ds_read_b64_tr_b16 v[54:55], v206 offset:56064
    s_waitcnt lgkmcnt(4)
    v_mfma_f32_32x32x16_bf16 v[32:47], v[56:59], v[128:131], v[32:47]
    ds_read_b64_tr_b16 v[56:57], v207 offset:55296
    ds_read_b64_tr_b16 v[58:59], v207 offset:56064
    s_add_u32 s31, s37, 61440
    buffer_load_dwordx4 v[184:187], v204, s[12:15], s31 offen offset:2048 sc1
    s_waitcnt vmcnt(13)
    s_waitcnt lgkmcnt(4)
    v_mfma_f32_32x32x16_bf16 v[0:15], v[48:51], v[132:135], v[0:15]
    v_mfma_f32_16x16x32_bf16 v[192:195], v[188:191], v[48:51], v[192:195]
    ds_read_b64_tr_b16 v[48:49], v205 offset:58368
    ds_read_b64_tr_b16 v[50:51], v205 offset:59136
    s_waitcnt lgkmcnt(4)
    v_mfma_f32_32x32x16_bf16 v[16:31], v[52:55], v[132:135], v[16:31]
    ds_read_b64_tr_b16 v[52:53], v206 offset:58368
    ds_read_b64_tr_b16 v[54:55], v206 offset:59136
    s_waitcnt lgkmcnt(4)
    v_mfma_f32_32x32x16_bf16 v[32:47], v[56:59], v[132:135], v[32:47]
    ds_read_b64_tr_b16 v[56:57], v207 offset:58368
    ds_read_b64_tr_b16 v[58:59], v207 offset:59136
    s_add_u32 s31, s37, 65536
    buffer_load_dwordx4 v[60:63], v204, s[12:15], s31 offen offset:0 sc1
    v_add_u32 v205, 61440, v205
    v_add_u32 v206, 61440, v206
    v_add_u32 v207, 61440, v207
    s_waitcnt vmcnt(13)
    s_waitcnt lgkmcnt(4)
    v_mfma_f32_32x32x16_bf16 v[0:15], v[48:51], v[136:139], v[0:15]
    v_mfma_f32_16x16x32_bf16 v[192:195], v[188:191], v[48:51], v[192:195]
    ds_read_b64_tr_b16 v[48:49], v205 offset:0
    ds_read_b64_tr_b16 v[50:51], v205 offset:768
    s_waitcnt lgkmcnt(4)
    v_mfma_f32_32x32x16_bf16 v[16:31], v[52:55], v[136:139], v[16:31]
    ds_read_b64_tr_b16 v[52:53], v206 offset:0
    ds_read_b64_tr_b16 v[54:55], v206 offset:768
    s_waitcnt lgkmcnt(4)
    v_mfma_f32_32x32x16_bf16 v[32:47], v[56:59], v[136:139], v[32:47]
    ds_read_b64_tr_b16 v[56:57], v207 offset:0
    ds_read_b64_tr_b16 v[58:59], v207 offset:768
    s_add_u32 s31, s37, 65536
    buffer_load_dwordx4 v[64:67], v204, s[12:15], s31 offen offset:2048 sc1
    s_barrier
    s_waitcnt vmcnt(13)
    s_waitcnt lgkmcnt(4)
    v_mfma_f32_32x32x16_bf16 v[0:15], v[48:51], v[140:143], v[0:15]
    v_mfma_f32_16x16x32_bf16 v[192:195], v[188:191], v[48:51], v[192:195]
    ds_read_b64_tr_b16 v[48:49], v205 offset:3072
    ds_read_b64_tr_b16 v[50:51], v205 offset:3840
    s_waitcnt lgkmcnt(4)
    v_mfma_f32_32x32x16_bf16 v[16:31], v[52:55], v[140:143], v[16:31]
    ds_read_b64_tr_b16 v[52:53], v206 offset:3072
    ds_read_b64_tr_b16 v[54:55], v206 offset:3840
    s_waitcnt lgkmcnt(4)
    v_mfma_f32_32x32x16_bf16 v[32:47], v[56:59], v[140:143], v[32:47]
    ds_read_b64_tr_b16 v[56:57], v207 offset:3072
    ds_read_b64_tr_b16 v[58:59], v207 offset:3840
    s_add_u32 s31, s37, 69632
    buffer_load_dwordx4 v[68:71], v204, s[12:15], s31 offen offset:0 sc1
    s_waitcnt vmcnt(13)
    s_waitcnt lgkmcnt(4)
    v_mfma_f32_32x32x16_bf16 v[0:15], v[48:51], v[144:147], v[0:15]
    v_mfma_f32_16x16x32_bf16 v[192:195], v[188:191], v[48:51], v[192:195]
    ds_read_b64_tr_b16 v[48:49], v205 offset:6144
    ds_read_b64_tr_b16 v[50:51], v205 offset:6912
    s_waitcnt lgkmcnt(4)
    v_mfma_f32_32x32x16_bf16 v[16:31], v[52:55], v[144:147], v[16:31]
    ds_read_b64_tr_b16 v[52:53], v206 offset:6144
    ds_read_b64_tr_b16 v[54:55], v206 offset:6912
    s_waitcnt lgkmcnt(4)
    v_mfma_f32_32x32x16_bf16 v[32:47], v[56:59], v[144:147], v[32:47]
    ds_read_b64_tr_b16 v[56:57], v207 offset:6144
    ds_read_b64_tr_b16 v[58:59], v207 offset:6912
    s_add_u32 s31, s37, 69632
    buffer_load_dwordx4 v[72:75], v204, s[12:15], s31 offen offset:2048 sc1
    s_waitcnt vmcnt(13)
    s_waitcnt lgkmcnt(4)
    v_mfma_f32_32x32x16_bf16 v[0:15], v[48:51], v[148:151], v[0:15]
    v_mfma_f32_16x16x32_bf16 v[192:195], v[188:191], v[48:51], v[192:195]
    ds_read_b64_tr_b16 v[48:49], v205 offset:9216
    ds_read_b64_tr_b16 v[50:51], v205 offset:9984
    s_waitcnt lgkmcnt(4)
    v_mfma_f32_32x32x16_bf16 v[16:31], v[52:55], v[148:151], v[16:31]
    ds_read_b64_tr_b16 v[52:53], v206 offset:9216
    ds_read_b64_tr_b16 v[54:55], v206 offset:9984
    s_waitcnt lgkmcnt(4)
    v_mfma_f32_32x32x16_bf16 v[32:47], v[56:59], v[148:151], v[32:47]
    ds_read_b64_tr_b16 v[56:57], v207 offset:9216
    ds_read_b64_tr_b16 v[58:59], v207 offset:9984
    s_add_u32 s31, s37, 73728
    buffer_load_dwordx4 v[76:79], v204, s[12:15], s31 offen offset:0 sc1
    s_waitcnt vmcnt(13)
    s_waitcnt lgkmcnt(4)
    v_mfma_f32_32x32x16_bf16 v[0:15], v[48:51], v[152:155], v[0:15]
    v_mfma_f32_16x16x32_bf16 v[192:195], v[188:191], v[48:51], v[192:195]
    ds_read_b64_tr_b16 v[48:49], v205 offset:12288
    ds_read_b64_tr_b16 v[50:51], v205 offset:13056
    s_waitcnt lgkmcnt(4)
    v_mfma_f32_32x32x16_bf16 v[16:31], v[52:55], v[152:155], v[16:31]
    ds_read_b64_tr_b16 v[52:53], v206 offset:12288
    ds_read_b64_tr_b16 v[54:55], v206 offset:13056
    s_waitcnt lgkmcnt(4)
    v_mfma_f32_32x32x16_bf16 v[32:47], v[56:59], v[152:155], v[32:47]
    ds_read_b64_tr_b16 v[56:57], v207 offset:12288
    ds_read_b64_tr_b16 v[58:59], v207 offset:13056
    s_add_u32 s31, s37, 73728
    buffer_load_dwordx4 v[80:83], v204, s[12:15], s31 offen offset:2048 sc1
    s_waitcnt vmcnt(13)
    s_waitcnt lgkmcnt(4)
    v_mfma_f32_32x32x16_bf16 v[0:15], v[48:51], v[156:159], v[0:15]
    v_mfma_f32_16x16x32_bf16 v[192:195], v[188:191], v[48:51], v[192:195]
    ds_read_b64_tr_b16 v[48:49], v205 offset:15360
    ds_read_b64_tr_b16 v[50:51], v205 offset:16128
    s_waitcnt lgkmcnt(4)
    v_mfma_f32_32x32x16_bf16 v[16:31], v[52:55], v[156:159], v[16:31]
    ds_read_b64_tr_b16 v[52:53], v206 offset:15360
    ds_read_b64_tr_b16 v[54:55], v206 offset:16128
    s_waitcnt lgkmcnt(4)
    v_mfma_f32_32x32x16_bf16 v[32:47], v[56:59], v[156:159], v[32:47]
    ds_read_b64_tr_b16 v[56:57], v207 offset:15360
    ds_read_b64_tr_b16 v[58:59], v207 offset:16128
    s_add_u32 s31, s37, 77824
    buffer_load_dwordx4 v[84:87], v204, s[12:15], s31 offen offset:0 sc1
    s_waitcnt vmcnt(13)
    s_waitcnt lgkmcnt(4)
    v_mfma_f32_32x32x16_bf16 v[0:15], v[48:51], v[160:163], v[0:15]
    v_mfma_f32_16x16x32_bf16 v[192:195], v[188:191], v[48:51], v[192:195]
    ds_read_b64_tr_b16 v[48:49], v205 offset:18432
    ds_read_b64_tr_b16 v[50:51], v205 offset:19200
    s_waitcnt lgkmcnt(4)
    v_mfma_f32_32x32x16_bf16 v[16:31], v[52:55], v[160:163], v[16:31]
    ds_read_b64_tr_b16 v[52:53], v206 offset:18432
    ds_read_b64_tr_b16 v[54:55], v206 offset:19200
    s_waitcnt lgkmcnt(4)
    v_mfma_f32_32x32x16_bf16 v[32:47], v[56:59], v[160:163], v[32:47]
    ds_read_b64_tr_b16 v[56:57], v207 offset:18432
    ds_read_b64_tr_b16 v[58:59], v207 offset:19200
    s_add_u32 s31, s37, 77824
    buffer_load_dwordx4 v[88:91], v204, s[12:15], s31 offen offset:2048 sc1
    s_waitcnt vmcnt(13)
    s_waitcnt lgkmcnt(4)
    v_mfma_f32_32x32x16_bf16 v[0:15], v[48:51], v[164:167], v[0:15]
    v_mfma_f32_16x16x32_bf16 v[192:195], v[188:191], v[48:51], v[192:195]
    ds_read_b64_tr_b16 v[48:49], v205 offset:21504
    ds_read_b64_tr_b16 v[50:51], v205 offset:22272
    s_waitcnt lgkmcnt(4)
    v_mfma_f32_32x32x16_bf16 v[16:31], v[52:55], v[164:167], v[16:31]
    ds_read_b64_tr_b16 v[52:53], v206 offset:21504
    ds_read_b64_tr_b16 v[54:55], v206 offset:22272
    s_waitcnt lgkmcnt(4)
    v_mfma_f32_32x32x16_bf16 v[32:47], v[56:59], v[164:167], v[32:47]
    ds_read_b64_tr_b16 v[56:57], v207 offset:21504
    ds_read_b64_tr_b16 v[58:59], v207 offset:22272
    s_barrier
    s_waitcnt vmcnt(12)
    s_waitcnt lgkmcnt(4)
    v_mfma_f32_32x32x16_bf16 v[0:15], v[48:51], v[168:171], v[0:15]
    v_mfma_f32_16x16x32_bf16 v[192:195], v[188:191], v[48:51], v[192:195]
    ds_read_b64_tr_b16 v[48:49], v205 offset:24576
    ds_read_b64_tr_b16 v[50:51], v205 offset:25344
    s_waitcnt lgkmcnt(4)
    v_mfma_f32_32x32x16_bf16 v[16:31], v[52:55], v[168:171], v[16:31]
    ds_read_b64_tr_b16 v[52:53], v206 offset:24576
    ds_read_b64_tr_b16 v[54:55], v206 offset:25344
    s_waitcnt lgkmcnt(4)
    v_mfma_f32_32x32x16_bf16 v[32:47], v[56:59], v[168:171], v[32:47]
    ds_read_b64_tr_b16 v[56:57], v207 offset:24576
    ds_read_b64_tr_b16 v[58:59], v207 offset:25344
    s_waitcnt vmcnt(11)
    s_waitcnt lgkmcnt(4)
    v_mfma_f32_32x32x16_bf16 v[0:15], v[48:51], v[172:175], v[0:15]
    v_mfma_f32_16x16x32_bf16 v[192:195], v[188:191], v[48:51], v[192:195]
    ds_read_b64_tr_b16 v[48:49], v205 offset:27648
    ds_read_b64_tr_b16 v[50:51], v205 offset:28416
    s_waitcnt lgkmcnt(4)
    v_mfma_f32_32x32x16_bf16 v[16:31], v[52:55], v[172:175], v[16:31]
    ds_read_b64_tr_b16 v[52:53], v206 offset:27648
    ds_read_b64_tr_b16 v[54:55], v206 offset:28416
    s_waitcnt lgkmcnt(4)
    v_mfma_f32_32x32x16_bf16 v[32:47], v[56:59], v[172:175], v[32:47]
    ds_read_b64_tr_b16 v[56:57], v207 offset:27648
    ds_read_b64_tr_b16 v[58:59], v207 offset:28416
    s_waitcnt vmcnt(10)
    s_waitcnt lgkmcnt(4)
    v_mfma_f32_32x32x16_bf16 v[0:15], v[48:51], v[176:179], v[0:15]
    v_mfma_f32_16x16x32_bf16 v[192:195], v[188:191], v[48:51], v[192:195]
    ds_read_b64_tr_b16 v[48:49], v205 offset:30720
    ds_read_b64_tr_b16 v[50:51], v205 offset:31488
    s_waitcnt lgkmcnt(4)
    v_mfma_f32_32x32x16_bf16 v[16:31], v[52:55], v[176:179], v[16:31]
    ds_read_b64_tr_b16 v[52:53], v206 offset:30720
    ds_read_b64_tr_b16 v[54:55], v206 offset:31488
    s_waitcnt lgkmcnt(4)
    v_mfma_f32_32x32x16_bf16 v[32:47], v[56:59], v[176:179], v[32:47]
    ds_read_b64_tr_b16 v[56:57], v207 offset:30720
    ds_read_b64_tr_b16 v[58:59], v207 offset:31488
    s_waitcnt vmcnt(9)
    s_waitcnt lgkmcnt(4)
    v_mfma_f32_32x32x16_bf16 v[0:15], v[48:51], v[180:183], v[0:15]
    v_mfma_f32_16x16x32_bf16 v[192:195], v[188:191], v[48:51], v[192:195]
    ds_read_b64_tr_b16 v[48:49], v205 offset:33792
    ds_read_b64_tr_b16 v[50:51], v205 offset:34560
    s_waitcnt lgkmcnt(4)
    v_mfma_f32_32x32x16_bf16 v[16:31], v[52:55], v[180:183], v[16:31]
    ds_read_b64_tr_b16 v[52:53], v206 offset:33792
    ds_read_b64_tr_b16 v[54:55], v206 offset:34560
    s_waitcnt lgkmcnt(4)
    v_mfma_f32_32x32x16_bf16 v[32:47], v[56:59], v[180:183], v[32:47]
    ds_read_b64_tr_b16 v[56:57], v207 offset:33792
    ds_read_b64_tr_b16 v[58:59], v207 offset:34560
    s_waitcnt vmcnt(8)
    s_waitcnt lgkmcnt(4)
    v_mfma_f32_32x32x16_bf16 v[0:15], v[48:51], v[184:187], v[0:15]
    v_mfma_f32_16x16x32_bf16 v[192:195], v[188:191], v[48:51], v[192:195]
    ds_read_b64_tr_b16 v[48:49], v205 offset:36864
    ds_read_b64_tr_b16 v[50:51], v205 offset:37632
    s_waitcnt lgkmcnt(4)
    v_mfma_f32_32x32x16_bf16 v[16:31], v[52:55], v[184:187], v[16:31]
    ds_read_b64_tr_b16 v[52:53], v206 offset:36864
    ds_read_b64_tr_b16 v[54:55], v206 offset:37632
    s_waitcnt lgkmcnt(4)
    v_mfma_f32_32x32x16_bf16 v[32:47], v[56:59], v[184:187], v[32:47]
    ds_read_b64_tr_b16 v[56:57], v207 offset:36864
    ds_read_b64_tr_b16 v[58:59], v207 offset:37632
    s_waitcnt vmcnt(7)
    s_waitcnt lgkmcnt(4)
    v_mfma_f32_32x32x16_bf16 v[0:15], v[48:51], v[60:63], v[0:15]
    v_mfma_f32_16x16x32_bf16 v[192:195], v[188:191], v[48:51], v[192:195]
    ds_read_b64_tr_b16 v[48:49], v205 offset:39936
    ds_read_b64_tr_b16 v[50:51], v205 offset:40704
    s_waitcnt lgkmcnt(4)
    v_mfma_f32_32x32x16_bf16 v[16:31], v[52:55], v[60:63], v[16:31]
    ds_read_b64_tr_b16 v[52:53], v206 offset:39936
    ds_read_b64_tr_b16 v[54:55], v206 offset:40704
    s_waitcnt lgkmcnt(4)
    v_mfma_f32_32x32x16_bf16 v[32:47], v[56:59], v[60:63], v[32:47]
    ds_read_b64_tr_b16 v[56:57], v207 offset:39936
    ds_read_b64_tr_b16 v[58:59], v207 offset:40704
    s_waitcnt vmcnt(6)
    s_waitcnt lgkmcnt(4)
    v_mfma_f32_32x32x16_bf16 v[0:15], v[48:51], v[64:67], v[0:15]
    v_mfma_f32_16x16x32_bf16 v[192:195], v[188:191], v[48:51], v[192:195]
    ds_read_b64_tr_b16 v[48:49], v205 offset:43008
    ds_read_b64_tr_b16 v[50:51], v205 offset:43776
    s_waitcnt lgkmcnt(4)
    v_mfma_f32_32x32x16_bf16 v[16:31], v[52:55], v[64:67], v[16:31]
    ds_read_b64_tr_b16 v[52:53], v206 offset:43008
    ds_read_b64_tr_b16 v[54:55], v206 offset:43776
    s_waitcnt lgkmcnt(4)
    v_mfma_f32_32x32x16_bf16 v[32:47], v[56:59], v[64:67], v[32:47]
    ds_read_b64_tr_b16 v[56:57], v207 offset:43008
    ds_read_b64_tr_b16 v[58:59], v207 offset:43776
    s_barrier
    s_waitcnt vmcnt(5)
    s_waitcnt lgkmcnt(4)
    v_mfma_f32_32x32x16_bf16 v[0:15], v[48:51], v[68:71], v[0:15]
    v_mfma_f32_16x16x32_bf16 v[192:195], v[188:191], v[48:51], v[192:195]
    ds_read_b64_tr_b16 v[48:49], v205 offset:46080
    ds_read_b64_tr_b16 v[50:51], v205 offset:46848
    s_waitcnt lgkmcnt(4)
    v_mfma_f32_32x32x16_bf16 v[16:31], v[52:55], v[68:71], v[16:31]
    ds_read_b64_tr_b16 v[52:53], v206 offset:46080
    ds_read_b64_tr_b16 v[54:55], v206 offset:46848
    s_waitcnt lgkmcnt(4)
    v_mfma_f32_32x32x16_bf16 v[32:47], v[56:59], v[68:71], v[32:47]
    ds_read_b64_tr_b16 v[56:57], v207 offset:46080
    ds_read_b64_tr_b16 v[58:59], v207 offset:46848
    s_waitcnt vmcnt(4)
    s_waitcnt lgkmcnt(4)
    v_mfma_f32_32x32x16_bf16 v[0:15], v[48:51], v[72:75], v[0:15]
    v_mfma_f32_16x16x32_bf16 v[192:195], v[188:191], v[48:51], v[192:195]
    ds_read_b64_tr_b16 v[48:49], v205 offset:49152
    ds_read_b64_tr_b16 v[50:51], v205 offset:49920
    s_waitcnt lgkmcnt(4)
    v_mfma_f32_32x32x16_bf16 v[16:31], v[52:55], v[72:75], v[16:31]
    ds_read_b64_tr_b16 v[52:53], v206 offset:49152
    ds_read_b64_tr_b16 v[54:55], v206 offset:49920
    s_waitcnt lgkmcnt(4)
    v_mfma_f32_32x32x16_bf16 v[32:47], v[56:59], v[72:75], v[32:47]
    ds_read_b64_tr_b16 v[56:57], v207 offset:49152
    ds_read_b64_tr_b16 v[58:59], v207 offset:49920
    s_waitcnt vmcnt(3)
    s_waitcnt lgkmcnt(4)
    v_mfma_f32_32x32x16_bf16 v[0:15], v[48:51], v[76:79], v[0:15]
    v_mfma_f32_16x16x32_bf16 v[192:195], v[188:191], v[48:51], v[192:195]
    ds_read_b64_tr_b16 v[48:49], v205 offset:52224
    ds_read_b64_tr_b16 v[50:51], v205 offset:52992
    s_waitcnt lgkmcnt(4)
    v_mfma_f32_32x32x16_bf16 v[16:31], v[52:55], v[76:79], v[16:31]
    ds_read_b64_tr_b16 v[52:53], v206 offset:52224
    ds_read_b64_tr_b16 v[54:55], v206 offset:52992
    s_waitcnt lgkmcnt(4)
    v_mfma_f32_32x32x16_bf16 v[32:47], v[56:59], v[76:79], v[32:47]
    ds_read_b64_tr_b16 v[56:57], v207 offset:52224
    ds_read_b64_tr_b16 v[58:59], v207 offset:52992
    s_waitcnt vmcnt(2)
    s_waitcnt lgkmcnt(4)
    v_mfma_f32_32x32x16_bf16 v[0:15], v[48:51], v[80:83], v[0:15]
    v_mfma_f32_16x16x32_bf16 v[192:195], v[188:191], v[48:51], v[192:195]
    ds_read_b64_tr_b16 v[48:49], v205 offset:55296
    ds_read_b64_tr_b16 v[50:51], v205 offset:56064
    s_waitcnt lgkmcnt(4)
    v_mfma_f32_32x32x16_bf16 v[16:31], v[52:55], v[80:83], v[16:31]
    ds_read_b64_tr_b16 v[52:53], v206 offset:55296
    ds_read_b64_tr_b16 v[54:55], v206 offset:56064
    s_waitcnt lgkmcnt(4)
    v_mfma_f32_32x32x16_bf16 v[32:47], v[56:59], v[80:83], v[32:47]
    ds_read_b64_tr_b16 v[56:57], v207 offset:55296
    ds_read_b64_tr_b16 v[58:59], v207 offset:56064
    s_waitcnt vmcnt(1)
    s_waitcnt lgkmcnt(4)
    v_mfma_f32_32x32x16_bf16 v[0:15], v[48:51], v[84:87], v[0:15]
    v_mfma_f32_16x16x32_bf16 v[192:195], v[188:191], v[48:51], v[192:195]
    ds_read_b64_tr_b16 v[48:49], v205 offset:58368
    ds_read_b64_tr_b16 v[50:51], v205 offset:59136
    s_waitcnt lgkmcnt(4)
    v_mfma_f32_32x32x16_bf16 v[16:31], v[52:55], v[84:87], v[16:31]
    ds_read_b64_tr_b16 v[52:53], v206 offset:58368
    ds_read_b64_tr_b16 v[54:55], v206 offset:59136
    s_waitcnt lgkmcnt(4)
    v_mfma_f32_32x32x16_bf16 v[32:47], v[56:59], v[84:87], v[32:47]
    ds_read_b64_tr_b16 v[56:57], v207 offset:58368
    ds_read_b64_tr_b16 v[58:59], v207 offset:59136
    s_waitcnt vmcnt(0)
    s_waitcnt lgkmcnt(4)
    v_mfma_f32_32x32x16_bf16 v[0:15], v[48:51], v[88:91], v[0:15]
    v_mfma_f32_16x16x32_bf16 v[192:195], v[188:191], v[48:51], v[192:195]
    s_waitcnt lgkmcnt(2)
    v_mfma_f32_32x32x16_bf16 v[16:31], v[52:55], v[88:91], v[16:31]
    s_waitcnt lgkmcnt(0)
    v_mfma_f32_32x32x16_bf16 v[32:47], v[56:59], v[88:91], v[32:47]
    s_waitcnt vmcnt(0)
    v_add_f32 v208, v196, v198
    v_add_f32 v210, v197, v199
    v_add_f32 v209, v200, v202
    v_add_f32 v211, v201, v203
    v_add_f32 v208, v208, v209
    v_add_f32 v210, v210, v211
    v_mov_b32 v209, v208
    v_mov_b32 v211, v210
    s_lshl_b32 s30, s52, 7
    s_add_u32 s30, s30, 143360
    v_lshl_add_u32 v216, v245, 2, s30
    v_permlane32_swap_b32 v208, v209
    v_permlane32_swap_b32 v210, v211
    s_mov_b64 exec, 0xffff
    ds_write_b32 v216, v192
    ds_write_b32 v216, v193 offset:64
    s_mov_b64 exec, -1
    v_add_f32 v208, v208, v209
    v_add_f32 v210, v210, v211
    v_mul_f32 v208, 0x3acccccd, v208
    v_mul_f32 v210, 0x3acccccd, v210
    v_fma_f32 v210, -v208, v208, v210
    v_max_f32 v210, 0, v210
    v_add_f32 v210, 0x3727c5ac, v210
    v_rsq_f32 v210, v210
    s_nop 0
    v_mul_f32 v212, 0x3fb8aa3b, v210
    s_waitcnt lgkmcnt(0)
    s_barrier
    v_lshlrev_b32 v216, 4, v215
    v_add_u32 v216, 143360, v216
    s_lshl_b32 s30, s52, 7
    v_add_u32 v217, s30, v216
    ds_read_b128 v[60:63], v217 offset:0
    ds_read_b128 v[64:67], v217 offset:32
    ds_read_b128 v[68:71], v217 offset:64
    ds_read_b128 v[72:75], v217 offset:96
    s_lshl_b32 s30, s53, 7
    v_add_u32 v217, s30, v216
    ds_read_b128 v[76:79], v217 offset:0
    ds_read_b128 v[80:83], v217 offset:32
    ds_read_b128 v[84:87], v217 offset:64
    ds_read_b128 v[88:91], v217 offset:96
    s_lshl_b32 s30, s54, 7
    v_add_u32 v217, s30, v216
    ds_read_b128 v[92:95], v217 offset:0
    ds_read_b128 v[96:99], v217 offset:32
    ds_read_b128 v[100:103], v217 offset:64
    ds_read_b128 v[104:107], v217 offset:96
    v_mov_b32 v232, 0x3fb8aa3b
    v_mov_b32 v233, 0x3fb8aa3b
    s_waitcnt lgkmcnt(11)
    v_pk_fma_f32 v[0:1], v[208:209], v[60:61], v[0:1] op_sel_hi:[0,1,1] neg_lo:[1,0,0] neg_hi:[1,0,0]
    v_pk_fma_f32 v[2:3], v[208:209], v[62:63], v[2:3] op_sel_hi:[0,1,1] neg_lo:[1,0,0] neg_hi:[1,0,0]
    v_pk_mul_f32 v[0:1], v[212:213], v[0:1] op_sel_hi:[0,1]
    v_pk_mul_f32 v[2:3], v[212:213], v[2:3] op_sel_hi:[0,1]
    v_exp_f32 v220, -v0
    v_exp_f32 v221, -v1
    v_exp_f32 v222, -v2
    v_exp_f32 v223, -v3
    s_nop 0
    v_pk_fma_f32 v[220:221], v[220:221], v[232:233], v[232:233]
    v_pk_fma_f32 v[222:223], v[222:223], v[232:233], v[232:233]
    v_rcp_f32 v220, v220
    v_rcp_f32 v221, v221
    v_rcp_f32 v222, v222
    v_rcp_f32 v223, v223
    s_nop 0
    v_pk_mul_f32 v[0:1], v[0:1], v[220:221]
    v_pk_mul_f32 v[2:3], v[2:3], v[222:223]
    v_cvt_pk_bf16_f32 v224, v0, v1
    v_cvt_pk_bf16_f32 v225, v2, v3
    s_waitcnt lgkmcnt(10)
    v_pk_fma_f32 v[4:5], v[208:209], v[64:65], v[4:5] op_sel_hi:[0,1,1] neg_lo:[1,0,0] neg_hi:[1,0,0]
    v_pk_fma_f32 v[6:7], v[208:209], v[66:67], v[6:7] op_sel_hi:[0,1,1] neg_lo:[1,0,0] neg_hi:[1,0,0]
    v_pk_mul_f32 v[4:5], v[212:213], v[4:5] op_sel_hi:[0,1]
    v_pk_mul_f32 v[6:7], v[212:213], v[6:7] op_sel_hi:[0,1]
    v_exp_f32 v220, -v4
    v_exp_f32 v221, -v5
    v_exp_f32 v222, -v6
    v_exp_f32 v223, -v7
    s_nop 0
    v_pk_fma_f32 v[220:221], v[220:221], v[232:233], v[232:233]
    v_pk_fma_f32 v[222:223], v[222:223], v[232:233], v[232:233]
    v_rcp_f32 v220, v220
    v_rcp_f32 v221, v221
    v_rcp_f32 v222, v222
    v_rcp_f32 v223, v223
    s_nop 0
    v_pk_mul_f32 v[4:5], v[4:5], v[220:221]
    v_pk_mul_f32 v[6:7], v[6:7], v[222:223]
    v_cvt_pk_bf16_f32 v226, v4, v5
    v_cvt_pk_bf16_f32 v227, v6, v7
    s_mul_i32 s30, s25, 12
    s_lshl_b32 s31, s52, 2
    s_add_u32 s30, s30, s31
    s_add_u32 s30, s30, 0
    s_lshl_b32 s30, s30, 10
    s_add_u32 s30, s30, s50
    buffer_store_dwordx4 v[224:227], v204, s[40:43], s30 offen sc1
    s_waitcnt lgkmcnt(9)
    v_pk_fma_f32 v[8:9], v[208:209], v[68:69], v[8:9] op_sel_hi:[0,1,1] neg_lo:[1,0,0] neg_hi:[1,0,0]
    v_pk_fma_f32 v[10:11], v[208:209], v[70:71], v[10:11] op_sel_hi:[0,1,1] neg_lo:[1,0,0] neg_hi:[1,0,0]
    v_pk_mul_f32 v[8:9], v[212:213], v[8:9] op_sel_hi:[0,1]
    v_pk_mul_f32 v[10:11], v[212:213], v[10:11] op_sel_hi:[0,1]
    v_exp_f32 v220, -v8
    v_exp_f32 v221, -v9
    v_exp_f32 v222, -v10
    v_exp_f32 v223, -v11
    s_nop 0
    v_pk_fma_f32 v[220:221], v[220:221], v[232:233], v[232:233]
    v_pk_fma_f32 v[222:223], v[222:223], v[232:233], v[232:233]
    v_rcp_f32 v220, v220
    v_rcp_f32 v221, v221
    v_rcp_f32 v222, v222
    v_rcp_f32 v223, v223
    s_nop 0
    v_pk_mul_f32 v[8:9], v[8:9], v[220:221]
    v_pk_mul_f32 v[10:11], v[10:11], v[222:223]
    v_cvt_pk_bf16_f32 v228, v8, v9
    v_cvt_pk_bf16_f32 v229, v10, v11
    s_waitcnt lgkmcnt(8)
    v_pk_fma_f32 v[12:13], v[208:209], v[72:73], v[12:13] op_sel_hi:[0,1,1] neg_lo:[1,0,0] neg_hi:[1,0,0]
    v_pk_fma_f32 v[14:15], v[208:209], v[74:75], v[14:15] op_sel_hi:[0,1,1] neg_lo:[1,0,0] neg_hi:[1,0,0]
    v_pk_mul_f32 v[12:13], v[212:213], v[12:13] op_sel_hi:[0,1]
    v_pk_mul_f32 v[14:15], v[212:213], v[14:15] op_sel_hi:[0,1]
    v_exp_f32 v220, -v12
    v_exp_f32 v221, -v13
    v_exp_f32 v222, -v14
    v_exp_f32 v223, -v15
    s_nop 0
    v_pk_fma_f32 v[220:221], v[220:221], v[232:233], v[232:233]
    v_pk_fma_f32 v[222:223], v[222:223], v[232:233], v[232:233]
    v_rcp_f32 v220, v220
    v_rcp_f32 v221, v221
    v_rcp_f32 v222, v222
    v_rcp_f32 v223, v223
    s_nop 0
    v_pk_mul_f32 v[12:13], v[12:13], v[220:221]
    v_pk_mul_f32 v[14:15], v[14:15], v[222:223]
    v_cvt_pk_bf16_f32 v230, v12, v13
    v_cvt_pk_bf16_f32 v231, v14, v15
    s_mul_i32 s30, s25, 12
    s_lshl_b32 s31, s52, 2
    s_add_u32 s30, s30, s31
    s_add_u32 s30, s30, 2
    s_lshl_b32 s30, s30, 10
    s_add_u32 s30, s30, s50
    buffer_store_dwordx4 v[228:231], v204, s[40:43], s30 offen sc1
    s_waitcnt lgkmcnt(7)
    v_pk_fma_f32 v[16:17], v[208:209], v[76:77], v[16:17] op_sel_hi:[0,1,1] neg_lo:[1,0,0] neg_hi:[1,0,0]
    v_pk_fma_f32 v[18:19], v[208:209], v[78:79], v[18:19] op_sel_hi:[0,1,1] neg_lo:[1,0,0] neg_hi:[1,0,0]
    v_pk_mul_f32 v[16:17], v[212:213], v[16:17] op_sel_hi:[0,1]
    v_pk_mul_f32 v[18:19], v[212:213], v[18:19] op_sel_hi:[0,1]
    v_exp_f32 v220, -v16
    v_exp_f32 v221, -v17
    v_exp_f32 v222, -v18
    v_exp_f32 v223, -v19
    s_nop 0
    v_pk_fma_f32 v[220:221], v[220:221], v[232:233], v[232:233]
    v_pk_fma_f32 v[222:223], v[222:223], v[232:233], v[232:233]
    v_rcp_f32 v220, v220
    v_rcp_f32 v221, v221
    v_rcp_f32 v222, v222
    v_rcp_f32 v223, v223
    s_nop 0
    v_pk_mul_f32 v[16:17], v[16:17], v[220:221]
    v_pk_mul_f32 v[18:19], v[18:19], v[222:223]
    v_cvt_pk_bf16_f32 v224, v16, v17
    v_cvt_pk_bf16_f32 v225, v18, v19
    s_waitcnt lgkmcnt(6)
    v_pk_fma_f32 v[20:21], v[208:209], v[80:81], v[20:21] op_sel_hi:[0,1,1] neg_lo:[1,0,0] neg_hi:[1,0,0]
    v_pk_fma_f32 v[22:23], v[208:209], v[82:83], v[22:23] op_sel_hi:[0,1,1] neg_lo:[1,0,0] neg_hi:[1,0,0]
    v_pk_mul_f32 v[20:21], v[212:213], v[20:21] op_sel_hi:[0,1]
    v_pk_mul_f32 v[22:23], v[212:213], v[22:23] op_sel_hi:[0,1]
    v_exp_f32 v220, -v20
    v_exp_f32 v221, -v21
    v_exp_f32 v222, -v22
    v_exp_f32 v223, -v23
    s_nop 0
    v_pk_fma_f32 v[220:221], v[220:221], v[232:233], v[232:233]
    v_pk_fma_f32 v[222:223], v[222:223], v[232:233], v[232:233]
    v_rcp_f32 v220, v220
    v_rcp_f32 v221, v221
    v_rcp_f32 v222, v222
    v_rcp_f32 v223, v223
    s_nop 0
    v_pk_mul_f32 v[20:21], v[20:21], v[220:221]
    v_pk_mul_f32 v[22:23], v[22:23], v[222:223]
    v_cvt_pk_bf16_f32 v226, v20, v21
    v_cvt_pk_bf16_f32 v227, v22, v23
    s_mul_i32 s30, s25, 12
    s_lshl_b32 s31, s53, 2
    s_add_u32 s30, s30, s31
    s_add_u32 s30, s30, 0
    s_lshl_b32 s30, s30, 10
    s_add_u32 s30, s30, s50
    buffer_store_dwordx4 v[224:227], v204, s[40:43], s30 offen sc1
    s_waitcnt lgkmcnt(5)
    v_pk_fma_f32 v[24:25], v[208:209], v[84:85], v[24:25] op_sel_hi:[0,1,1] neg_lo:[1,0,0] neg_hi:[1,0,0]
    v_pk_fma_f32 v[26:27], v[208:209], v[86:87], v[26:27] op_sel_hi:[0,1,1] neg_lo:[1,0,0] neg_hi:[1,0,0]
    v_pk_mul_f32 v[24:25], v[212:213], v[24:25] op_sel_hi:[0,1]
    v_pk_mul_f32 v[26:27], v[212:213], v[26:27] op_sel_hi:[0,1]
    v_exp_f32 v220, -v24
    v_exp_f32 v221, -v25
    v_exp_f32 v222, -v26
    v_exp_f32 v223, -v27
    s_nop 0
    v_pk_fma_f32 v[220:221], v[220:221], v[232:233], v[232:233]
    v_pk_fma_f32 v[222:223], v[222:223], v[232:233], v[232:233]
    v_rcp_f32 v220, v220
    v_rcp_f32 v221, v221
    v_rcp_f32 v222, v222
    v_rcp_f32 v223, v223
    s_nop 0
    v_pk_mul_f32 v[24:25], v[24:25], v[220:221]
    v_pk_mul_f32 v[26:27], v[26:27], v[222:223]
    v_cvt_pk_bf16_f32 v228, v24, v25
    v_cvt_pk_bf16_f32 v229, v26, v27
    s_waitcnt lgkmcnt(4)
    v_pk_fma_f32 v[28:29], v[208:209], v[88:89], v[28:29] op_sel_hi:[0,1,1] neg_lo:[1,0,0] neg_hi:[1,0,0]
    v_pk_fma_f32 v[30:31], v[208:209], v[90:91], v[30:31] op_sel_hi:[0,1,1] neg_lo:[1,0,0] neg_hi:[1,0,0]
    v_pk_mul_f32 v[28:29], v[212:213], v[28:29] op_sel_hi:[0,1]
    v_pk_mul_f32 v[30:31], v[212:213], v[30:31] op_sel_hi:[0,1]
    v_exp_f32 v220, -v28
    v_exp_f32 v221, -v29
    v_exp_f32 v222, -v30
    v_exp_f32 v223, -v31
    s_nop 0
    v_pk_fma_f32 v[220:221], v[220:221], v[232:233], v[232:233]
    v_pk_fma_f32 v[222:223], v[222:223], v[232:233], v[232:233]
    v_rcp_f32 v220, v220
    v_rcp_f32 v221, v221
    v_rcp_f32 v222, v222
    v_rcp_f32 v223, v223
    s_nop 0
    v_pk_mul_f32 v[28:29], v[28:29], v[220:221]
    v_pk_mul_f32 v[30:31], v[30:31], v[222:223]
    v_cvt_pk_bf16_f32 v230, v28, v29
    v_cvt_pk_bf16_f32 v231, v30, v31
    s_mul_i32 s30, s25, 12
    s_lshl_b32 s31, s53, 2
    s_add_u32 s30, s30, s31
    s_add_u32 s30, s30, 2
    s_lshl_b32 s30, s30, 10
    s_add_u32 s30, s30, s50
    buffer_store_dwordx4 v[228:231], v204, s[40:43], s30 offen sc1
    s_waitcnt lgkmcnt(3)
    v_pk_fma_f32 v[32:33], v[208:209], v[92:93], v[32:33] op_sel_hi:[0,1,1] neg_lo:[1,0,0] neg_hi:[1,0,0]
    v_pk_fma_f32 v[34:35], v[208:209], v[94:95], v[34:35] op_sel_hi:[0,1,1] neg_lo:[1,0,0] neg_hi:[1,0,0]
    v_pk_mul_f32 v[32:33], v[212:213], v[32:33] op_sel_hi:[0,1]
    v_pk_mul_f32 v[34:35], v[212:213], v[34:35] op_sel_hi:[0,1]
    v_exp_f32 v220, -v32
    v_exp_f32 v221, -v33
    v_exp_f32 v222, -v34
    v_exp_f32 v223, -v35
    s_nop 0
    v_pk_fma_f32 v[220:221], v[220:221], v[232:233], v[232:233]
    v_pk_fma_f32 v[222:223], v[222:223], v[232:233], v[232:233]
    v_rcp_f32 v220, v220
    v_rcp_f32 v221, v221
    v_rcp_f32 v222, v222
    v_rcp_f32 v223, v223
    s_nop 0
    v_pk_mul_f32 v[32:33], v[32:33], v[220:221]
    v_pk_mul_f32 v[34:35], v[34:35], v[222:223]
    v_cvt_pk_bf16_f32 v224, v32, v33
    v_cvt_pk_bf16_f32 v225, v34, v35
    s_waitcnt lgkmcnt(2)
    v_pk_fma_f32 v[36:37], v[208:209], v[96:97], v[36:37] op_sel_hi:[0,1,1] neg_lo:[1,0,0] neg_hi:[1,0,0]
    v_pk_fma_f32 v[38:39], v[208:209], v[98:99], v[38:39] op_sel_hi:[0,1,1] neg_lo:[1,0,0] neg_hi:[1,0,0]
    v_pk_mul_f32 v[36:37], v[212:213], v[36:37] op_sel_hi:[0,1]
    v_pk_mul_f32 v[38:39], v[212:213], v[38:39] op_sel_hi:[0,1]
    v_exp_f32 v220, -v36
    v_exp_f32 v221, -v37
    v_exp_f32 v222, -v38
    v_exp_f32 v223, -v39
    s_nop 0
    v_pk_fma_f32 v[220:221], v[220:221], v[232:233], v[232:233]
    v_pk_fma_f32 v[222:223], v[222:223], v[232:233], v[232:233]
    v_rcp_f32 v220, v220
    v_rcp_f32 v221, v221
    v_rcp_f32 v222, v222
    v_rcp_f32 v223, v223
    s_nop 0
    v_pk_mul_f32 v[36:37], v[36:37], v[220:221]
    v_pk_mul_f32 v[38:39], v[38:39], v[222:223]
    v_cvt_pk_bf16_f32 v226, v36, v37
    v_cvt_pk_bf16_f32 v227, v38, v39
    s_mul_i32 s30, s25, 12
    s_lshl_b32 s31, s54, 2
    s_add_u32 s30, s30, s31
    s_add_u32 s30, s30, 0
    s_lshl_b32 s30, s30, 10
    s_add_u32 s30, s30, s50
    buffer_store_dwordx4 v[224:227], v204, s[40:43], s30 offen sc1
    s_waitcnt lgkmcnt(1)
    v_pk_fma_f32 v[40:41], v[208:209], v[100:101], v[40:41] op_sel_hi:[0,1,1] neg_lo:[1,0,0] neg_hi:[1,0,0]
    v_pk_fma_f32 v[42:43], v[208:209], v[102:103], v[42:43] op_sel_hi:[0,1,1] neg_lo:[1,0,0] neg_hi:[1,0,0]
    v_pk_mul_f32 v[40:41], v[212:213], v[40:41] op_sel_hi:[0,1]
    v_pk_mul_f32 v[42:43], v[212:213], v[42:43] op_sel_hi:[0,1]
    v_exp_f32 v220, -v40
    v_exp_f32 v221, -v41
    v_exp_f32 v222, -v42
    v_exp_f32 v223, -v43
    s_nop 0
    v_pk_fma_f32 v[220:221], v[220:221], v[232:233], v[232:233]
    v_pk_fma_f32 v[222:223], v[222:223], v[232:233], v[232:233]
    v_rcp_f32 v220, v220
    v_rcp_f32 v221, v221
    v_rcp_f32 v222, v222
    v_rcp_f32 v223, v223
    s_nop 0
    v_pk_mul_f32 v[40:41], v[40:41], v[220:221]
    v_pk_mul_f32 v[42:43], v[42:43], v[222:223]
    v_cvt_pk_bf16_f32 v228, v40, v41
    v_cvt_pk_bf16_f32 v229, v42, v43
    s_waitcnt lgkmcnt(0)
    v_pk_fma_f32 v[44:45], v[208:209], v[104:105], v[44:45] op_sel_hi:[0,1,1] neg_lo:[1,0,0] neg_hi:[1,0,0]
    v_pk_fma_f32 v[46:47], v[208:209], v[106:107], v[46:47] op_sel_hi:[0,1,1] neg_lo:[1,0,0] neg_hi:[1,0,0]
    v_pk_mul_f32 v[44:45], v[212:213], v[44:45] op_sel_hi:[0,1]
    v_pk_mul_f32 v[46:47], v[212:213], v[46:47] op_sel_hi:[0,1]
    v_exp_f32 v220, -v44
    v_exp_f32 v221, -v45
    v_exp_f32 v222, -v46
    v_exp_f32 v223, -v47
    s_nop 0
    v_pk_fma_f32 v[220:221], v[220:221], v[232:233], v[232:233]
    v_pk_fma_f32 v[222:223], v[222:223], v[232:233], v[232:233]
    v_rcp_f32 v220, v220
    v_rcp_f32 v221, v221
    v_rcp_f32 v222, v222
    v_rcp_f32 v223, v223
    s_nop 0
    v_pk_mul_f32 v[44:45], v[44:45], v[220:221]
    v_pk_mul_f32 v[46:47], v[46:47], v[222:223]
    v_cvt_pk_bf16_f32 v230, v44, v45
    v_cvt_pk_bf16_f32 v231, v46, v47
    s_mul_i32 s30, s25, 12
    s_lshl_b32 s31, s54, 2
    s_add_u32 s30, s30, s31
    s_add_u32 s30, s30, 2
    s_lshl_b32 s30, s30, 10
    s_add_u32 s30, s30, s50
    buffer_store_dwordx4 v[228:231], v204, s[40:43], s30 offen sc1
    s_lshl_b32 s34, s24, 8
    s_add_u32 s34, s34, 24287232
    s_barrier
    s_waitcnt vmcnt(0)
    s_barrier
    s_cmp_lg_u32 s22, 0
    s_cbranch_scc1 sequential_preLN__softmax_full_mha__dense_activation_silu__prompt_kernel_att_w0_8
    s_mov_b64 exec, 1
    v_mov_b32 v60, s34
    v_mov_b32 v61, 1
    global_atomic_add v60, v61, s[4:5] sc1
    s_mov_b64 exec, -1
sequential_preLN__softmax_full_mha__dense_activation_silu__prompt_kernel_att_w0_8:
    s_load_dwordx2 s[56:57], s[0:1], 48
    s_and_b32 s30, s2, 7
    s_lshr_b32 s31, s2, 3
    s_lshr_b32 s24, s30, 1
    s_lshl_b32 s24, s24, 3
    s_and_b32 s32, s31, 7
    s_add_u32 s24, s24, s32
    s_and_b32 s25, s30, 1
    s_lshl_b32 s25, s25, 2
    s_lshr_b32 s32, s31, 3
    s_add_u32 s25, s25, s32
    s_and_b32 s26, s22, 1
    s_bfe_u32 s27, s22, 0x10001
    v_and_b32 v71, 15, v245
    v_lshrrev_b32 v72, 4, v245
    v_lshlrev_b32 v84, 10, v72
    v_lshl_add_u32 v84, v71, 4, v84
    s_lshl_b32 s30, s26, 9
    v_add_u32 v84, s30, v84
    s_lshl_b32 s30, s27, 8
    v_add_u32 v65, s30, v84
    s_xor_b32 s30, s30, 256
    v_add_u32 v66, s30, v84
    s_mul_i32 s37, s27, 98304
    s_mul_i32 s30, s24, 196608
    s_add_u32 s30, s30, 13107200
    s_add_u32 s12, s4, s30
    s_addc_u32 s13, s5, 0
    s_and_b32 s13, s13, 0xffff
    s_mov_b32 s14, 196608
    s_mov_b32 s15, 0x20000
    v_mul_u32_u24 v108, 1280, v71
    v_lshl_add_u32 v108, v72, 3, v108
    v_lshrrev_b32 v84, 1, v72
    v_lshlrev_b32 v84, 10, v84
    v_and_b32 v85, 1, v72
    v_lshl_add_u32 v84, v85, 3, v84
    v_lshl_add_u32 v109, v71, 4, v84
    s_lshl_b32 s30, s26, 5
    s_lshl_b32 s31, s27, 4
    s_add_u32 s30, s30, s31
    s_lshl_b32 s48, s30, 4
    s_mul_i32 s31, s24, 81920
    s_add_u32 s48, s48, s31
    s_mul_i32 s31, s25, 10240
    s_add_u32 s48, s48, s31
    s_lshl_b32 s31, s24, 6
    s_add_u32 s32, s30, s31
    s_mul_i32 s39, s32, 1280
    s_mul_i32 s31, s25, 160
    s_add_u32 s39, s39, s31
    v_lshrrev_b32 v84, 1, v72
    v_lshlrev_b32 v84, 4, v84
    v_and_b32 v85, 1, v72
    v_lshl_add_u32 v84, v85, 2, v84
    v_lshrrev_b32 v85, 2, v71
    v_add_u32 v84, v84, v85
    v_mul_u32_u24 v84, 160, v84
    v_and_b32 v85, 3, v71
    v_lshl_add_u32 v84, v85, 3, v84
    s_mul_i32 s30, s27, 10240
    v_add_u32 v67, s30, v84
    v_add_u32 v68, 61440, v67
    v_add_u32 v69, 122880, v67
    s_waitcnt lgkmcnt(0)
    s_mov_b32 s16, s56
    s_and_b32 s17, s57, 0xffff
    s_mov_b32 s18, 2621440
    s_mov_b32 s19, 0x20000
    v_lshlrev_b32 v0, 16, v246
    v_and_b32 v1, 0xffff0000, v246
    v_lshlrev_b32 v2, 16, v247
    v_and_b32 v3, 0xffff0000, v247
    v_lshlrev_b32 v4, 16, v248
    v_and_b32 v5, 0xffff0000, v248
    v_lshlrev_b32 v6, 16, v249
    v_and_b32 v7, 0xffff0000, v249
    v_lshlrev_b32 v8, 16, v250
    v_and_b32 v9, 0xffff0000, v250
    v_lshlrev_b32 v10, 16, v251
    v_and_b32 v11, 0xffff0000, v251
    v_lshlrev_b32 v12, 16, v252
    v_and_b32 v13, 0xffff0000, v252
    v_lshlrev_b32 v14, 16, v253
    v_and_b32 v15, 0xffff0000, v253
    v_lshlrev_b32 v16, 16, v254
    v_and_b32 v17, 0xffff0000, v254
    v_lshlrev_b32 v18, 16, v255
    v_and_b32 v19, 0xffff0000, v255
    s_lshr_b32 s34, s24, 1
    s_lshl_b32 s34, s34, 8
    s_add_u32 s34, s34, 24287232
    s_cmp_lg_u32 s22, 0
    s_cbranch_scc1 sequential_preLN__softmax_full_mha__dense_activation_silu__prompt_kernel_att_w0_9
    s_mov_b64 exec, 1
    v_mov_b32 v60, s34
    s_mov_b32 s35, 262144
sequential_preLN__softmax_full_mha__dense_activation_silu__prompt_kernel_att_poll10:
    global_load_dword v61, v60, s[4:5] sc1
    s_waitcnt vmcnt(0)
    v_cmp_gt_u32 vcc, 16, v61
    s_cbranch_vccz sequential_preLN__softmax_full_mha__dense_activation_silu__prompt_kernel_att_poll10_d
    s_sub_u32 s35, s35, 1
    s_cmp_lg_u32 s35, 0
    s_cbranch_scc1 sequential_preLN__softmax_full_mha__dense_activation_silu__prompt_kernel_att_poll10
sequential_preLN__softmax_full_mha__dense_activation_silu__prompt_kernel_att_poll10_d:
    s_mov_b64 exec, -1
sequential_preLN__softmax_full_mha__dense_activation_silu__prompt_kernel_att_w0_9:
    s_barrier
    s_add_u32 s31, s37, 0
    buffer_load_dwordx4 v[112:115], v65, s[12:15], s31 offen sc1
    buffer_load_dwordx4 v[116:119], v66, s[12:15], s31 offen sc1
    s_add_u32 s31, s37, 4096
    buffer_load_dwordx4 v[120:123], v65, s[12:15], s31 offen sc1
    buffer_load_dwordx4 v[124:127], v66, s[12:15], s31 offen sc1
    s_add_u32 s31, s37, 8192
    buffer_load_dwordx4 v[128:131], v65, s[12:15], s31 offen sc1
    buffer_load_dwordx4 v[132:135], v66, s[12:15], s31 offen sc1
    s_add_u32 s31, s37, 12288
    buffer_load_dwordx4 v[136:139], v65, s[12:15], s31 offen sc1
    buffer_load_dwordx4 v[140:143], v66, s[12:15], s31 offen sc1
    ds_read_b64_tr_b16 v[40:41], v69 offset:0
    ds_read_b64_tr_b16 v[42:43], v69 offset:1280
    ds_read_b64_tr_b16 v[44:45], v69 offset:32
    ds_read_b64_tr_b16 v[46:47], v69 offset:1312
    ds_read_b64_tr_b16 v[48:49], v69 offset:64
    ds_read_b64_tr_b16 v[50:51], v69 offset:1344
    ds_read_b64_tr_b16 v[52:53], v69 offset:96
    ds_read_b64_tr_b16 v[54:55], v69 offset:1376
    ds_read_b64_tr_b16 v[56:57], v69 offset:128
    ds_read_b64_tr_b16 v[58:59], v69 offset:1408
    s_add_u32 s31, s37, 16384
    buffer_load_dwordx4 v[144:147], v65, s[12:15], s31 offen sc1
    buffer_load_dwordx4 v[148:151], v66, s[12:15], s31 offen sc1
    s_add_u32 s31, s37, 20480
    buffer_load_dwordx4 v[152:155], v65, s[12:15], s31 offen sc1
    buffer_load_dwordx4 v[156:159], v66, s[12:15], s31 offen sc1
    s_add_u32 s31, s37, 24576
    buffer_load_dwordx4 v[160:163], v65, s[12:15], s31 offen sc1
    buffer_load_dwordx4 v[164:167], v66, s[12:15], s31 offen sc1
    s_add_u32 s31, s37, 28672
    buffer_load_dwordx4 v[168:171], v65, s[12:15], s31 offen sc1
    buffer_load_dwordx4 v[172:175], v66, s[12:15], s31 offen sc1
    s_waitcnt vmcnt(14)
    s_waitcnt lgkmcnt(0)
    v_mfma_f32_16x16x32_bf16 v[0:3], v[40:43], v[112:115], v[0:3]
    ds_read_b64_tr_b16 v[88:89], v69 offset:5120
    v_mfma_f32_16x16x32_bf16 v[20:23], v[40:43], v[116:119], 0
    ds_read_b64_tr_b16 v[90:91], v69 offset:6400
    v_mfma_f32_16x16x32_bf16 v[4:7], v[44:47], v[112:115], v[4:7]
    ds_read_b64_tr_b16 v[92:93], v69 offset:5152
    v_mfma_f32_16x16x32_bf16 v[24:27], v[44:47], v[116:119], 0
    ds_read_b64_tr_b16 v[94:95], v69 offset:6432
    v_mfma_f32_16x16x32_bf16 v[8:11], v[48:51], v[112:115], v[8:11]
    ds_read_b64_tr_b16 v[96:97], v69 offset:5184
    v_mfma_f32_16x16x32_bf16 v[28:31], v[48:51], v[116:119], 0
    ds_read_b64_tr_b16 v[98:99], v69 offset:6464
    v_mfma_f32_16x16x32_bf16 v[12:15], v[52:55], v[112:115], v[12:15]
    ds_read_b64_tr_b16 v[100:101], v69 offset:5216
    v_mfma_f32_16x16x32_bf16 v[32:35], v[52:55], v[116:119], 0
    ds_read_b64_tr_b16 v[102:103], v69 offset:6496
    v_mfma_f32_16x16x32_bf16 v[16:19], v[56:59], v[112:115], v[16:19]
    ds_read_b64_tr_b16 v[104:105], v69 offset:5248
    v_mfma_f32_16x16x32_bf16 v[36:39], v[56:59], v[116:119], 0
    ds_read_b64_tr_b16 v[106:107], v69 offset:6528
    s_add_u32 s31, s37, 32768
    buffer_load_dwordx4 v[176:179], v65, s[12:15], s31 offen sc1
    buffer_load_dwordx4 v[180:183], v66, s[12:15], s31 offen sc1
    s_barrier
    s_waitcnt vmcnt(14)
    s_waitcnt lgkmcnt(0)
    v_mfma_f32_16x16x32_bf16 v[0:3], v[88:91], v[120:123], v[0:3]
    ds_read_b64_tr_b16 v[40:41], v67 offset:0
    v_mfma_f32_16x16x32_bf16 v[20:23], v[88:91], v[124:127], v[20:23]
    ds_read_b64_tr_b16 v[42:43], v67 offset:1280
    v_mfma_f32_16x16x32_bf16 v[4:7], v[92:95], v[120:123], v[4:7]
    ds_read_b64_tr_b16 v[44:45], v67 offset:32
    v_mfma_f32_16x16x32_bf16 v[24:27], v[92:95], v[124:127], v[24:27]
    ds_read_b64_tr_b16 v[46:47], v67 offset:1312
    v_mfma_f32_16x16x32_bf16 v[8:11], v[96:99], v[120:123], v[8:11]
    ds_read_b64_tr_b16 v[48:49], v67 offset:64
    v_mfma_f32_16x16x32_bf16 v[28:31], v[96:99], v[124:127], v[28:31]
    ds_read_b64_tr_b16 v[50:51], v67 offset:1344
    v_mfma_f32_16x16x32_bf16 v[12:15], v[100:103], v[120:123], v[12:15]
    ds_read_b64_tr_b16 v[52:53], v67 offset:96
    v_mfma_f32_16x16x32_bf16 v[32:35], v[100:103], v[124:127], v[32:35]
    ds_read_b64_tr_b16 v[54:55], v67 offset:1376
    v_mfma_f32_16x16x32_bf16 v[16:19], v[104:107], v[120:123], v[16:19]
    ds_read_b64_tr_b16 v[56:57], v67 offset:128
    v_mfma_f32_16x16x32_bf16 v[36:39], v[104:107], v[124:127], v[36:39]
    ds_read_b64_tr_b16 v[58:59], v67 offset:1408
    s_add_u32 s31, s37, 36864
    buffer_load_dwordx4 v[184:187], v65, s[12:15], s31 offen sc1
    buffer_load_dwordx4 v[188:191], v66, s[12:15], s31 offen sc1
    s_waitcnt vmcnt(14)
    s_waitcnt lgkmcnt(0)
    v_mfma_f32_16x16x32_bf16 v[0:3], v[40:43], v[128:131], v[0:3]
    ds_read_b64_tr_b16 v[88:89], v67 offset:5120
    v_mfma_f32_16x16x32_bf16 v[20:23], v[40:43], v[132:135], v[20:23]
    ds_read_b64_tr_b16 v[90:91], v67 offset:6400
    v_mfma_f32_16x16x32_bf16 v[4:7], v[44:47], v[128:131], v[4:7]
    ds_read_b64_tr_b16 v[92:93], v67 offset:5152
    v_mfma_f32_16x16x32_bf16 v[24:27], v[44:47], v[132:135], v[24:27]
    ds_read_b64_tr_b16 v[94:95], v67 offset:6432
    v_mfma_f32_16x16x32_bf16 v[8:11], v[48:51], v[128:131], v[8:11]
    ds_read_b64_tr_b16 v[96:97], v67 offset:5184
    v_mfma_f32_16x16x32_bf16 v[28:31], v[48:51], v[132:135], v[28:31]
    ds_read_b64_tr_b16 v[98:99], v67 offset:6464
    v_mfma_f32_16x16x32_bf16 v[12:15], v[52:55], v[128:131], v[12:15]
    ds_read_b64_tr_b16 v[100:101], v67 offset:5216
    v_mfma_f32_16x16x32_bf16 v[32:35], v[52:55], v[132:135], v[32:35]
    ds_read_b64_tr_b16 v[102:103], v67 offset:6496
    v_mfma_f32_16x16x32_bf16 v[16:19], v[56:59], v[128:131], v[16:19]
    ds_read_b64_tr_b16 v[104:105], v67 offset:5248
    v_mfma_f32_16x16x32_bf16 v[36:39], v[56:59], v[132:135], v[36:39]
    ds_read_b64_tr_b16 v[106:107], v67 offset:6528
    s_add_u32 s31, s37, 40960
    buffer_load_dwordx4 v[192:195], v65, s[12:15], s31 offen sc1
    buffer_load_dwordx4 v[196:199], v66, s[12:15], s31 offen sc1
    s_barrier
    s_waitcnt vmcnt(14)
    s_waitcnt lgkmcnt(0)
    v_mfma_f32_16x16x32_bf16 v[0:3], v[88:91], v[136:139], v[0:3]
    ds_read_b64_tr_b16 v[40:41], v67 offset:20480
    v_mfma_f32_16x16x32_bf16 v[20:23], v[88:91], v[140:143], v[20:23]
    ds_read_b64_tr_b16 v[42:43], v67 offset:21760
    v_mfma_f32_16x16x32_bf16 v[4:7], v[92:95], v[136:139], v[4:7]
    ds_read_b64_tr_b16 v[44:45], v67 offset:20512
    v_mfma_f32_16x16x32_bf16 v[24:27], v[92:95], v[140:143], v[24:27]
    ds_read_b64_tr_b16 v[46:47], v67 offset:21792
    v_mfma_f32_16x16x32_bf16 v[8:11], v[96:99], v[136:139], v[8:11]
    ds_read_b64_tr_b16 v[48:49], v67 offset:20544
    v_mfma_f32_16x16x32_bf16 v[28:31], v[96:99], v[140:143], v[28:31]
    ds_read_b64_tr_b16 v[50:51], v67 offset:21824
    v_mfma_f32_16x16x32_bf16 v[12:15], v[100:103], v[136:139], v[12:15]
    ds_read_b64_tr_b16 v[52:53], v67 offset:20576
    v_mfma_f32_16x16x32_bf16 v[32:35], v[100:103], v[140:143], v[32:35]
    ds_read_b64_tr_b16 v[54:55], v67 offset:21856
    v_mfma_f32_16x16x32_bf16 v[16:19], v[104:107], v[136:139], v[16:19]
    ds_read_b64_tr_b16 v[56:57], v67 offset:20608
    v_mfma_f32_16x16x32_bf16 v[36:39], v[104:107], v[140:143], v[36:39]
    ds_read_b64_tr_b16 v[58:59], v67 offset:21888
    s_add_u32 s31, s37, 45056
    buffer_load_dwordx4 v[200:203], v65, s[12:15], s31 offen sc1
    buffer_load_dwordx4 v[204:207], v66, s[12:15], s31 offen sc1
    s_waitcnt vmcnt(14)
    s_waitcnt lgkmcnt(0)
    v_mfma_f32_16x16x32_bf16 v[0:3], v[40:43], v[144:147], v[0:3]
    ds_read_b64_tr_b16 v[88:89], v67 offset:25600
    v_mfma_f32_16x16x32_bf16 v[20:23], v[40:43], v[148:151], v[20:23]
    ds_read_b64_tr_b16 v[90:91], v67 offset:26880
    v_mfma_f32_16x16x32_bf16 v[4:7], v[44:47], v[144:147], v[4:7]
    ds_read_b64_tr_b16 v[92:93], v67 offset:25632
    v_mfma_f32_16x16x32_bf16 v[24:27], v[44:47], v[148:151], v[24:27]
    ds_read_b64_tr_b16 v[94:95], v67 offset:26912
    v_mfma_f32_16x16x32_bf16 v[8:11], v[48:51], v[144:147], v[8:11]
    ds_read_b64_tr_b16 v[96:97], v67 offset:25664
    v_mfma_f32_16x16x32_bf16 v[28:31], v[48:51], v[148:151], v[28:31]
    ds_read_b64_tr_b16 v[98:99], v67 offset:26944
    v_mfma_f32_16x16x32_bf16 v[12:15], v[52:55], v[144:147], v[12:15]
    ds_read_b64_tr_b16 v[100:101], v67 offset:25696
    v_mfma_f32_16x16x32_bf16 v[32:35], v[52:55], v[148:151], v[32:35]
    ds_read_b64_tr_b16 v[102:103], v67 offset:26976
    v_mfma_f32_16x16x32_bf16 v[16:19], v[56:59], v[144:147], v[16:19]
    ds_read_b64_tr_b16 v[104:105], v67 offset:25728
    v_mfma_f32_16x16x32_bf16 v[36:39], v[56:59], v[148:151], v[36:39]
    ds_read_b64_tr_b16 v[106:107], v67 offset:27008
    s_add_u32 s31, s37, 49152
    buffer_load_dwordx4 v[208:211], v65, s[12:15], s31 offen sc1
    buffer_load_dwordx4 v[212:215], v66, s[12:15], s31 offen sc1
    s_barrier
    s_waitcnt vmcnt(14)
    s_waitcnt lgkmcnt(0)
    v_mfma_f32_16x16x32_bf16 v[0:3], v[88:91], v[152:155], v[0:3]
    ds_read_b64_tr_b16 v[40:41], v67 offset:40960
    v_mfma_f32_16x16x32_bf16 v[20:23], v[88:91], v[156:159], v[20:23]
    ds_read_b64_tr_b16 v[42:43], v67 offset:42240
    v_mfma_f32_16x16x32_bf16 v[4:7], v[92:95], v[152:155], v[4:7]
    ds_read_b64_tr_b16 v[44:45], v67 offset:40992
    v_mfma_f32_16x16x32_bf16 v[24:27], v[92:95], v[156:159], v[24:27]
    ds_read_b64_tr_b16 v[46:47], v67 offset:42272
    v_mfma_f32_16x16x32_bf16 v[8:11], v[96:99], v[152:155], v[8:11]
    ds_read_b64_tr_b16 v[48:49], v67 offset:41024
    v_mfma_f32_16x16x32_bf16 v[28:31], v[96:99], v[156:159], v[28:31]
    ds_read_b64_tr_b16 v[50:51], v67 offset:42304
    v_mfma_f32_16x16x32_bf16 v[12:15], v[100:103], v[152:155], v[12:15]
    ds_read_b64_tr_b16 v[52:53], v67 offset:41056
    v_mfma_f32_16x16x32_bf16 v[32:35], v[100:103], v[156:159], v[32:35]
    ds_read_b64_tr_b16 v[54:55], v67 offset:42336
    v_mfma_f32_16x16x32_bf16 v[16:19], v[104:107], v[152:155], v[16:19]
    ds_read_b64_tr_b16 v[56:57], v67 offset:41088
    v_mfma_f32_16x16x32_bf16 v[36:39], v[104:107], v[156:159], v[36:39]
    ds_read_b64_tr_b16 v[58:59], v67 offset:42368
    s_add_u32 s31, s37, 53248
    buffer_load_dwordx4 v[216:219], v65, s[12:15], s31 offen sc1
    buffer_load_dwordx4 v[220:223], v66, s[12:15], s31 offen sc1
    s_waitcnt vmcnt(14)
    s_waitcnt lgkmcnt(0)
    v_mfma_f32_16x16x32_bf16 v[0:3], v[40:43], v[160:163], v[0:3]
    ds_read_b64_tr_b16 v[88:89], v67 offset:46080
    v_mfma_f32_16x16x32_bf16 v[20:23], v[40:43], v[164:167], v[20:23]
    ds_read_b64_tr_b16 v[90:91], v67 offset:47360
    v_mfma_f32_16x16x32_bf16 v[4:7], v[44:47], v[160:163], v[4:7]
    ds_read_b64_tr_b16 v[92:93], v67 offset:46112
    v_mfma_f32_16x16x32_bf16 v[24:27], v[44:47], v[164:167], v[24:27]
    ds_read_b64_tr_b16 v[94:95], v67 offset:47392
    v_mfma_f32_16x16x32_bf16 v[8:11], v[48:51], v[160:163], v[8:11]
    ds_read_b64_tr_b16 v[96:97], v67 offset:46144
    v_mfma_f32_16x16x32_bf16 v[28:31], v[48:51], v[164:167], v[28:31]
    ds_read_b64_tr_b16 v[98:99], v67 offset:47424
    v_mfma_f32_16x16x32_bf16 v[12:15], v[52:55], v[160:163], v[12:15]
    ds_read_b64_tr_b16 v[100:101], v67 offset:46176
    v_mfma_f32_16x16x32_bf16 v[32:35], v[52:55], v[164:167], v[32:35]
    ds_read_b64_tr_b16 v[102:103], v67 offset:47456
    v_mfma_f32_16x16x32_bf16 v[16:19], v[56:59], v[160:163], v[16:19]
    ds_read_b64_tr_b16 v[104:105], v67 offset:46208
    v_mfma_f32_16x16x32_bf16 v[36:39], v[56:59], v[164:167], v[36:39]
    ds_read_b64_tr_b16 v[106:107], v67 offset:47488
    s_add_u32 s31, s37, 57344
    buffer_load_dwordx4 v[224:227], v65, s[12:15], s31 offen sc1
    buffer_load_dwordx4 v[228:231], v66, s[12:15], s31 offen sc1
    s_barrier
    s_waitcnt vmcnt(14)
    s_waitcnt lgkmcnt(0)
    v_mfma_f32_16x16x32_bf16 v[0:3], v[88:91], v[168:171], v[0:3]
    ds_read_b64_tr_b16 v[40:41], v68 offset:0
    v_mfma_f32_16x16x32_bf16 v[20:23], v[88:91], v[172:175], v[20:23]
    ds_read_b64_tr_b16 v[42:43], v68 offset:1280
    v_mfma_f32_16x16x32_bf16 v[4:7], v[92:95], v[168:171], v[4:7]
    ds_read_b64_tr_b16 v[44:45], v68 offset:32
    v_mfma_f32_16x16x32_bf16 v[24:27], v[92:95], v[172:175], v[24:27]
    ds_read_b64_tr_b16 v[46:47], v68 offset:1312
    v_mfma_f32_16x16x32_bf16 v[8:11], v[96:99], v[168:171], v[8:11]
    ds_read_b64_tr_b16 v[48:49], v68 offset:64
    v_mfma_f32_16x16x32_bf16 v[28:31], v[96:99], v[172:175], v[28:31]
    ds_read_b64_tr_b16 v[50:51], v68 offset:1344
    v_mfma_f32_16x16x32_bf16 v[12:15], v[100:103], v[168:171], v[12:15]
    ds_read_b64_tr_b16 v[52:53], v68 offset:96
    v_mfma_f32_16x16x32_bf16 v[32:35], v[100:103], v[172:175], v[32:35]
    ds_read_b64_tr_b16 v[54:55], v68 offset:1376
    v_mfma_f32_16x16x32_bf16 v[16:19], v[104:107], v[168:171], v[16:19]
    ds_read_b64_tr_b16 v[56:57], v68 offset:128
    v_mfma_f32_16x16x32_bf16 v[36:39], v[104:107], v[172:175], v[36:39]
    ds_read_b64_tr_b16 v[58:59], v68 offset:1408
    s_add_u32 s31, s37, 61440
    buffer_load_dwordx4 v[232:235], v65, s[12:15], s31 offen sc1
    buffer_load_dwordx4 v[236:239], v66, s[12:15], s31 offen sc1
    s_waitcnt vmcnt(14)
    s_waitcnt lgkmcnt(0)
    v_mfma_f32_16x16x32_bf16 v[0:3], v[40:43], v[176:179], v[0:3]
    ds_read_b64_tr_b16 v[88:89], v68 offset:5120
    v_mfma_f32_16x16x32_bf16 v[20:23], v[40:43], v[180:183], v[20:23]
    ds_read_b64_tr_b16 v[90:91], v68 offset:6400
    v_mfma_f32_16x16x32_bf16 v[4:7], v[44:47], v[176:179], v[4:7]
    ds_read_b64_tr_b16 v[92:93], v68 offset:5152
    v_mfma_f32_16x16x32_bf16 v[24:27], v[44:47], v[180:183], v[24:27]
    ds_read_b64_tr_b16 v[94:95], v68 offset:6432
    v_mfma_f32_16x16x32_bf16 v[8:11], v[48:51], v[176:179], v[8:11]
    ds_read_b64_tr_b16 v[96:97], v68 offset:5184
    v_mfma_f32_16x16x32_bf16 v[28:31], v[48:51], v[180:183], v[28:31]
    ds_read_b64_tr_b16 v[98:99], v68 offset:6464
    v_mfma_f32_16x16x32_bf16 v[12:15], v[52:55], v[176:179], v[12:15]
    ds_read_b64_tr_b16 v[100:101], v68 offset:5216
    v_mfma_f32_16x16x32_bf16 v[32:35], v[52:55], v[180:183], v[32:35]
    ds_read_b64_tr_b16 v[102:103], v68 offset:6496
    v_mfma_f32_16x16x32_bf16 v[16:19], v[56:59], v[176:179], v[16:19]
    ds_read_b64_tr_b16 v[104:105], v68 offset:5248
    v_mfma_f32_16x16x32_bf16 v[36:39], v[56:59], v[180:183], v[36:39]
    ds_read_b64_tr_b16 v[106:107], v68 offset:6528
    s_add_u32 s31, s37, 65536
    buffer_load_dwordx4 v[112:115], v65, s[12:15], s31 offen sc1
    buffer_load_dwordx4 v[116:119], v66, s[12:15], s31 offen sc1
    s_barrier
    s_waitcnt vmcnt(14)
    s_waitcnt lgkmcnt(0)
    v_mfma_f32_16x16x32_bf16 v[0:3], v[88:91], v[184:187], v[0:3]
    ds_read_b64_tr_b16 v[40:41], v68 offset:20480
    v_mfma_f32_16x16x32_bf16 v[20:23], v[88:91], v[188:191], v[20:23]
    ds_read_b64_tr_b16 v[42:43], v68 offset:21760
    v_mfma_f32_16x16x32_bf16 v[4:7], v[92:95], v[184:187], v[4:7]
    ds_read_b64_tr_b16 v[44:45], v68 offset:20512
    v_mfma_f32_16x16x32_bf16 v[24:27], v[92:95], v[188:191], v[24:27]
    ds_read_b64_tr_b16 v[46:47], v68 offset:21792
    v_mfma_f32_16x16x32_bf16 v[8:11], v[96:99], v[184:187], v[8:11]
    ds_read_b64_tr_b16 v[48:49], v68 offset:20544
    v_mfma_f32_16x16x32_bf16 v[28:31], v[96:99], v[188:191], v[28:31]
    ds_read_b64_tr_b16 v[50:51], v68 offset:21824
    v_mfma_f32_16x16x32_bf16 v[12:15], v[100:103], v[184:187], v[12:15]
    ds_read_b64_tr_b16 v[52:53], v68 offset:20576
    v_mfma_f32_16x16x32_bf16 v[32:35], v[100:103], v[188:191], v[32:35]
    ds_read_b64_tr_b16 v[54:55], v68 offset:21856
    v_mfma_f32_16x16x32_bf16 v[16:19], v[104:107], v[184:187], v[16:19]
    ds_read_b64_tr_b16 v[56:57], v68 offset:20608
    v_mfma_f32_16x16x32_bf16 v[36:39], v[104:107], v[188:191], v[36:39]
    ds_read_b64_tr_b16 v[58:59], v68 offset:21888
    s_add_u32 s31, s37, 69632
    buffer_load_dwordx4 v[120:123], v65, s[12:15], s31 offen sc1
    buffer_load_dwordx4 v[124:127], v66, s[12:15], s31 offen sc1
    s_waitcnt vmcnt(14)
    s_waitcnt lgkmcnt(0)
    v_mfma_f32_16x16x32_bf16 v[0:3], v[40:43], v[192:195], v[0:3]
    ds_read_b64_tr_b16 v[88:89], v68 offset:25600
    v_mfma_f32_16x16x32_bf16 v[20:23], v[40:43], v[196:199], v[20:23]
    ds_read_b64_tr_b16 v[90:91], v68 offset:26880
    v_mfma_f32_16x16x32_bf16 v[4:7], v[44:47], v[192:195], v[4:7]
    ds_read_b64_tr_b16 v[92:93], v68 offset:25632
    v_mfma_f32_16x16x32_bf16 v[24:27], v[44:47], v[196:199], v[24:27]
    ds_read_b64_tr_b16 v[94:95], v68 offset:26912
    v_mfma_f32_16x16x32_bf16 v[8:11], v[48:51], v[192:195], v[8:11]
    ds_read_b64_tr_b16 v[96:97], v68 offset:25664
    v_mfma_f32_16x16x32_bf16 v[28:31], v[48:51], v[196:199], v[28:31]
    ds_read_b64_tr_b16 v[98:99], v68 offset:26944
    v_mfma_f32_16x16x32_bf16 v[12:15], v[52:55], v[192:195], v[12:15]
    ds_read_b64_tr_b16 v[100:101], v68 offset:25696
    v_mfma_f32_16x16x32_bf16 v[32:35], v[52:55], v[196:199], v[32:35]
    ds_read_b64_tr_b16 v[102:103], v68 offset:26976
    v_mfma_f32_16x16x32_bf16 v[16:19], v[56:59], v[192:195], v[16:19]
    ds_read_b64_tr_b16 v[104:105], v68 offset:25728
    v_mfma_f32_16x16x32_bf16 v[36:39], v[56:59], v[196:199], v[36:39]
    ds_read_b64_tr_b16 v[106:107], v68 offset:27008
    s_add_u32 s31, s37, 73728
    buffer_load_dwordx4 v[128:131], v65, s[12:15], s31 offen sc1
    buffer_load_dwordx4 v[132:135], v66, s[12:15], s31 offen sc1
    s_barrier
    s_waitcnt vmcnt(14)
    s_waitcnt lgkmcnt(0)
    v_mfma_f32_16x16x32_bf16 v[0:3], v[88:91], v[200:203], v[0:3]
    ds_read_b64_tr_b16 v[40:41], v68 offset:40960
    v_mfma_f32_16x16x32_bf16 v[20:23], v[88:91], v[204:207], v[20:23]
    ds_read_b64_tr_b16 v[42:43], v68 offset:42240
    v_mfma_f32_16x16x32_bf16 v[4:7], v[92:95], v[200:203], v[4:7]
    ds_read_b64_tr_b16 v[44:45], v68 offset:40992
    v_mfma_f32_16x16x32_bf16 v[24:27], v[92:95], v[204:207], v[24:27]
    ds_read_b64_tr_b16 v[46:47], v68 offset:42272
    v_mfma_f32_16x16x32_bf16 v[8:11], v[96:99], v[200:203], v[8:11]
    ds_read_b64_tr_b16 v[48:49], v68 offset:41024
    v_mfma_f32_16x16x32_bf16 v[28:31], v[96:99], v[204:207], v[28:31]
    ds_read_b64_tr_b16 v[50:51], v68 offset:42304
    v_mfma_f32_16x16x32_bf16 v[12:15], v[100:103], v[200:203], v[12:15]
    ds_read_b64_tr_b16 v[52:53], v68 offset:41056
    v_mfma_f32_16x16x32_bf16 v[32:35], v[100:103], v[204:207], v[32:35]
    ds_read_b64_tr_b16 v[54:55], v68 offset:42336
    v_mfma_f32_16x16x32_bf16 v[16:19], v[104:107], v[200:203], v[16:19]
    ds_read_b64_tr_b16 v[56:57], v68 offset:41088
    v_mfma_f32_16x16x32_bf16 v[36:39], v[104:107], v[204:207], v[36:39]
    ds_read_b64_tr_b16 v[58:59], v68 offset:42368
    s_add_u32 s31, s37, 77824
    buffer_load_dwordx4 v[136:139], v65, s[12:15], s31 offen sc1
    buffer_load_dwordx4 v[140:143], v66, s[12:15], s31 offen sc1
    s_waitcnt vmcnt(14)
    s_waitcnt lgkmcnt(0)
    v_mfma_f32_16x16x32_bf16 v[0:3], v[40:43], v[208:211], v[0:3]
    ds_read_b64_tr_b16 v[88:89], v68 offset:46080
    v_mfma_f32_16x16x32_bf16 v[20:23], v[40:43], v[212:215], v[20:23]
    ds_read_b64_tr_b16 v[90:91], v68 offset:47360
    v_mfma_f32_16x16x32_bf16 v[4:7], v[44:47], v[208:211], v[4:7]
    ds_read_b64_tr_b16 v[92:93], v68 offset:46112
    v_mfma_f32_16x16x32_bf16 v[24:27], v[44:47], v[212:215], v[24:27]
    ds_read_b64_tr_b16 v[94:95], v68 offset:47392
    v_mfma_f32_16x16x32_bf16 v[8:11], v[48:51], v[208:211], v[8:11]
    ds_read_b64_tr_b16 v[96:97], v68 offset:46144
    v_mfma_f32_16x16x32_bf16 v[28:31], v[48:51], v[212:215], v[28:31]
    ds_read_b64_tr_b16 v[98:99], v68 offset:47424
    v_mfma_f32_16x16x32_bf16 v[12:15], v[52:55], v[208:211], v[12:15]
    ds_read_b64_tr_b16 v[100:101], v68 offset:46176
    v_mfma_f32_16x16x32_bf16 v[32:35], v[52:55], v[212:215], v[32:35]
    ds_read_b64_tr_b16 v[102:103], v68 offset:47456
    v_mfma_f32_16x16x32_bf16 v[16:19], v[56:59], v[208:211], v[16:19]
    ds_read_b64_tr_b16 v[104:105], v68 offset:46208
    v_mfma_f32_16x16x32_bf16 v[36:39], v[56:59], v[212:215], v[36:39]
    ds_read_b64_tr_b16 v[106:107], v68 offset:47488
    s_add_u32 s31, s37, 81920
    buffer_load_dwordx4 v[144:147], v65, s[12:15], s31 offen sc1
    buffer_load_dwordx4 v[148:151], v66, s[12:15], s31 offen sc1
    s_barrier
    s_waitcnt vmcnt(14)
    s_waitcnt lgkmcnt(0)
    v_mfma_f32_16x16x32_bf16 v[0:3], v[88:91], v[216:219], v[0:3]
    ds_read_b64_tr_b16 v[40:41], v69 offset:20480
    v_mfma_f32_16x16x32_bf16 v[20:23], v[88:91], v[220:223], v[20:23]
    ds_read_b64_tr_b16 v[42:43], v69 offset:21760
    v_mfma_f32_16x16x32_bf16 v[4:7], v[92:95], v[216:219], v[4:7]
    ds_read_b64_tr_b16 v[44:45], v69 offset:20512
    v_mfma_f32_16x16x32_bf16 v[24:27], v[92:95], v[220:223], v[24:27]
    ds_read_b64_tr_b16 v[46:47], v69 offset:21792
    v_mfma_f32_16x16x32_bf16 v[8:11], v[96:99], v[216:219], v[8:11]
    ds_read_b64_tr_b16 v[48:49], v69 offset:20544
    v_mfma_f32_16x16x32_bf16 v[28:31], v[96:99], v[220:223], v[28:31]
    ds_read_b64_tr_b16 v[50:51], v69 offset:21824
    v_mfma_f32_16x16x32_bf16 v[12:15], v[100:103], v[216:219], v[12:15]
    ds_read_b64_tr_b16 v[52:53], v69 offset:20576
    v_mfma_f32_16x16x32_bf16 v[32:35], v[100:103], v[220:223], v[32:35]
    ds_read_b64_tr_b16 v[54:55], v69 offset:21856
    v_mfma_f32_16x16x32_bf16 v[16:19], v[104:107], v[216:219], v[16:19]
    ds_read_b64_tr_b16 v[56:57], v69 offset:20608
    v_mfma_f32_16x16x32_bf16 v[36:39], v[104:107], v[220:223], v[36:39]
    ds_read_b64_tr_b16 v[58:59], v69 offset:21888
    s_add_u32 s31, s37, 86016
    buffer_load_dwordx4 v[152:155], v65, s[12:15], s31 offen sc1
    buffer_load_dwordx4 v[156:159], v66, s[12:15], s31 offen sc1
    s_waitcnt vmcnt(14)
    s_waitcnt lgkmcnt(0)
    v_mfma_f32_16x16x32_bf16 v[0:3], v[40:43], v[224:227], v[0:3]
    ds_read_b64_tr_b16 v[88:89], v69 offset:25600
    v_mfma_f32_16x16x32_bf16 v[20:23], v[40:43], v[228:231], v[20:23]
    ds_read_b64_tr_b16 v[90:91], v69 offset:26880
    v_mfma_f32_16x16x32_bf16 v[4:7], v[44:47], v[224:227], v[4:7]
    ds_read_b64_tr_b16 v[92:93], v69 offset:25632
    v_mfma_f32_16x16x32_bf16 v[24:27], v[44:47], v[228:231], v[24:27]
    ds_read_b64_tr_b16 v[94:95], v69 offset:26912
    v_mfma_f32_16x16x32_bf16 v[8:11], v[48:51], v[224:227], v[8:11]
    ds_read_b64_tr_b16 v[96:97], v69 offset:25664
    v_mfma_f32_16x16x32_bf16 v[28:31], v[48:51], v[228:231], v[28:31]
    ds_read_b64_tr_b16 v[98:99], v69 offset:26944
    v_mfma_f32_16x16x32_bf16 v[12:15], v[52:55], v[224:227], v[12:15]
    ds_read_b64_tr_b16 v[100:101], v69 offset:25696
    v_mfma_f32_16x16x32_bf16 v[32:35], v[52:55], v[228:231], v[32:35]
    ds_read_b64_tr_b16 v[102:103], v69 offset:26976
    v_mfma_f32_16x16x32_bf16 v[16:19], v[56:59], v[224:227], v[16:19]
    ds_read_b64_tr_b16 v[104:105], v69 offset:25728
    v_mfma_f32_16x16x32_bf16 v[36:39], v[56:59], v[228:231], v[36:39]
    ds_read_b64_tr_b16 v[106:107], v69 offset:27008
    s_add_u32 s31, s37, 90112
    buffer_load_dwordx4 v[160:163], v65, s[12:15], s31 offen sc1
    buffer_load_dwordx4 v[164:167], v66, s[12:15], s31 offen sc1
    s_barrier
    s_waitcnt vmcnt(14)
    s_waitcnt lgkmcnt(0)
    v_mfma_f32_16x16x32_bf16 v[0:3], v[88:91], v[232:235], v[0:3]
    ds_read_b64_tr_b16 v[40:41], v69 offset:0
    v_mfma_f32_16x16x32_bf16 v[20:23], v[88:91], v[236:239], v[20:23]
    ds_read_b64_tr_b16 v[42:43], v69 offset:1280
    v_mfma_f32_16x16x32_bf16 v[4:7], v[92:95], v[232:235], v[4:7]
    ds_read_b64_tr_b16 v[44:45], v69 offset:32
    v_mfma_f32_16x16x32_bf16 v[24:27], v[92:95], v[236:239], v[24:27]
    ds_read_b64_tr_b16 v[46:47], v69 offset:1312
    v_mfma_f32_16x16x32_bf16 v[8:11], v[96:99], v[232:235], v[8:11]
    ds_read_b64_tr_b16 v[48:49], v69 offset:64
    v_mfma_f32_16x16x32_bf16 v[28:31], v[96:99], v[236:239], v[28:31]
    ds_read_b64_tr_b16 v[50:51], v69 offset:1344
    v_mfma_f32_16x16x32_bf16 v[12:15], v[100:103], v[232:235], v[12:15]
    ds_read_b64_tr_b16 v[52:53], v69 offset:96
    v_mfma_f32_16x16x32_bf16 v[32:35], v[100:103], v[236:239], v[32:35]
    ds_read_b64_tr_b16 v[54:55], v69 offset:1376
    v_mfma_f32_16x16x32_bf16 v[16:19], v[104:107], v[232:235], v[16:19]
    ds_read_b64_tr_b16 v[56:57], v69 offset:128
    v_mfma_f32_16x16x32_bf16 v[36:39], v[104:107], v[236:239], v[36:39]
    ds_read_b64_tr_b16 v[58:59], v69 offset:1408
    s_add_u32 s31, s37, 94208
    buffer_load_dwordx4 v[168:171], v65, s[12:15], s31 offen sc1
    buffer_load_dwordx4 v[172:175], v66, s[12:15], s31 offen sc1
    s_waitcnt vmcnt(14)
    s_waitcnt lgkmcnt(0)
    v_mfma_f32_16x16x32_bf16 v[0:3], v[40:43], v[112:115], v[0:3]
    ds_read_b64_tr_b16 v[88:89], v69 offset:5120
    v_mfma_f32_16x16x32_bf16 v[20:23], v[40:43], v[116:119], v[20:23]
    ds_read_b64_tr_b16 v[90:91], v69 offset:6400
    v_mfma_f32_16x16x32_bf16 v[4:7], v[44:47], v[112:115], v[4:7]
    ds_read_b64_tr_b16 v[92:93], v69 offset:5152
    v_mfma_f32_16x16x32_bf16 v[24:27], v[44:47], v[116:119], v[24:27]
    ds_read_b64_tr_b16 v[94:95], v69 offset:6432
    v_mfma_f32_16x16x32_bf16 v[8:11], v[48:51], v[112:115], v[8:11]
    ds_read_b64_tr_b16 v[96:97], v69 offset:5184
    v_mfma_f32_16x16x32_bf16 v[28:31], v[48:51], v[116:119], v[28:31]
    ds_read_b64_tr_b16 v[98:99], v69 offset:6464
    v_mfma_f32_16x16x32_bf16 v[12:15], v[52:55], v[112:115], v[12:15]
    ds_read_b64_tr_b16 v[100:101], v69 offset:5216
    v_mfma_f32_16x16x32_bf16 v[32:35], v[52:55], v[116:119], v[32:35]
    ds_read_b64_tr_b16 v[102:103], v69 offset:6496
    v_mfma_f32_16x16x32_bf16 v[16:19], v[56:59], v[112:115], v[16:19]
    ds_read_b64_tr_b16 v[104:105], v69 offset:5248
    v_mfma_f32_16x16x32_bf16 v[36:39], v[56:59], v[116:119], v[36:39]
    ds_read_b64_tr_b16 v[106:107], v69 offset:6528
    s_barrier
    s_waitcnt vmcnt(12)
    s_waitcnt lgkmcnt(0)
    v_mfma_f32_16x16x32_bf16 v[0:3], v[88:91], v[120:123], v[0:3]
    ds_read_b64_tr_b16 v[40:41], v67 offset:0
    v_mfma_f32_16x16x32_bf16 v[20:23], v[88:91], v[124:127], v[20:23]
    ds_read_b64_tr_b16 v[42:43], v67 offset:1280
    v_mfma_f32_16x16x32_bf16 v[4:7], v[92:95], v[120:123], v[4:7]
    ds_read_b64_tr_b16 v[44:45], v67 offset:32
    v_mfma_f32_16x16x32_bf16 v[24:27], v[92:95], v[124:127], v[24:27]
    ds_read_b64_tr_b16 v[46:47], v67 offset:1312
    v_mfma_f32_16x16x32_bf16 v[8:11], v[96:99], v[120:123], v[8:11]
    ds_read_b64_tr_b16 v[48:49], v67 offset:64
    v_mfma_f32_16x16x32_bf16 v[28:31], v[96:99], v[124:127], v[28:31]
    ds_read_b64_tr_b16 v[50:51], v67 offset:1344
    v_mfma_f32_16x16x32_bf16 v[12:15], v[100:103], v[120:123], v[12:15]
    ds_read_b64_tr_b16 v[52:53], v67 offset:96
    v_mfma_f32_16x16x32_bf16 v[32:35], v[100:103], v[124:127], v[32:35]
    ds_read_b64_tr_b16 v[54:55], v67 offset:1376
    v_mfma_f32_16x16x32_bf16 v[16:19], v[104:107], v[120:123], v[16:19]
    ds_read_b64_tr_b16 v[56:57], v67 offset:128
    v_mfma_f32_16x16x32_bf16 v[36:39], v[104:107], v[124:127], v[36:39]
    ds_read_b64_tr_b16 v[58:59], v67 offset:1408
    s_waitcnt vmcnt(10)
    s_waitcnt lgkmcnt(0)
    v_mfma_f32_16x16x32_bf16 v[0:3], v[40:43], v[128:131], v[0:3]
    ds_read_b64_tr_b16 v[88:89], v67 offset:5120
    v_mfma_f32_16x16x32_bf16 v[20:23], v[40:43], v[132:135], v[20:23]
    ds_read_b64_tr_b16 v[90:91], v67 offset:6400
    v_mfma_f32_16x16x32_bf16 v[4:7], v[44:47], v[128:131], v[4:7]
    ds_read_b64_tr_b16 v[92:93], v67 offset:5152
    v_mfma_f32_16x16x32_bf16 v[24:27], v[44:47], v[132:135], v[24:27]
    ds_read_b64_tr_b16 v[94:95], v67 offset:6432
    v_mfma_f32_16x16x32_bf16 v[8:11], v[48:51], v[128:131], v[8:11]
    ds_read_b64_tr_b16 v[96:97], v67 offset:5184
    v_mfma_f32_16x16x32_bf16 v[28:31], v[48:51], v[132:135], v[28:31]
    ds_read_b64_tr_b16 v[98:99], v67 offset:6464
    v_mfma_f32_16x16x32_bf16 v[12:15], v[52:55], v[128:131], v[12:15]
    ds_read_b64_tr_b16 v[100:101], v67 offset:5216
    v_mfma_f32_16x16x32_bf16 v[32:35], v[52:55], v[132:135], v[32:35]
    ds_read_b64_tr_b16 v[102:103], v67 offset:6496
    v_mfma_f32_16x16x32_bf16 v[16:19], v[56:59], v[128:131], v[16:19]
    ds_read_b64_tr_b16 v[104:105], v67 offset:5248
    v_mfma_f32_16x16x32_bf16 v[36:39], v[56:59], v[132:135], v[36:39]
    ds_read_b64_tr_b16 v[106:107], v67 offset:6528
    s_barrier
    s_waitcnt vmcnt(8)
    s_waitcnt lgkmcnt(0)
    v_mfma_f32_16x16x32_bf16 v[0:3], v[88:91], v[136:139], v[0:3]
    ds_read_b64_tr_b16 v[40:41], v67 offset:20480
    v_mfma_f32_16x16x32_bf16 v[20:23], v[88:91], v[140:143], v[20:23]
    ds_read_b64_tr_b16 v[42:43], v67 offset:21760
    v_mfma_f32_16x16x32_bf16 v[4:7], v[92:95], v[136:139], v[4:7]
    ds_read_b64_tr_b16 v[44:45], v67 offset:20512
    v_mfma_f32_16x16x32_bf16 v[24:27], v[92:95], v[140:143], v[24:27]
    ds_read_b64_tr_b16 v[46:47], v67 offset:21792
    v_mfma_f32_16x16x32_bf16 v[8:11], v[96:99], v[136:139], v[8:11]
    ds_read_b64_tr_b16 v[48:49], v67 offset:20544
    v_mfma_f32_16x16x32_bf16 v[28:31], v[96:99], v[140:143], v[28:31]
    ds_read_b64_tr_b16 v[50:51], v67 offset:21824
    v_mfma_f32_16x16x32_bf16 v[12:15], v[100:103], v[136:139], v[12:15]
    ds_read_b64_tr_b16 v[52:53], v67 offset:20576
    v_mfma_f32_16x16x32_bf16 v[32:35], v[100:103], v[140:143], v[32:35]
    ds_read_b64_tr_b16 v[54:55], v67 offset:21856
    v_mfma_f32_16x16x32_bf16 v[16:19], v[104:107], v[136:139], v[16:19]
    ds_read_b64_tr_b16 v[56:57], v67 offset:20608
    v_mfma_f32_16x16x32_bf16 v[36:39], v[104:107], v[140:143], v[36:39]
    ds_read_b64_tr_b16 v[58:59], v67 offset:21888
    s_waitcnt vmcnt(6)
    s_waitcnt lgkmcnt(0)
    v_mfma_f32_16x16x32_bf16 v[0:3], v[40:43], v[144:147], v[0:3]
    ds_read_b64_tr_b16 v[88:89], v67 offset:25600
    v_mfma_f32_16x16x32_bf16 v[20:23], v[40:43], v[148:151], v[20:23]
    ds_read_b64_tr_b16 v[90:91], v67 offset:26880
    v_mfma_f32_16x16x32_bf16 v[4:7], v[44:47], v[144:147], v[4:7]
    ds_read_b64_tr_b16 v[92:93], v67 offset:25632
    v_mfma_f32_16x16x32_bf16 v[24:27], v[44:47], v[148:151], v[24:27]
    ds_read_b64_tr_b16 v[94:95], v67 offset:26912
    v_mfma_f32_16x16x32_bf16 v[8:11], v[48:51], v[144:147], v[8:11]
    ds_read_b64_tr_b16 v[96:97], v67 offset:25664
    v_mfma_f32_16x16x32_bf16 v[28:31], v[48:51], v[148:151], v[28:31]
    ds_read_b64_tr_b16 v[98:99], v67 offset:26944
    v_mfma_f32_16x16x32_bf16 v[12:15], v[52:55], v[144:147], v[12:15]
    ds_read_b64_tr_b16 v[100:101], v67 offset:25696
    v_mfma_f32_16x16x32_bf16 v[32:35], v[52:55], v[148:151], v[32:35]
    ds_read_b64_tr_b16 v[102:103], v67 offset:26976
    v_mfma_f32_16x16x32_bf16 v[16:19], v[56:59], v[144:147], v[16:19]
    ds_read_b64_tr_b16 v[104:105], v67 offset:25728
    v_mfma_f32_16x16x32_bf16 v[36:39], v[56:59], v[148:151], v[36:39]
    ds_read_b64_tr_b16 v[106:107], v67 offset:27008
    s_barrier
    s_waitcnt vmcnt(4)
    s_waitcnt lgkmcnt(0)
    v_mfma_f32_16x16x32_bf16 v[0:3], v[88:91], v[152:155], v[0:3]
    ds_read_b64_tr_b16 v[40:41], v67 offset:40960
    v_mfma_f32_16x16x32_bf16 v[20:23], v[88:91], v[156:159], v[20:23]
    ds_read_b64_tr_b16 v[42:43], v67 offset:42240
    v_mfma_f32_16x16x32_bf16 v[4:7], v[92:95], v[152:155], v[4:7]
    ds_read_b64_tr_b16 v[44:45], v67 offset:40992
    v_mfma_f32_16x16x32_bf16 v[24:27], v[92:95], v[156:159], v[24:27]
    ds_read_b64_tr_b16 v[46:47], v67 offset:42272
    v_mfma_f32_16x16x32_bf16 v[8:11], v[96:99], v[152:155], v[8:11]
    ds_read_b64_tr_b16 v[48:49], v67 offset:41024
    v_mfma_f32_16x16x32_bf16 v[28:31], v[96:99], v[156:159], v[28:31]
    ds_read_b64_tr_b16 v[50:51], v67 offset:42304
    v_mfma_f32_16x16x32_bf16 v[12:15], v[100:103], v[152:155], v[12:15]
    ds_read_b64_tr_b16 v[52:53], v67 offset:41056
    v_mfma_f32_16x16x32_bf16 v[32:35], v[100:103], v[156:159], v[32:35]
    ds_read_b64_tr_b16 v[54:55], v67 offset:42336
    v_mfma_f32_16x16x32_bf16 v[16:19], v[104:107], v[152:155], v[16:19]
    ds_read_b64_tr_b16 v[56:57], v67 offset:41088
    v_mfma_f32_16x16x32_bf16 v[36:39], v[104:107], v[156:159], v[36:39]
    ds_read_b64_tr_b16 v[58:59], v67 offset:42368
    s_waitcnt vmcnt(2)
    s_waitcnt lgkmcnt(0)
    v_mfma_f32_16x16x32_bf16 v[0:3], v[40:43], v[160:163], v[0:3]
    ds_read_b64_tr_b16 v[88:89], v67 offset:46080
    v_mfma_f32_16x16x32_bf16 v[20:23], v[40:43], v[164:167], v[20:23]
    ds_read_b64_tr_b16 v[90:91], v67 offset:47360
    v_mfma_f32_16x16x32_bf16 v[4:7], v[44:47], v[160:163], v[4:7]
    ds_read_b64_tr_b16 v[92:93], v67 offset:46112
    v_mfma_f32_16x16x32_bf16 v[24:27], v[44:47], v[164:167], v[24:27]
    ds_read_b64_tr_b16 v[94:95], v67 offset:47392
    v_mfma_f32_16x16x32_bf16 v[8:11], v[48:51], v[160:163], v[8:11]
    ds_read_b64_tr_b16 v[96:97], v67 offset:46144
    v_mfma_f32_16x16x32_bf16 v[28:31], v[48:51], v[164:167], v[28:31]
    ds_read_b64_tr_b16 v[98:99], v67 offset:47424
    v_mfma_f32_16x16x32_bf16 v[12:15], v[52:55], v[160:163], v[12:15]
    ds_read_b64_tr_b16 v[100:101], v67 offset:46176
    v_mfma_f32_16x16x32_bf16 v[32:35], v[52:55], v[164:167], v[32:35]
    ds_read_b64_tr_b16 v[102:103], v67 offset:47456
    v_mfma_f32_16x16x32_bf16 v[16:19], v[56:59], v[160:163], v[16:19]
    ds_read_b64_tr_b16 v[104:105], v67 offset:46208
    v_mfma_f32_16x16x32_bf16 v[36:39], v[56:59], v[164:167], v[36:39]
    ds_read_b64_tr_b16 v[106:107], v67 offset:47488
    s_waitcnt vmcnt(0)
    s_waitcnt lgkmcnt(0)
    v_mfma_f32_16x16x32_bf16 v[0:3], v[88:91], v[168:171], v[0:3]
    v_mfma_f32_16x16x32_bf16 v[20:23], v[88:91], v[172:175], v[20:23]
    v_mfma_f32_16x16x32_bf16 v[4:7], v[92:95], v[168:171], v[4:7]
    v_mfma_f32_16x16x32_bf16 v[24:27], v[92:95], v[172:175], v[24:27]
    v_mfma_f32_16x16x32_bf16 v[8:11], v[96:99], v[168:171], v[8:11]
    v_mfma_f32_16x16x32_bf16 v[28:31], v[96:99], v[172:175], v[28:31]
    v_mfma_f32_16x16x32_bf16 v[12:15], v[100:103], v[168:171], v[12:15]
    v_mfma_f32_16x16x32_bf16 v[32:35], v[100:103], v[172:175], v[32:35]
    v_mfma_f32_16x16x32_bf16 v[16:19], v[104:107], v[168:171], v[16:19]
    v_mfma_f32_16x16x32_bf16 v[36:39], v[104:107], v[172:175], v[36:39]
    v_lshlrev_b32 v84, 4, v245
    s_mul_i32 s30, s22, 5120
    s_add_u32 s30, s30, 143360
    v_add_u32 v85, s30, v84
    s_xor_b32 s31, s22, 2
    s_mul_i32 s31, s31, 5120
    s_add_u32 s31, s31, 143360
    v_add_u32 v86, s31, v84
    s_nop 1
    ds_write_b128 v85, v[20:23] offset:0
    ds_write_b128 v85, v[24:27] offset:1024
    ds_write_b128 v85, v[28:31] offset:2048
    ds_write_b128 v85, v[32:35] offset:3072
    ds_write_b128 v85, v[36:39] offset:4096
    s_waitcnt lgkmcnt(0)
    s_barrier
    ds_read_b128 v[20:23], v86 offset:0
    ds_read_b128 v[24:27], v86 offset:1024
    ds_read_b128 v[28:31], v86 offset:2048
    ds_read_b128 v[32:35], v86 offset:3072
    ds_read_b128 v[36:39], v86 offset:4096
    v_and_b32 v87, 1, v72
    v_lshlrev_b32 v87, 5, v87
    v_lshrrev_b32 v88, 1, v72
    v_lshl_add_u32 v87, v88, 4, v87
    v_mul_u32_u24 v88, 1280, v71
    v_add_u32 v87, v87, v88
    s_waitcnt lgkmcnt(4)
    v_pk_add_f32 v[0:1], v[0:1], v[20:21]
    v_pk_add_f32 v[2:3], v[2:3], v[22:23]
    v_cvt_pk_bf16_f32 v74, v0, v1
    v_cvt_pk_bf16_f32 v75, v2, v3
    s_waitcnt lgkmcnt(3)
    v_pk_add_f32 v[4:5], v[4:5], v[24:25]
    v_pk_add_f32 v[6:7], v[6:7], v[26:27]
    v_cvt_pk_bf16_f32 v76, v4, v5
    v_cvt_pk_bf16_f32 v77, v6, v7
    s_nop 1
    v_permlane16_swap_b32 v74, v76
    v_permlane16_swap_b32 v75, v77
    buffer_store_dwordx4 v[74:77], v87, s[16:19], s39 offen offset:0
    s_waitcnt lgkmcnt(2)
    v_pk_add_f32 v[8:9], v[8:9], v[28:29]
    v_pk_add_f32 v[10:11], v[10:11], v[30:31]
    v_cvt_pk_bf16_f32 v78, v8, v9
    v_cvt_pk_bf16_f32 v79, v10, v11
    s_waitcnt lgkmcnt(1)
    v_pk_add_f32 v[12:13], v[12:13], v[32:33]
    v_pk_add_f32 v[14:15], v[14:15], v[34:35]
    v_cvt_pk_bf16_f32 v80, v12, v13
    v_cvt_pk_bf16_f32 v81, v14, v15
    s_nop 1
    v_permlane16_swap_b32 v78, v80
    v_permlane16_swap_b32 v79, v81
    buffer_store_dwordx4 v[78:81], v87, s[16:19], s39 offen offset:64
    s_waitcnt lgkmcnt(0)
    v_pk_add_f32 v[16:17], v[16:17], v[36:37]
    v_pk_add_f32 v[18:19], v[18:19], v[38:39]
    v_cvt_pk_bf16_f32 v82, v16, v17
    v_cvt_pk_bf16_f32 v83, v18, v19
    buffer_store_dwordx2 v[82:83], v108, s[16:19], s39 offen offset:128
    s_endpgm
sequential_preLN__softmax_full_mha__dense_activation_silu__prompt_kernel_att_L:
    s_setprio 0
    v_lshlrev_b32 v1, 4, v245
    s_and_b32 s28, s22, 3
    s_mov_b32 s35, 262144
sequential_preLN__softmax_full_mha__dense_activation_silu__prompt_kernel_att_rpoll:
    v_cmp_gt_u32 vcc, 16, v3
    s_cbranch_vccz sequential_preLN__softmax_full_mha__dense_activation_silu__prompt_kernel_att_rpoll_d
    global_load_dword v3, v2, s[4:5] sc1
    s_waitcnt vmcnt(0)
    s_sub_u32 s35, s35, 1
    s_cmp_lg_u32 s35, 0
    s_cbranch_scc1 sequential_preLN__softmax_full_mha__dense_activation_silu__prompt_kernel_att_rpoll
sequential_preLN__softmax_full_mha__dense_activation_silu__prompt_kernel_att_rpoll_d:
    s_and_b32 s30, s2, 7
    s_lshr_b32 s31, s2, 3
    s_lshr_b32 s24, s30, 1
    s_lshl_b32 s24, s24, 3
    s_and_b32 s32, s31, 7
    s_add_u32 s24, s24, s32
    s_and_b32 s25, s30, 1
    s_lshl_b32 s25, s25, 2
    s_lshr_b32 s32, s31, 3
    s_add_u32 s25, s25, s32
    s_mul_i32 s30, s25, 102400
    s_add_u32 s30, s30, 19398656
    s_add_u32 s8, s4, s30
    s_addc_u32 s9, s5, 0
    s_and_b32 s9, s9, 0xffff
    s_mov_b32 s10, 102400
    s_mov_b32 s11, 0x20000
    s_mul_i32 s38, s28, 25600
    s_add_u32 m0, s38, 40960
    s_add_u32 s30, s38, 0
    buffer_load_dwordx4 v1, s[8:11], s30 offen offset:0 sc1 lds
    buffer_load_dwordx4 v1, s[8:11], s30 offen offset:1024 sc1 lds
    buffer_load_dwordx4 v1, s[8:11], s30 offen offset:2048 sc1 lds
    buffer_load_dwordx4 v1, s[8:11], s30 offen offset:3072 sc1 lds
    s_add_u32 m0, s38, 45056
    s_add_u32 s30, s38, 4096
    buffer_load_dwordx4 v1, s[8:11], s30 offen offset:0 sc1 lds
    buffer_load_dwordx4 v1, s[8:11], s30 offen offset:1024 sc1 lds
    buffer_load_dwordx4 v1, s[8:11], s30 offen offset:2048 sc1 lds
    buffer_load_dwordx4 v1, s[8:11], s30 offen offset:3072 sc1 lds
    s_add_u32 m0, s38, 49152
    s_add_u32 s30, s38, 8192
    buffer_load_dwordx4 v1, s[8:11], s30 offen offset:0 sc1 lds
    buffer_load_dwordx4 v1, s[8:11], s30 offen offset:1024 sc1 lds
    buffer_load_dwordx4 v1, s[8:11], s30 offen offset:2048 sc1 lds
    buffer_load_dwordx4 v1, s[8:11], s30 offen offset:3072 sc1 lds
    s_add_u32 m0, s38, 53248
    s_add_u32 s30, s38, 12288
    buffer_load_dwordx4 v1, s[8:11], s30 offen offset:0 sc1 lds
    buffer_load_dwordx4 v1, s[8:11], s30 offen offset:1024 sc1 lds
    buffer_load_dwordx4 v1, s[8:11], s30 offen offset:2048 sc1 lds
    buffer_load_dwordx4 v1, s[8:11], s30 offen offset:3072 sc1 lds
    s_add_u32 m0, s38, 57344
    s_add_u32 s30, s38, 16384
    buffer_load_dwordx4 v1, s[8:11], s30 offen offset:0 sc1 lds
    buffer_load_dwordx4 v1, s[8:11], s30 offen offset:1024 sc1 lds
    buffer_load_dwordx4 v1, s[8:11], s30 offen offset:2048 sc1 lds
    buffer_load_dwordx4 v1, s[8:11], s30 offen offset:3072 sc1 lds
    s_add_u32 m0, s38, 61440
    s_add_u32 s30, s38, 20480
    buffer_load_dwordx4 v1, s[8:11], s30 offen offset:0 sc1 lds
    buffer_load_dwordx4 v1, s[8:11], s30 offen offset:1024 sc1 lds
    buffer_load_dwordx4 v1, s[8:11], s30 offen offset:2048 sc1 lds
    buffer_load_dwordx4 v1, s[8:11], s30 offen offset:3072 sc1 lds
    s_add_u32 m0, s38, 65536
    s_add_u32 s30, s38, 24576
    buffer_load_dwordx4 v1, s[8:11], s30 offen offset:0 sc1 lds
    s_waitcnt vmcnt(0)
    s_barrier
    s_barrier
    s_and_b32 s30, s2, 7
    s_lshr_b32 s31, s2, 3
    s_lshr_b32 s24, s30, 1
    s_lshl_b32 s24, s24, 2
    s_and_b32 s32, s31, 3
    s_add_u32 s24, s24, s32
    s_and_b32 s25, s30, 1
    s_lshl_b32 s25, s25, 3
    s_lshr_b32 s32, s31, 2
    s_add_u32 s25, s25, s32
    s_mul_i32 s30, s25, 122880
    s_add_u32 s30, s30, 22183936
    s_add_u32 s8, s4, s30
    s_addc_u32 s9, s5, 0
    s_and_b32 s9, s9, 0xffff
    s_mov_b32 s10, 122880
    s_mov_b32 s11, 0x20000
    s_mul_i32 s38, s28, 10240
    s_add_u32 m0, s38, 0
    s_add_u32 s30, s38, 0
    buffer_load_dwordx4 v1, s[8:11], s30 offen offset:0 sc1 lds
    buffer_load_dwordx4 v1, s[8:11], s30 offen offset:1024 sc1 lds
    buffer_load_dwordx4 v1, s[8:11], s30 offen offset:2048 sc1 lds
    buffer_load_dwordx4 v1, s[8:11], s30 offen offset:3072 sc1 lds
    s_add_u32 m0, s38, 4096
    s_add_u32 s30, s38, 4096
    buffer_load_dwordx4 v1, s[8:11], s30 offen offset:0 sc1 lds
    buffer_load_dwordx4 v1, s[8:11], s30 offen offset:1024 sc1 lds
    buffer_load_dwordx4 v1, s[8:11], s30 offen offset:2048 sc1 lds
    buffer_load_dwordx4 v1, s[8:11], s30 offen offset:3072 sc1 lds
    s_add_u32 m0, s38, 8192
    s_add_u32 s30, s38, 8192
    buffer_load_dwordx4 v1, s[8:11], s30 offen offset:0 sc1 lds
    buffer_load_dwordx4 v1, s[8:11], s30 offen offset:1024 sc1 lds
    s_barrier
    s_barrier
    s_mul_i32 s30, s25, 122880
    s_add_u32 s30, s30, 22183936
    s_add_u32 s8, s4, s30
    s_addc_u32 s9, s5, 0
    s_and_b32 s9, s9, 0xffff
    s_mov_b32 s10, 122880
    s_mov_b32 s11, 0x20000
    s_mul_i32 s38, s28, 10240
    s_add_u32 s38, s38, 40960
    s_add_u32 m0, s38, 0
    s_add_u32 s30, s38, 0
    buffer_load_dwordx4 v1, s[8:11], s30 offen offset:0 sc1 lds
    buffer_load_dwordx4 v1, s[8:11], s30 offen offset:1024 sc1 lds
    buffer_load_dwordx4 v1, s[8:11], s30 offen offset:2048 sc1 lds
    buffer_load_dwordx4 v1, s[8:11], s30 offen offset:3072 sc1 lds
    s_add_u32 m0, s38, 4096
    s_add_u32 s30, s38, 4096
    buffer_load_dwordx4 v1, s[8:11], s30 offen offset:0 sc1 lds
    buffer_load_dwordx4 v1, s[8:11], s30 offen offset:1024 sc1 lds
    buffer_load_dwordx4 v1, s[8:11], s30 offen offset:2048 sc1 lds
    buffer_load_dwordx4 v1, s[8:11], s30 offen offset:3072 sc1 lds
    s_add_u32 m0, s38, 8192
    s_add_u32 s30, s38, 8192
    buffer_load_dwordx4 v1, s[8:11], s30 offen offset:0 sc1 lds
    buffer_load_dwordx4 v1, s[8:11], s30 offen offset:1024 sc1 lds
    s_barrier
    s_mul_i32 s30, s25, 122880
    s_add_u32 s30, s30, 22183936
    s_add_u32 s8, s4, s30
    s_addc_u32 s9, s5, 0
    s_and_b32 s9, s9, 0xffff
    s_mov_b32 s10, 122880
    s_mov_b32 s11, 0x20000
    s_mul_i32 s38, s28, 10240
    s_add_u32 s38, s38, 81920
    s_add_u32 m0, s38, 0
    s_add_u32 s30, s38, 0
    buffer_load_dwordx4 v1, s[8:11], s30 offen offset:0 sc1 lds
    buffer_load_dwordx4 v1, s[8:11], s30 offen offset:1024 sc1 lds
    buffer_load_dwordx4 v1, s[8:11], s30 offen offset:2048 sc1 lds
    buffer_load_dwordx4 v1, s[8:11], s30 offen offset:3072 sc1 lds
    s_add_u32 m0, s38, 4096
    s_add_u32 s30, s38, 4096
    buffer_load_dwordx4 v1, s[8:11], s30 offen offset:0 sc1 lds
    buffer_load_dwordx4 v1, s[8:11], s30 offen offset:1024 sc1 lds
    buffer_load_dwordx4 v1, s[8:11], s30 offen offset:2048 sc1 lds
    buffer_load_dwordx4 v1, s[8:11], s30 offen offset:3072 sc1 lds
    s_add_u32 m0, s38, 8192
    s_add_u32 s30, s38, 8192
    buffer_load_dwordx4 v1, s[8:11], s30 offen offset:0 sc1 lds
    buffer_load_dwordx4 v1, s[8:11], s30 offen offset:1024 sc1 lds
    s_waitcnt vmcnt(0)
    s_barrier
    s_and_b32 s30, s2, 7
    s_lshr_b32 s31, s2, 3
    s_lshr_b32 s24, s30, 1
    s_lshl_b32 s24, s24, 3
    s_and_b32 s32, s31, 7
    s_add_u32 s24, s24, s32
    s_and_b32 s25, s30, 1
    s_lshl_b32 s25, s25, 2
    s_lshr_b32 s32, s31, 3
    s_add_u32 s25, s25, s32
    s_mul_i32 s30, s25, 245760
    s_add_u32 s30, s30, 20217856
    s_add_u32 s8, s4, s30
    s_addc_u32 s9, s5, 0
    s_and_b32 s9, s9, 0xffff
    s_mov_b32 s10, 245760
    s_mov_b32 s11, 0x20000
    s_and_b32 s26, s22, 1
    s_bfe_u32 s27, s22, 0x10001
    s_mul_i32 s36, s27, 24
    s_add_u32 s36, s36, s26
    s_mul_i32 s36, s36, 5120
    s_mul_i32 s38, s27, 10240
    s_mul_i32 s30, s26, 5120
    s_add_u32 s38, s38, s30
    s_add_u32 m0, s38, 122880
    s_add_u32 s30, s36, 0
    buffer_load_dwordx4 v1, s[8:11], s30 offen offset:0 sc1 lds
    buffer_load_dwordx4 v1, s[8:11], s30 offen offset:1024 sc1 lds
    buffer_load_dwordx4 v1, s[8:11], s30 offen offset:2048 sc1 lds
    buffer_load_dwordx4 v1, s[8:11], s30 offen offset:3072 sc1 lds
    s_add_u32 m0, s38, 126976
    s_add_u32 s30, s36, 4096
    buffer_load_dwordx4 v1, s[8:11], s30 offen sc1 lds
    s_barrier
    s_add_u32 m0, s38, 0
    s_add_u32 s30, s36, 10240
    buffer_load_dwordx4 v1, s[8:11], s30 offen offset:0 sc1 lds
    buffer_load_dwordx4 v1, s[8:11], s30 offen offset:1024 sc1 lds
    buffer_load_dwordx4 v1, s[8:11], s30 offen offset:2048 sc1 lds
    buffer_load_dwordx4 v1, s[8:11], s30 offen offset:3072 sc1 lds
    s_add_u32 m0, s38, 4096
    s_add_u32 s30, s36, 14336
    buffer_load_dwordx4 v1, s[8:11], s30 offen sc1 lds
    s_barrier
    s_add_u32 m0, s38, 20480
    s_add_u32 s30, s36, 20480
    buffer_load_dwordx4 v1, s[8:11], s30 offen offset:0 sc1 lds
    buffer_load_dwordx4 v1, s[8:11], s30 offen offset:1024 sc1 lds
    buffer_load_dwordx4 v1, s[8:11], s30 offen offset:2048 sc1 lds
    buffer_load_dwordx4 v1, s[8:11], s30 offen offset:3072 sc1 lds
    s_add_u32 m0, s38, 24576
    s_add_u32 s30, s36, 24576
    buffer_load_dwordx4 v1, s[8:11], s30 offen sc1 lds
    s_barrier
    s_add_u32 m0, s38, 40960
    s_add_u32 s30, s36, 30720
    buffer_load_dwordx4 v1, s[8:11], s30 offen offset:0 sc1 lds
    buffer_load_dwordx4 v1, s[8:11], s30 offen offset:1024 sc1 lds
    buffer_load_dwordx4 v1, s[8:11], s30 offen offset:2048 sc1 lds
    buffer_load_dwordx4 v1, s[8:11], s30 offen offset:3072 sc1 lds
    s_add_u32 m0, s38, 45056
    s_add_u32 s30, s36, 34816
    buffer_load_dwordx4 v1, s[8:11], s30 offen sc1 lds
    s_barrier
    s_add_u32 m0, s38, 61440
    s_add_u32 s30, s36, 40960
    buffer_load_dwordx4 v1, s[8:11], s30 offen offset:0 sc1 lds
    buffer_load_dwordx4 v1, s[8:11], s30 offen offset:1024 sc1 lds
    buffer_load_dwordx4 v1, s[8:11], s30 offen offset:2048 sc1 lds
    buffer_load_dwordx4 v1, s[8:11], s30 offen offset:3072 sc1 lds
    s_add_u32 m0, s38, 65536
    s_add_u32 s30, s36, 45056
    buffer_load_dwordx4 v1, s[8:11], s30 offen sc1 lds
    s_barrier
    s_add_u32 m0, s38, 81920
    s_add_u32 s30, s36, 51200
    buffer_load_dwordx4 v1, s[8:11], s30 offen offset:0 sc1 lds
    buffer_load_dwordx4 v1, s[8:11], s30 offen offset:1024 sc1 lds
    buffer_load_dwordx4 v1, s[8:11], s30 offen offset:2048 sc1 lds
    buffer_load_dwordx4 v1, s[8:11], s30 offen offset:3072 sc1 lds
    s_add_u32 m0, s38, 86016
    s_add_u32 s30, s36, 55296
    buffer_load_dwordx4 v1, s[8:11], s30 offen sc1 lds
    s_barrier
    s_barrier
    s_barrier
    s_add_u32 m0, s38, 102400
    s_add_u32 s30, s36, 61440
    buffer_load_dwordx4 v1, s[8:11], s30 offen offset:0 sc1 lds
    buffer_load_dwordx4 v1, s[8:11], s30 offen offset:1024 sc1 lds
    buffer_load_dwordx4 v1, s[8:11], s30 offen offset:2048 sc1 lds
    buffer_load_dwordx4 v1, s[8:11], s30 offen offset:3072 sc1 lds
    s_add_u32 m0, s38, 106496
    s_add_u32 s30, s36, 65536
    buffer_load_dwordx4 v1, s[8:11], s30 offen sc1 lds
    s_add_u32 m0, s38, 143360
    s_add_u32 s30, s36, 71680
    buffer_load_dwordx4 v1, s[8:11], s30 offen offset:0 sc1 lds
    buffer_load_dwordx4 v1, s[8:11], s30 offen offset:1024 sc1 lds
    buffer_load_dwordx4 v1, s[8:11], s30 offen offset:2048 sc1 lds
    buffer_load_dwordx4 v1, s[8:11], s30 offen offset:3072 sc1 lds
    s_add_u32 m0, s38, 147456
    s_add_u32 s30, s36, 75776
    buffer_load_dwordx4 v1, s[8:11], s30 offen sc1 lds
    s_waitcnt vmcnt(35)
    s_barrier
    s_waitcnt vmcnt(30)
    s_barrier
    s_waitcnt vmcnt(25)
    s_barrier
    s_waitcnt vmcnt(20)
    s_barrier
    s_waitcnt vmcnt(15)
    s_barrier
    s_waitcnt vmcnt(10)
    s_barrier
    s_add_u32 m0, s38, 122880
    s_add_u32 s30, s36, 81920
    buffer_load_dwordx4 v1, s[8:11], s30 offen offset:0 sc1 lds
    buffer_load_dwordx4 v1, s[8:11], s30 offen offset:1024 sc1 lds
    buffer_load_dwordx4 v1, s[8:11], s30 offen offset:2048 sc1 lds
    buffer_load_dwordx4 v1, s[8:11], s30 offen offset:3072 sc1 lds
    s_add_u32 m0, s38, 126976
    s_add_u32 s30, s36, 86016
    buffer_load_dwordx4 v1, s[8:11], s30 offen sc1 lds
    s_waitcnt vmcnt(10)
    s_barrier
    s_add_u32 m0, s38, 0
    s_add_u32 s30, s36, 92160
    buffer_load_dwordx4 v1, s[8:11], s30 offen offset:0 sc1 lds
    buffer_load_dwordx4 v1, s[8:11], s30 offen offset:1024 sc1 lds
    buffer_load_dwordx4 v1, s[8:11], s30 offen offset:2048 sc1 lds
    buffer_load_dwordx4 v1, s[8:11], s30 offen offset:3072 sc1 lds
    s_add_u32 m0, s38, 4096
    s_add_u32 s30, s36, 96256
    buffer_load_dwordx4 v1, s[8:11], s30 offen sc1 lds
    s_waitcnt vmcnt(10)
    s_barrier
    s_add_u32 m0, s38, 20480
    s_add_u32 s30, s36, 102400
    buffer_load_dwordx4 v1, s[8:11], s30 offen offset:0 sc1 lds
    buffer_load_dwordx4 v1, s[8:11], s30 offen offset:1024 sc1 lds
    buffer_load_dwordx4 v1, s[8:11], s30 offen offset:2048 sc1 lds
    buffer_load_dwordx4 v1, s[8:11], s30 offen offset:3072 sc1 lds
    s_add_u32 m0, s38, 24576
    s_add_u32 s30, s36, 106496
    buffer_load_dwordx4 v1, s[8:11], s30 offen sc1 lds
    s_waitcnt vmcnt(10)
    s_barrier
    s_add_u32 m0, s38, 40960
    s_add_u32 s30, s36, 112640
    buffer_load_dwordx4 v1, s[8:11], s30 offen offset:0 sc1 lds
    buffer_load_dwordx4 v1, s[8:11], s30 offen offset:1024 sc1 lds
    buffer_load_dwordx4 v1, s[8:11], s30 offen offset:2048 sc1 lds
    buffer_load_dwordx4 v1, s[8:11], s30 offen offset:3072 sc1 lds
    s_add_u32 m0, s38, 45056
    s_add_u32 s30, s36, 116736
    buffer_load_dwordx4 v1, s[8:11], s30 offen sc1 lds
    s_waitcnt vmcnt(10)
    s_barrier
    s_waitcnt vmcnt(5)
    s_barrier
    s_waitcnt vmcnt(0)
    s_barrier
    s_barrier
sequential_preLN__softmax_full_mha__dense_activation_silu__prompt_kernel_att_end:
    s_endpgm
all_code_end:
.fill 64, 4, 0xBF800000
.section .rodata,"a"
.p2align 6
.amdhsa_kernel sequential_preLN__softmax_full_mha__dense_activation_silu__prompt_kernel
  .amdhsa_next_free_vgpr 256
  .amdhsa_next_free_sgpr 102
  .amdhsa_accum_offset 256
  .amdhsa_group_segment_fixed_size 0
  .amdhsa_kernarg_size 72
  .amdhsa_user_sgpr_count 2
  .amdhsa_user_sgpr_kernarg_segment_ptr 1
  .amdhsa_system_sgpr_workgroup_id_x 1
.end_amdhsa_kernel
```
